```python
import torch

def _softmax(x, axis=-1):
    return torch.softmax(x, dim=axis)
def _gelu(x):
    return torch.nn.functional.gelu(x, approximate="tanh")
def _silu(x):
    return torch.nn.functional.silu(x)
def _sigmoid(x):
    return torch.sigmoid(x)
def _layernorm(x, axis=-1, eps=1e-5):
    m = x.mean(dim=axis, keepdim=True)
    v = x.var(dim=axis, keepdim=True, unbiased=False)
    return (x - m) / torch.sqrt(v + eps)
def _scatter_add(tgt, idx, src, axis=0):
    return tgt.clone().index_add_(axis, idx, src)
def _segment_sum(src, seg, n):
    out = torch.zeros((n,) + src.shape[1:], dtype=src.dtype)
    return out.index_add_(0, seg, src)
def _pad(x, pw):
    flat = tuple(v for pair in reversed(pw) for v in pair)
    return torch.nn.functional.pad(x, flat)

kernel_name = 'standalone__mha_block_cached__near_ridge'

def setup_inputs():

    _w = (lambda a: (lambda t: t.to(torch.bfloat16) if t.is_floating_point() else t)(torch.as_tensor(a)))
    B, Sq, D = 8, 112, 512
    H, Sk, Dh = 32, 1024, 128
    return {
        "x": _w((lambda *s: torch.randn(*s, dtype=torch.bfloat16) * 0.8)(B, Sq, D)),
        "k_cache": _w((lambda *s: torch.randn(*s, dtype=torch.bfloat16) * 0.8)(B, H, Sk, Dh)),
        "v_cache": _w((lambda *s: torch.randn(*s, dtype=torch.bfloat16) * 0.05)(B, H, Sk, Dh)),
        "wq": _w((lambda *s: torch.randn(*s, dtype=torch.bfloat16) * 0.8)(D, H * Dh) * (D ** -0.5)),
        "wo": _w((lambda *s: torch.randn(*s, dtype=torch.bfloat16) * 0.05)(H * Dh, D) * ((H * Dh) ** -0.5)),
    }

def reference(x, k_cache, v_cache, wq, wo):
    B, Sq, D = x.shape
    H, Dh = 32, 128
    q = (lambda x, *d: x.permute(*d))((x @ wq).reshape(B, Sq, H, Dh), 0, 2, 1, 3)
    scores = torch.einsum("bhqd,bhkd->bhqk", q, k_cache) * (Dh ** -0.5)
    p = _softmax(scores, axis=-1)
    o = torch.einsum("bhqk,bhkd->bhqd", p, v_cache)
    return (lambda x, *d: x.permute(*d))(o, 0, 2, 1, 3).reshape(B, Sq, H * Dh) @ wo
```

```asm
; @launch grid=(256,1,1) block=(256,1,1) lds=163840
.amdgcn_target "amdgcn-amd-amdhsa--gfx950"
.text
.globl standalone__mha_block_cached__near_ridge_kernel
.p2align 8
.type standalone__mha_block_cached__near_ridge_kernel,@function
standalone__mha_block_cached__near_ridge_kernel:
    s_cmp_ge_u32 s2, 256
    s_cbranch_scc1 L_end
    s_load_dwordx16 s[4:19], s[0:1], 0
    v_lshrrev_b32 v1, 6, v0
    v_and_b32 v0, 63, v0
    s_and_b32 s60, s2, 7
    v_readfirstlane_b32 s52, v1
    s_getpc_b64 s[62:63]
L_pcref:
    v_lshlrev_b32 v60, 13, v1
    v_lshl_add_u32 v60, v0, 7, v60
    v_min_u32 v60, L_hot_end - L_pcref, v60
    global_load_dword v48, v60, s[62:63]
    s_lshr_b32 s56, s60, 1
    s_and_b32 s60, s60, 1
    s_lshr_b32 s72, s2, 3
    s_and_b32 s53, s72, 7
    s_lshr_b32 s69, s72, 3
    s_lshl_b32 s55, s60, 2
    s_add_u32 s55, s55, s69
    s_mul_i32 s61, s69, 4
    s_mul_i32 s58, s53, 2
    s_add_u32 s58, s58, s61
    s_lshl_b32 s54, s56, 3
    s_add_u32 s54, s54, s55
    s_and_b32 s58, s58, 7
    s_lshl_b32 s57, s52, 12
    v_lshrrev_b32 v2, 4, v0
    v_and_b32 v3, 15, v0
    v_lshrrev_b32 v6, 3, v0
    v_and_b32 v7, 7, v0
    s_lshl_b32 s60, s52, 5
    v_add_u32 v5, s60, v6
    v_xor_b32 v1, v2, v7
    v_lshlrev_b32 v1, 4, v1
    v_lshl_add_u32 v28, v5, 10, v1
    v_xor_b32 v1, 64, v1
    v_lshl_add_u32 v29, v5, 10, v1
    s_cmp_eq_u32 s52, 3
    s_cselect_b32 s60, 16384, 0
    s_sub_u32 s60, 14336, s60
    v_add_u32 v29, 7168, v29
    v_add_u32 v30, s60, v28
    v_add_u32 v31, s60, v29
    v_lshlrev_b32 v4, 1, v2
    v_xor_b32 v4, v4, v3
    v_lshlrev_b32 v4, 4, v4
    s_lshl_b32 s60, s52, 4
    v_add_u32 v1, s60, v2
    v_lshl_add_u32 v32, v1, 13, v4
    s_mul_i32 s60, s53, 114688
    s_lshl_b32 s61, s54, 8
    v_xor_b32 v34, 128, v32
    v_add_u32 v33, 31744, v32
    v_add_u32 v35, 95232, v34
    v_add_u32 v34, 63488, v34
    s_mov_b32 s22, 114688
    s_mov_b32 s23, 0x20000
    s_sub_u32 s26, 0x400000, s61
    s_mov_b32 s27, 0x20000
    s_add_u32 m0, s57, 16384
    s_waitcnt lgkmcnt(0)
    s_add_u32 s20, s4, s60
    s_addc_u32 s21, s5, 0
    s_add_u32 s24, s10, s61
    s_addc_u32 s25, s11, 0
    s_mov_b32 s3, 0
    s_lshl_b32 s4, s58, 7
    s_lshl_b32 s5, s58, 19
    s_add_u32 s58, s58, 1
    s_and_b32 s58, s58, 7
    buffer_load_dwordx4 v28, s[20:23], s4 offen offset:0  lds
    buffer_load_dwordx4 v29, s[20:23], s4 offen offset:1024  lds
    buffer_load_dwordx4 v30, s[20:23], s4 offen offset:2048  lds
    buffer_load_dwordx4 v31, s[20:23], s4 offen offset:3072  lds
    s_add_u32 m0, s57, 65536
    s_nop 0
    buffer_load_dwordx4 v32, s[24:27], s5 offen offset:0  lds
    buffer_load_dwordx4 v33, s[24:27], s5 offen offset:1024  lds
    buffer_load_dwordx4 v34, s[24:27], s5 offen offset:2048  lds
    buffer_load_dwordx4 v35, s[24:27], s5 offen offset:3072  lds
    s_add_u32 m0, s57, 32768
    s_lshl_b32 s4, s58, 7
    s_lshl_b32 s5, s58, 19
    s_add_u32 s58, s58, 1
    s_and_b32 s58, s58, 7
    buffer_load_dwordx4 v28, s[20:23], s4 offen offset:0  lds
    buffer_load_dwordx4 v29, s[20:23], s4 offen offset:1024  lds
    buffer_load_dwordx4 v30, s[20:23], s4 offen offset:2048  lds
    buffer_load_dwordx4 v31, s[20:23], s4 offen offset:3072  lds
    s_add_u32 m0, s57, 81920
    s_nop 0
    buffer_load_dwordx4 v32, s[24:27], s5 offen offset:0  lds
    buffer_load_dwordx4 v33, s[24:27], s5 offen offset:1024  lds
    buffer_load_dwordx4 v34, s[24:27], s5 offen offset:2048  lds
    buffer_load_dwordx4 v35, s[24:27], s5 offen offset:3072  lds
    s_add_u32 s44, s14, s60
    s_addc_u32 s45, s15, 0
    s_lshl_b32 s60, s53, 5
    s_add_u32 s60, s60, s54
    s_lshl_b32 s60, s60, 18
    s_add_u32 s28, s6, s60
    s_addc_u32 s29, s7, 0
    s_mov_b32 s30, 0x40000
    s_mov_b32 s31, 0x20000
    s_add_u32 s32, s8, s60
    s_addc_u32 s33, s9, 0
    s_mov_b32 s34, 0x40000
    s_mov_b32 s35, 0x20000
    s_add_u32 s6, s57, s3
    s_mov_b32 s46, 114688
    s_mov_b32 s47, 0x20000
    s_lshl_b32 s60, s56, 20
    s_mov_b32 s61, s55
    s_lshl_b32 s61, s61, 7
    s_add_u32 s60, s60, s61
    s_add_u32 s36, s12, s60
    s_addc_u32 s37, s13, 0
    s_sub_u32 s38, 0x400000, s60
    s_mov_b32 s39, 0x20000
    s_mov_b32 s40, s18
    s_mov_b32 s41, s19
    s_mov_b32 s42, 17039488
    s_mov_b32 s43, 0x20000
    s_mov_b32 s48, s16
    s_mov_b32 s49, s17
    s_mov_b32 s50, 256
    s_mov_b32 s51, 0x20000
    s_mov_b32 s70, 0x3e0293ee
    s_lshl_b32 s69, s69, 7
    s_lshl_b32 s60, s72, 2
    s_add_u32 s60, s60, s52
    s_lshl_b32 s60, s60, 13
    s_sub_u32 s69, s60, s69
    v_bfe_u32 v49, v0, 2, 3
    v_lshl_add_u32 v49, v49, 10, s69
    v_and_b32 v60, 3, v0
    v_lshl_add_u32 v49, v60, 7, v49
    s_lshl_b32 s61, s55, 2
    s_lshr_b32 s61, 0x52419876, s61
    s_and_b32 s61, s61, 15
    s_lshl_b32 s9, s61, 14
    s_lshl_b32 s60, s53, 2
    s_add_u32 s60, s60, s56
    s_lshl_b32 s73, s60, 18
    s_lshl_b32 s61, s52, 13
    s_add_u32 s73, s73, s61
    s_lshl_b32 s60, s60, 2
    s_add_u32 s60, s60, s52
    s_lshl_b32 s60, s60, 10
    s_add_u32 s60, s60, 16777216
    v_add_u32 v60, s55, v0
    v_and_b32 v60, 7, v60
    s_lshl_b32 s61, s55, 7
    s_mov_b32 s61, s60
    v_lshl_add_u32 v51, v60, 3, s61
    s_lshl_b32 s61, s55, 3
    s_add_u32 s61, s60, s61
    v_mov_b32 v55, s61
    s_lshl_b32 s60, s53, 3
    s_add_u32 s60, s60, s55
    s_lshl_b32 s60, s60, 2
    s_add_u32 s60, s60, s52
    s_lshl_b32 s74, s60, 15
    s_add_u32 s74, s74, 8388608
    s_lshl_b32 s60, s60, 9
    s_add_u32 s60, s60, 16908288
    v_and_b32 v60, 3, v0
    v_max_u32 v60, 1, v60
    v_xor_b32 v60, s56, v60
    s_lshl_b32 s61, s56, 7
    s_add_u32 s61, s60, s61
    v_lshl_add_u32 v52, v60, 3, s61
    s_lshl_b32 s61, s56, 3
    s_add_u32 s61, s60, s61
    v_lshl_add_u32 v188, v60, 7, s61
    v_mov_b32 v50, 17039360
    s_or_b32 s72, s2, s52
    s_cbranch_scc1 L_noepoch
    buffer_load_dwordx2 v[184:185], v50, s[40:43], 0 offen sc1
L_noepoch:
    v_lshrrev_b32 v6, 1, v3
    v_xor_b32 v6, v6, v2
    v_lshlrev_b32 v6, 4, v6
    v_lshl_add_u32 v6, v3, 7, v6
    s_add_u32 s60, s57, 16384
    v_add_u32 v144, s60, v6
    v_xor_b32 v145, 64, v144
    v_add_u32 v146, 81920, v144
    v_add_u32 v147, 81920, v145
    v_bfe_u32 v60, v0, 2, 2
    v_and_b32 v61, 3, v0
    v_and_b32 v6, 1, v2
    v_lshl_add_u32 v6, v6, 2, v60
    v_lshlrev_b32 v6, 5, v6
    v_lshl_add_u32 v6, v61, 3, v6
    v_lshl_add_u32 v6, v60, 8, v6
    v_lshl_add_u32 v12, v2, 10, v6
    v_lshl_add_u32 v6, v2, 11, v6
    v_add_u32 v128, 65536, v6
    v_xor_b32 v129, 32, v128
    v_xor_b32 v130, 64, v128
    v_xor_b32 v131, 96, v128
    v_xor_b32 v132, 128, v128
    v_xor_b32 v133, 160, v128
    v_xor_b32 v134, 192, v128
    v_xor_b32 v135, 224, v128
    v_add_u32 v136, 49152, v128
    v_add_u32 v137, 49152, v129
    v_add_u32 v138, 49152, v130
    v_add_u32 v139, 49152, v131
    v_add_u32 v140, 49152, v132
    v_add_u32 v141, 49152, v133
    v_add_u32 v142, 49152, v134
    v_add_u32 v143, 49152, v135
    v_lshl_add_u32 v24, v1, 8, v4
    v_xor_b32 v25, 128, v24
    v_mov_b32 v26, v24
    v_mov_b32 v27, v25
    v_add_u32 v4, 0, v2
    v_xor_b32 v4, v4, v3
    v_lshlrev_b32 v4, 4, v4
    v_lshl_add_u32 v20, v1, 8, v4
    v_add_u32 v4, 4, v2
    v_xor_b32 v4, v4, v3
    v_lshlrev_b32 v4, 4, v4
    v_lshl_add_u32 v21, v1, 8, v4
    v_add_u32 v4, 8, v2
    v_xor_b32 v4, v4, v3
    v_lshlrev_b32 v4, 4, v4
    v_lshl_add_u32 v22, v1, 8, v4
    v_add_u32 v4, 12, v2
    v_xor_b32 v4, v4, v3
    v_lshlrev_b32 v4, 4, v4
    v_lshl_add_u32 v23, v1, 8, v4
    s_add_u32 m0, s57, 98304
    s_lshl_b32 s4, s58, 7
    s_lshl_b32 s5, s58, 19
    s_add_u32 s58, s58, 1
    s_and_b32 s58, s58, 7
    buffer_load_dwordx4 v28, s[20:23], s4 offen offset:0  lds
    buffer_load_dwordx4 v29, s[20:23], s4 offen offset:1024  lds
    buffer_load_dwordx4 v30, s[20:23], s4 offen offset:2048  lds
    buffer_load_dwordx4 v31, s[20:23], s4 offen offset:3072  lds
    s_add_u32 m0, s57, 114688
    s_nop 0
    buffer_load_dwordx4 v32, s[24:27], s5 offen offset:0  lds
    buffer_load_dwordx4 v33, s[24:27], s5 offen offset:1024  lds
    buffer_load_dwordx4 v34, s[24:27], s5 offen offset:2048  lds
    buffer_load_dwordx4 v35, s[24:27], s5 offen offset:3072  lds
    s_lshl_b32 s68, s55, 7
    s_cmp_eq_u32 s52, 3
    s_cbranch_scc1 L_one
    s_waitcnt vmcnt(16)
    s_barrier
    ds_read_b128 a[64:67], v144 offset:0
    ds_read_b128 a[68:71], v144 offset:2048
    ds_read_b64_tr_b16 a[0:1], v128 offset:0
    ds_read_b64_tr_b16 a[2:3], v128 offset:1024
    ds_read_b64_tr_b16 a[4:5], v129 offset:0
    ds_read_b64_tr_b16 a[6:7], v129 offset:1024
    ds_read_b64_tr_b16 a[8:9], v130 offset:0
    ds_read_b64_tr_b16 a[10:11], v130 offset:1024
    ds_read_b64_tr_b16 a[12:13], v131 offset:0
    ds_read_b64_tr_b16 a[14:15], v131 offset:1024
    ds_read_b64_tr_b16 a[16:17], v132 offset:0
    ds_read_b64_tr_b16 a[18:19], v132 offset:1024
    ds_read_b64_tr_b16 a[20:21], v133 offset:0
    ds_read_b64_tr_b16 a[22:23], v133 offset:1024
    ds_read_b64_tr_b16 a[24:25], v134 offset:0
    ds_read_b64_tr_b16 a[26:27], v134 offset:1024
    ds_read_b64_tr_b16 a[28:29], v135 offset:0
    ds_read_b64_tr_b16 a[30:31], v135 offset:1024
    s_waitcnt lgkmcnt(14)
    v_mfma_f32_16x16x32_bf16 v[160:163], a[0:3], a[64:67], 0
    ds_read_b128 a[72:75], v145 offset:0
    ds_read_b128 a[76:79], v145 offset:2048
    v_mfma_f32_16x16x32_bf16 v[164:167], a[0:3], a[68:71], 0
    ds_read_b64_tr_b16 a[32:33], v128 offset:8192
    ds_read_b64_tr_b16 a[34:35], v128 offset:9216
    s_add_u32 m0, s57, 131072
    s_lshl_b32 s4, s58, 7
    s_lshl_b32 s5, s58, 19
    s_waitcnt lgkmcnt(14)
    v_mfma_f32_16x16x32_bf16 v[168:171], a[4:7], a[64:67], 0
    ds_read_b64_tr_b16 a[36:37], v129 offset:8192
    ds_read_b64_tr_b16 a[38:39], v129 offset:9216
    buffer_load_dwordx4 v28, s[20:23], s4 offen offset:0  lds
    v_mfma_f32_16x16x32_bf16 v[172:175], a[4:7], a[68:71], 0
    ds_read_b64_tr_b16 a[40:41], v130 offset:8192
    ds_read_b64_tr_b16 a[42:43], v130 offset:9216
    v_mfma_f32_16x16x32_bf16 v[176:179], a[8:11], a[64:67], 0
    ds_read_b64_tr_b16 a[44:45], v131 offset:8192
    ds_read_b64_tr_b16 a[46:47], v131 offset:9216
    buffer_load_dwordx4 v29, s[20:23], s4 offen offset:1024  lds
    v_mfma_f32_16x16x32_bf16 v[180:183], a[8:11], a[68:71], 0
    buffer_load_dwordx4 v30, s[20:23], s4 offen offset:2048  lds
    s_waitcnt lgkmcnt(8)
    v_mfma_f32_16x16x32_bf16 v[148:151], a[12:15], a[64:67], 0
    v_mfma_f32_16x16x32_bf16 v[152:155], a[12:15], a[68:71], 0
    buffer_load_dwordx4 v31, s[20:23], s4 offen offset:3072  lds
    v_mfma_f32_16x16x32_bf16 v[224:227], a[16:19], a[64:67], 0
    ds_read_b64_tr_b16 a[48:49], v132 offset:8192
    ds_read_b64_tr_b16 a[50:51], v132 offset:9216
    s_add_u32 m0, s57, 147456
    s_add_u32 s58, s58, 1
    s_and_b32 s58, s58, 7
    v_mfma_f32_16x16x32_bf16 v[228:231], a[16:19], a[68:71], 0
    ds_read_b64_tr_b16 a[52:53], v133 offset:8192
    ds_read_b64_tr_b16 a[54:55], v133 offset:9216
    v_mfma_f32_16x16x32_bf16 v[232:235], a[20:23], a[64:67], 0
    ds_read_b64_tr_b16 a[56:57], v134 offset:8192
    buffer_load_dwordx4 v32, s[24:27], s5 offen offset:0  lds
    v_mfma_f32_16x16x32_bf16 v[236:239], a[20:23], a[68:71], 0
    ds_read_b64_tr_b16 a[58:59], v134 offset:9216
    ds_read_b64_tr_b16 a[60:61], v135 offset:8192
    buffer_load_dwordx4 v33, s[24:27], s5 offen offset:1024  lds
    v_mfma_f32_16x16x32_bf16 v[240:243], a[24:27], a[64:67], 0
    ds_read_b64_tr_b16 a[62:63], v135 offset:9216
    v_mfma_f32_16x16x32_bf16 v[244:247], a[24:27], a[68:71], 0
    buffer_load_dwordx4 v34, s[24:27], s5 offen offset:2048  lds
    v_mfma_f32_16x16x32_bf16 v[248:251], a[28:31], a[64:67], 0
    buffer_load_dwordx4 v35, s[24:27], s5 offen offset:3072  lds
    v_mfma_f32_16x16x32_bf16 v[252:255], a[28:31], a[68:71], 0
    s_waitcnt lgkmcnt(0)
    v_mfma_f32_16x16x32_bf16 v[160:163], a[32:35], a[72:75], v[160:163]
    s_waitcnt vmcnt(16)
    s_barrier
    v_mfma_f32_16x16x32_bf16 v[164:167], a[32:35], a[76:79], v[164:167]
    ds_read_b128 a[64:67], v144 offset:16384
    ds_read_b128 a[68:71], v144 offset:18432
    s_add_u32 m0, s57, 16384
    s_lshl_b32 s4, s58, 7
    s_lshl_b32 s5, s58, 19
    v_mfma_f32_16x16x32_bf16 v[168:171], a[36:39], a[72:75], v[168:171]
    ds_read_b64_tr_b16 a[0:1], v128 offset:16384
    ds_read_b64_tr_b16 a[2:3], v128 offset:17408
    v_mfma_f32_16x16x32_bf16 v[172:175], a[36:39], a[76:79], v[172:175]
    ds_read_b64_tr_b16 a[4:5], v129 offset:16384
    ds_read_b64_tr_b16 a[6:7], v129 offset:17408
    v_mfma_f32_16x16x32_bf16 v[176:179], a[40:43], a[72:75], v[176:179]
    ds_read_b64_tr_b16 a[8:9], v130 offset:16384
    ds_read_b64_tr_b16 a[10:11], v130 offset:17408
    buffer_load_dwordx4 v28, s[20:23], s4 offen offset:0  lds
    v_mfma_f32_16x16x32_bf16 v[180:183], a[40:43], a[76:79], v[180:183]
    ds_read_b64_tr_b16 a[12:13], v131 offset:16384
    ds_read_b64_tr_b16 a[14:15], v131 offset:17408
    v_mfma_f32_16x16x32_bf16 v[148:151], a[44:47], a[72:75], v[148:151]
    v_add_u32 v12, 49152, v12
    v_xor_b32 v13, 32, v12
    v_mfma_f32_16x16x32_bf16 v[152:155], a[44:47], a[76:79], v[152:155]
    buffer_load_dwordx4 v29, s[20:23], s4 offen offset:1024  lds
    v_xor_b32 v14, 64, v12
    v_mfma_f32_16x16x32_bf16 v[224:227], a[48:51], a[72:75], v[224:227]
    ds_read_b64_tr_b16 a[16:17], v132 offset:16384
    ds_read_b64_tr_b16 a[18:19], v132 offset:17408
    v_mfma_f32_16x16x32_bf16 v[228:231], a[48:51], a[76:79], v[228:231]
    ds_read_b64_tr_b16 a[20:21], v133 offset:16384
    ds_read_b64_tr_b16 a[22:23], v133 offset:17408
    v_mfma_f32_16x16x32_bf16 v[232:235], a[52:55], a[72:75], v[232:235]
    ds_read_b64_tr_b16 a[24:25], v134 offset:16384
    buffer_load_dwordx4 v30, s[20:23], s4 offen offset:2048  lds
    v_mfma_f32_16x16x32_bf16 v[236:239], a[52:55], a[76:79], v[236:239]
    ds_read_b64_tr_b16 a[26:27], v134 offset:17408
    ds_read_b64_tr_b16 a[28:29], v135 offset:16384
    v_mfma_f32_16x16x32_bf16 v[240:243], a[56:59], a[72:75], v[240:243]
    ds_read_b64_tr_b16 a[30:31], v135 offset:17408
    v_xor_b32 v15, 96, v12
    v_mfma_f32_16x16x32_bf16 v[244:247], a[56:59], a[76:79], v[244:247]
    buffer_load_dwordx4 v31, s[20:23], s4 offen offset:3072  lds
    v_xor_b32 v16, 128, v12
    v_mfma_f32_16x16x32_bf16 v[248:251], a[60:63], a[72:75], v[248:251]
    v_xor_b32 v17, 160, v12
    v_xor_b32 v18, 192, v12
    v_mfma_f32_16x16x32_bf16 v[252:255], a[60:63], a[76:79], v[252:255]
    v_xor_b32 v19, 224, v12
    v_xor_b32 v6, v2, v3
    s_waitcnt lgkmcnt(5)
    v_mfma_f32_16x16x32_bf16 v[160:163], a[0:3], a[64:67], v[160:163]
    ds_read_b128 a[72:75], v145 offset:16384
    ds_read_b128 a[76:79], v145 offset:18432
    s_add_u32 m0, s57, 65536
    s_add_u32 s58, s58, 1
    s_and_b32 s58, s58, 7
    v_mfma_f32_16x16x32_bf16 v[164:167], a[0:3], a[68:71], v[164:167]
    ds_read_b64_tr_b16 a[32:33], v128 offset:24576
    ds_read_b64_tr_b16 a[34:35], v128 offset:25600
    v_mfma_f32_16x16x32_bf16 v[168:171], a[4:7], a[64:67], v[168:171]
    ds_read_b64_tr_b16 a[36:37], v129 offset:24576
    ds_read_b64_tr_b16 a[38:39], v129 offset:25600
    v_mfma_f32_16x16x32_bf16 v[172:175], a[4:7], a[68:71], v[172:175]
    ds_read_b64_tr_b16 a[40:41], v130 offset:24576
    ds_read_b64_tr_b16 a[42:43], v130 offset:25600
    buffer_load_dwordx4 v32, s[24:27], s5 offen offset:0  lds
    v_mfma_f32_16x16x32_bf16 v[176:179], a[8:11], a[64:67], v[176:179]
    ds_read_b64_tr_b16 a[44:45], v131 offset:24576
    ds_read_b64_tr_b16 a[46:47], v131 offset:25600
    v_mfma_f32_16x16x32_bf16 v[180:183], a[8:11], a[68:71], v[180:183]
    v_lshlrev_b32 v6, 4, v6
    v_lshl_add_u32 v8, v3, 8, v6
    v_mfma_f32_16x16x32_bf16 v[148:151], a[12:15], a[64:67], v[148:151]
    buffer_load_dwordx4 v33, s[24:27], s5 offen offset:1024  lds
    v_xor_b32 v9, 64, v8
    v_mfma_f32_16x16x32_bf16 v[152:155], a[12:15], a[68:71], v[152:155]
    v_xor_b32 v10, 128, v8
    v_xor_b32 v11, 192, v8
    v_mfma_f32_16x16x32_bf16 v[224:227], a[16:19], a[64:67], v[224:227]
    ds_read_b64_tr_b16 a[48:49], v132 offset:24576
    ds_read_b64_tr_b16 a[50:51], v132 offset:25600
    v_mfma_f32_16x16x32_bf16 v[228:231], a[16:19], a[68:71], v[228:231]
    ds_read_b64_tr_b16 a[52:53], v133 offset:24576
    ds_read_b64_tr_b16 a[54:55], v133 offset:25600
    buffer_load_dwordx4 v34, s[24:27], s5 offen offset:2048  lds
    s_waitcnt lgkmcnt(6)
    v_mfma_f32_16x16x32_bf16 v[232:235], a[20:23], a[64:67], v[232:235]
    ds_read_b64_tr_b16 a[56:57], v134 offset:24576
    v_lshlrev_b32 v6, 1, v2
    v_mfma_f32_16x16x32_bf16 v[236:239], a[20:23], a[68:71], v[236:239]
    ds_read_b64_tr_b16 a[58:59], v134 offset:25600
    ds_read_b64_tr_b16 a[60:61], v135 offset:24576
    v_mfma_f32_16x16x32_bf16 v[240:243], a[24:27], a[64:67], v[240:243]
    ds_read_b64_tr_b16 a[62:63], v135 offset:25600
    buffer_load_dwordx4 v35, s[24:27], s5 offen offset:3072  lds
    v_mfma_f32_16x16x32_bf16 v[244:247], a[24:27], a[68:71], v[244:247]
    v_xor_b32 v6, v6, v7
    v_lshlrev_b32 v6, 4, v6
    v_mfma_f32_16x16x32_bf16 v[248:251], a[28:31], a[64:67], v[248:251]
    v_lshl_add_u32 v36, v5, 10, v6
    v_add_u32 v37, 7168, v36
    v_mfma_f32_16x16x32_bf16 v[252:255], a[28:31], a[68:71], v[252:255]
    v_add_u32 v38, 14336, v36
    v_add_u32 v39, 21504, v36
    s_waitcnt lgkmcnt(0)
    v_mfma_f32_16x16x32_bf16 v[160:163], a[32:35], a[72:75], v[160:163]
    s_waitcnt vmcnt(16)
    s_barrier
    v_mfma_f32_16x16x32_bf16 v[164:167], a[32:35], a[76:79], v[164:167]
    ds_read_b128 a[64:67], v146 offset:0
    ds_read_b128 a[68:71], v146 offset:2048
    s_add_u32 m0, s57, 32768
    s_lshl_b32 s4, s58, 7
    s_lshl_b32 s5, s58, 19
    v_mfma_f32_16x16x32_bf16 v[168:171], a[36:39], a[72:75], v[168:171]
    ds_read_b64_tr_b16 a[0:1], v136 offset:0
    ds_read_b64_tr_b16 a[2:3], v136 offset:1024
    v_mfma_f32_16x16x32_bf16 v[172:175], a[36:39], a[76:79], v[172:175]
    ds_read_b64_tr_b16 a[4:5], v137 offset:0
    ds_read_b64_tr_b16 a[6:7], v137 offset:1024
    v_mfma_f32_16x16x32_bf16 v[176:179], a[40:43], a[72:75], v[176:179]
    ds_read_b64_tr_b16 a[8:9], v138 offset:0
    ds_read_b64_tr_b16 a[10:11], v138 offset:1024
    buffer_load_dwordx4 v28, s[20:23], s4 offen offset:0  lds
    v_mfma_f32_16x16x32_bf16 v[180:183], a[40:43], a[76:79], v[180:183]
    ds_read_b64_tr_b16 a[12:13], v139 offset:0
    ds_read_b64_tr_b16 a[14:15], v139 offset:1024
    v_mfma_f32_16x16x32_bf16 v[148:151], a[44:47], a[72:75], v[148:151]
    v_and_b32 v6, 1, v2
    v_lshlrev_b32 v6, 1, v6
    v_mfma_f32_16x16x32_bf16 v[152:155], a[44:47], a[76:79], v[152:155]
    buffer_load_dwordx4 v29, s[20:23], s4 offen offset:1024  lds
    v_lshrrev_b32 v4, 1, v60
    v_mfma_f32_16x16x32_bf16 v[224:227], a[48:51], a[72:75], v[224:227]
    ds_read_b64_tr_b16 a[16:17], v140 offset:0
    ds_read_b64_tr_b16 a[18:19], v140 offset:1024
    v_mfma_f32_16x16x32_bf16 v[228:231], a[48:51], a[76:79], v[228:231]
    ds_read_b64_tr_b16 a[20:21], v141 offset:0
    ds_read_b64_tr_b16 a[22:23], v141 offset:1024
    v_mfma_f32_16x16x32_bf16 v[232:235], a[52:55], a[72:75], v[232:235]
    ds_read_b64_tr_b16 a[24:25], v142 offset:0
    buffer_load_dwordx4 v30, s[20:23], s4 offen offset:2048  lds
    v_mfma_f32_16x16x32_bf16 v[236:239], a[52:55], a[76:79], v[236:239]
    ds_read_b64_tr_b16 a[26:27], v142 offset:1024
    ds_read_b64_tr_b16 a[28:29], v143 offset:0
    v_mfma_f32_16x16x32_bf16 v[240:243], a[56:59], a[72:75], v[240:243]
    ds_read_b64_tr_b16 a[30:31], v143 offset:1024
    v_or_b32 v6, v6, v4
    v_mfma_f32_16x16x32_bf16 v[244:247], a[56:59], a[76:79], v[244:247]
    buffer_load_dwordx4 v31, s[20:23], s4 offen offset:3072  lds
    v_xor_b32 v6, s56, v6
    v_mfma_f32_16x16x32_bf16 v[248:251], a[60:63], a[72:75], v[248:251]
    v_lshlrev_b32 v6, 5, v6
    v_lshl_add_u32 v6, v61, 3, v6
    v_mfma_f32_16x16x32_bf16 v[252:255], a[60:63], a[76:79], v[252:255]
    v_lshl_add_u32 v6, v60, 7, v6
    v_lshl_add_u32 v40, v2, 9, v6
    s_waitcnt lgkmcnt(5)
    v_mfma_f32_16x16x32_bf16 v[160:163], a[0:3], a[64:67], v[160:163]
    ds_read_b128 a[72:75], v147 offset:0
    ds_read_b128 a[76:79], v147 offset:2048
    s_add_u32 m0, s57, 81920
    s_add_u32 s58, s58, 1
    s_and_b32 s58, s58, 7
    v_mfma_f32_16x16x32_bf16 v[164:167], a[0:3], a[68:71], v[164:167]
    ds_read_b64_tr_b16 a[32:33], v136 offset:8192
    ds_read_b64_tr_b16 a[34:35], v136 offset:9216
    v_mfma_f32_16x16x32_bf16 v[168:171], a[4:7], a[64:67], v[168:171]
    ds_read_b64_tr_b16 a[36:37], v137 offset:8192
    ds_read_b64_tr_b16 a[38:39], v137 offset:9216
    v_mfma_f32_16x16x32_bf16 v[172:175], a[4:7], a[68:71], v[172:175]
    ds_read_b64_tr_b16 a[40:41], v138 offset:8192
    ds_read_b64_tr_b16 a[42:43], v138 offset:9216
    buffer_load_dwordx4 v32, s[24:27], s5 offen offset:0  lds
    v_mfma_f32_16x16x32_bf16 v[176:179], a[8:11], a[64:67], v[176:179]
    ds_read_b64_tr_b16 a[44:45], v139 offset:8192
    ds_read_b64_tr_b16 a[46:47], v139 offset:9216
    v_mfma_f32_16x16x32_bf16 v[180:183], a[8:11], a[68:71], v[180:183]
    v_xor_b32 v41, 32, v40
    v_xor_b32 v42, 64, v40
    v_mfma_f32_16x16x32_bf16 v[148:151], a[12:15], a[64:67], v[148:151]
    buffer_load_dwordx4 v33, s[24:27], s5 offen offset:1024  lds
    v_xor_b32 v43, 96, v40
    v_mfma_f32_16x16x32_bf16 v[152:155], a[12:15], a[68:71], v[152:155]
    v_and_b32 v6, 1, v2
    v_lshl_add_u32 v6, v6, 4, v3
    v_mfma_f32_16x16x32_bf16 v[224:227], a[16:19], a[64:67], v[224:227]
    ds_read_b64_tr_b16 a[48:49], v140 offset:8192
    ds_read_b64_tr_b16 a[50:51], v140 offset:9216
    v_mfma_f32_16x16x32_bf16 v[228:231], a[16:19], a[68:71], v[228:231]
    ds_read_b64_tr_b16 a[52:53], v141 offset:8192
    ds_read_b64_tr_b16 a[54:55], v141 offset:9216
    buffer_load_dwordx4 v34, s[24:27], s5 offen offset:2048  lds
    s_waitcnt lgkmcnt(6)
    v_mfma_f32_16x16x32_bf16 v[232:235], a[20:23], a[64:67], v[232:235]
    ds_read_b64_tr_b16 a[56:57], v142 offset:8192
    v_lshlrev_b32 v6, 10, v6
    v_mfma_f32_16x16x32_bf16 v[236:239], a[20:23], a[68:71], v[236:239]
    ds_read_b64_tr_b16 a[58:59], v142 offset:9216
    ds_read_b64_tr_b16 a[60:61], v143 offset:8192
    v_mfma_f32_16x16x32_bf16 v[240:243], a[24:27], a[64:67], v[240:243]
    ds_read_b64_tr_b16 a[62:63], v143 offset:9216
    buffer_load_dwordx4 v35, s[24:27], s5 offen offset:3072  lds
    v_mfma_f32_16x16x32_bf16 v[244:247], a[24:27], a[68:71], v[244:247]
    v_lshl_add_u32 v6, s52, 15, v6
    v_add_u32 v6, s68, v6
    v_mfma_f32_16x16x32_bf16 v[248:251], a[28:31], a[64:67], v[248:251]
    v_lshl_add_u32 v6, s56, 5, v6
    v_lshrrev_b32 v4, 1, v2
    v_mfma_f32_16x16x32_bf16 v[252:255], a[28:31], a[68:71], v[252:255]
    v_lshl_add_u32 v54, v4, 4, v6
    v_lshlrev_b32 v53, 4, v0
    s_waitcnt lgkmcnt(0)
    v_mfma_f32_16x16x32_bf16 v[160:163], a[32:35], a[72:75], v[160:163]
    s_waitcnt vmcnt(16)
    s_barrier
    v_mfma_f32_16x16x32_bf16 v[164:167], a[32:35], a[76:79], v[164:167]
    ds_read_b128 a[64:67], v146 offset:32768
    ds_read_b128 a[68:71], v146 offset:34816
    s_add_u32 m0, s57, 98304
    s_lshl_b32 s4, s58, 7
    s_lshl_b32 s5, s58, 19
    v_mfma_f32_16x16x32_bf16 v[168:171], a[36:39], a[72:75], v[168:171]
    ds_read_b64_tr_b16 a[0:1], v136 offset:32768
    ds_read_b64_tr_b16 a[2:3], v136 offset:33792
    v_mfma_f32_16x16x32_bf16 v[172:175], a[36:39], a[76:79], v[172:175]
    ds_read_b64_tr_b16 a[4:5], v137 offset:32768
    ds_read_b64_tr_b16 a[6:7], v137 offset:33792
    v_mfma_f32_16x16x32_bf16 v[176:179], a[40:43], a[72:75], v[176:179]
    ds_read_b64_tr_b16 a[8:9], v138 offset:32768
    ds_read_b64_tr_b16 a[10:11], v138 offset:33792
    buffer_load_dwordx4 v28, s[20:23], s4 offen offset:0  lds
    v_mfma_f32_16x16x32_bf16 v[180:183], a[40:43], a[76:79], v[180:183]
    ds_read_b64_tr_b16 a[12:13], v139 offset:32768
    ds_read_b64_tr_b16 a[14:15], v139 offset:33792
    v_mfma_f32_16x16x32_bf16 v[148:151], a[44:47], a[72:75], v[148:151]
    v_mov_b32 v56, 0x3f803f80
    v_mov_b32 v57, 0x3f803f80
    v_mfma_f32_16x16x32_bf16 v[152:155], a[44:47], a[76:79], v[152:155]
    buffer_load_dwordx4 v29, s[20:23], s4 offen offset:1024  lds
    v_mov_b32 v58, 0x3f803f80
    v_mfma_f32_16x16x32_bf16 v[224:227], a[48:51], a[72:75], v[224:227]
    ds_read_b64_tr_b16 a[16:17], v140 offset:32768
    ds_read_b64_tr_b16 a[18:19], v140 offset:33792
    v_mfma_f32_16x16x32_bf16 v[228:231], a[48:51], a[76:79], v[228:231]
    ds_read_b64_tr_b16 a[20:21], v141 offset:32768
    ds_read_b64_tr_b16 a[22:23], v141 offset:33792
    v_mfma_f32_16x16x32_bf16 v[232:235], a[52:55], a[72:75], v[232:235]
    ds_read_b64_tr_b16 a[24:25], v142 offset:32768
    buffer_load_dwordx4 v30, s[20:23], s4 offen offset:2048  lds
    v_mfma_f32_16x16x32_bf16 v[236:239], a[52:55], a[76:79], v[236:239]
    ds_read_b64_tr_b16 a[26:27], v142 offset:33792
    ds_read_b64_tr_b16 a[28:29], v143 offset:32768
    v_mfma_f32_16x16x32_bf16 v[240:243], a[56:59], a[72:75], v[240:243]
    ds_read_b64_tr_b16 a[30:31], v143 offset:33792
    v_mov_b32 v59, 0x3f803f80
    v_mfma_f32_16x16x32_bf16 v[244:247], a[56:59], a[76:79], v[244:247]
    buffer_load_dwordx4 v31, s[20:23], s4 offen offset:3072  lds
    v_mov_b32 v64, 0
    v_mfma_f32_16x16x32_bf16 v[248:251], a[60:63], a[72:75], v[248:251]
    v_mov_b32 v65, 0
    v_mov_b32 v66, 0
    v_mfma_f32_16x16x32_bf16 v[252:255], a[60:63], a[76:79], v[252:255]
    v_mov_b32 v67, 0
    v_mov_b32 v72, 0
    s_waitcnt lgkmcnt(5)
    v_mfma_f32_16x16x32_bf16 v[160:163], a[0:3], a[64:67], v[160:163]
    ds_read_b128 a[72:75], v147 offset:32768
    ds_read_b128 a[76:79], v147 offset:34816
    s_add_u32 m0, s57, 114688
    s_add_u32 s58, s58, 1
    s_and_b32 s58, s58, 7
    v_mfma_f32_16x16x32_bf16 v[164:167], a[0:3], a[68:71], v[164:167]
    ds_read_b64_tr_b16 a[32:33], v136 offset:40960
    ds_read_b64_tr_b16 a[34:35], v136 offset:41984
    v_mfma_f32_16x16x32_bf16 v[168:171], a[4:7], a[64:67], v[168:171]
    ds_read_b64_tr_b16 a[36:37], v137 offset:40960
    ds_read_b64_tr_b16 a[38:39], v137 offset:41984
    v_mfma_f32_16x16x32_bf16 v[172:175], a[4:7], a[68:71], v[172:175]
    ds_read_b64_tr_b16 a[40:41], v138 offset:40960
    ds_read_b64_tr_b16 a[42:43], v138 offset:41984
    buffer_load_dwordx4 v32, s[24:27], s5 offen offset:0  lds
    v_mfma_f32_16x16x32_bf16 v[176:179], a[8:11], a[64:67], v[176:179]
    ds_read_b64_tr_b16 a[44:45], v139 offset:40960
    ds_read_b64_tr_b16 a[46:47], v139 offset:41984
    v_mfma_f32_16x16x32_bf16 v[180:183], a[8:11], a[68:71], v[180:183]
    v_mov_b32 v73, 0
    v_mov_b32 v74, 0
    v_mfma_f32_16x16x32_bf16 v[148:151], a[12:15], a[64:67], v[148:151]
    buffer_load_dwordx4 v33, s[24:27], s5 offen offset:1024  lds
    v_mov_b32 v75, 0
    v_mfma_f32_16x16x32_bf16 v[152:155], a[12:15], a[68:71], v[152:155]
    v_mov_b32 v80, 0
    v_mov_b32 v81, 0
    v_mfma_f32_16x16x32_bf16 v[224:227], a[16:19], a[64:67], v[224:227]
    ds_read_b64_tr_b16 a[48:49], v140 offset:40960
    ds_read_b64_tr_b16 a[50:51], v140 offset:41984
    v_mfma_f32_16x16x32_bf16 v[228:231], a[16:19], a[68:71], v[228:231]
    ds_read_b64_tr_b16 a[52:53], v141 offset:40960
    ds_read_b64_tr_b16 a[54:55], v141 offset:41984
    buffer_load_dwordx4 v34, s[24:27], s5 offen offset:2048  lds
    s_waitcnt lgkmcnt(6)
    v_mfma_f32_16x16x32_bf16 v[232:235], a[20:23], a[64:67], v[232:235]
    ds_read_b64_tr_b16 a[56:57], v142 offset:40960
    v_mov_b32 v82, 0
    v_mfma_f32_16x16x32_bf16 v[236:239], a[20:23], a[68:71], v[236:239]
    ds_read_b64_tr_b16 a[58:59], v142 offset:41984
    ds_read_b64_tr_b16 a[60:61], v143 offset:40960
    v_mfma_f32_16x16x32_bf16 v[240:243], a[24:27], a[64:67], v[240:243]
    ds_read_b64_tr_b16 a[62:63], v143 offset:41984
    buffer_load_dwordx4 v35, s[24:27], s5 offen offset:3072  lds
    v_mfma_f32_16x16x32_bf16 v[244:247], a[24:27], a[68:71], v[244:247]
    v_mov_b32 v83, 0
    v_mov_b32 v88, 0
    v_mfma_f32_16x16x32_bf16 v[248:251], a[28:31], a[64:67], v[248:251]
    v_mov_b32 v89, 0
    v_mov_b32 v90, 0
    v_mfma_f32_16x16x32_bf16 v[252:255], a[28:31], a[68:71], v[252:255]
    v_mov_b32 v91, 0
    v_mov_b32 v96, 0
    s_waitcnt lgkmcnt(0)
    v_mfma_f32_16x16x32_bf16 v[160:163], a[32:35], a[72:75], v[160:163]
    s_waitcnt vmcnt(16)
    s_barrier
    v_mfma_f32_16x16x32_bf16 v[164:167], a[32:35], a[76:79], v[164:167]
    ds_read_b128 a[64:67], v144 offset:0
    ds_read_b128 a[68:71], v144 offset:2048
    buffer_load_dword v49, v49, s[36:39], 0 offen
    v_mfma_f32_16x16x32_bf16 v[168:171], a[36:39], a[72:75], v[168:171]
    ds_read_b64_tr_b16 a[0:1], v128 offset:0
    ds_read_b64_tr_b16 a[2:3], v128 offset:1024
    v_mfma_f32_16x16x32_bf16 v[172:175], a[36:39], a[76:79], v[172:175]
    ds_read_b64_tr_b16 a[4:5], v129 offset:0
    ds_read_b64_tr_b16 a[6:7], v129 offset:1024
    s_add_u32 m0, s57, 131072
    s_lshl_b32 s4, s58, 7
    s_lshl_b32 s5, s58, 19
    v_mfma_f32_16x16x32_bf16 v[176:179], a[40:43], a[72:75], v[176:179]
    ds_read_b64_tr_b16 a[8:9], v130 offset:0
    ds_read_b64_tr_b16 a[10:11], v130 offset:1024
    v_mfma_f32_16x16x32_bf16 v[180:183], a[40:43], a[76:79], v[180:183]
    ds_read_b64_tr_b16 a[12:13], v131 offset:0
    ds_read_b64_tr_b16 a[14:15], v131 offset:1024
    v_mfma_f32_16x16x32_bf16 v[148:151], a[44:47], a[72:75], v[148:151]
    buffer_load_dwordx4 v28, s[20:23], s4 offen offset:0  lds
    v_mov_b32 v97, 0
    v_mfma_f32_16x16x32_bf16 v[152:155], a[44:47], a[76:79], v[152:155]
    v_mov_b32 v98, 0
    v_mov_b32 v99, 0
    v_mfma_f32_16x16x32_bf16 v[224:227], a[48:51], a[72:75], v[224:227]
    ds_read_b64_tr_b16 a[16:17], v132 offset:0
    ds_read_b64_tr_b16 a[18:19], v132 offset:1024
    v_mfma_f32_16x16x32_bf16 v[228:231], a[48:51], a[76:79], v[228:231]
    ds_read_b64_tr_b16 a[20:21], v133 offset:0
    ds_read_b64_tr_b16 a[22:23], v133 offset:1024
    buffer_load_dwordx4 v29, s[20:23], s4 offen offset:1024  lds
    v_mfma_f32_16x16x32_bf16 v[232:235], a[52:55], a[72:75], v[232:235]
    ds_read_b64_tr_b16 a[24:25], v134 offset:0
    v_mov_b32 v104, 0
    v_mfma_f32_16x16x32_bf16 v[236:239], a[52:55], a[76:79], v[236:239]
    ds_read_b64_tr_b16 a[26:27], v134 offset:1024
    ds_read_b64_tr_b16 a[28:29], v135 offset:0
    v_mfma_f32_16x16x32_bf16 v[240:243], a[56:59], a[72:75], v[240:243]
    ds_read_b64_tr_b16 a[30:31], v135 offset:1024
    buffer_load_dwordx4 v30, s[20:23], s4 offen offset:2048  lds
    v_mfma_f32_16x16x32_bf16 v[244:247], a[56:59], a[76:79], v[244:247]
    v_mov_b32 v105, 0
    v_mov_b32 v106, 0
    v_mfma_f32_16x16x32_bf16 v[248:251], a[60:63], a[72:75], v[248:251]
    v_mov_b32 v107, 0
    v_mov_b32 v112, 0
    v_mfma_f32_16x16x32_bf16 v[252:255], a[60:63], a[76:79], v[252:255]
    buffer_load_dwordx4 v31, s[20:23], s4 offen offset:3072  lds
    v_mov_b32 v113, 0
    s_waitcnt lgkmcnt(4)
    v_mfma_f32_16x16x32_bf16 v[160:163], a[0:3], a[64:67], v[160:163]
    ds_read_b128 a[72:75], v145 offset:0
    ds_read_b128 a[76:79], v145 offset:2048
    v_mfma_f32_16x16x32_bf16 v[164:167], a[0:3], a[68:71], v[164:167]
    ds_read_b64_tr_b16 a[32:33], v128 offset:8192
    ds_read_b64_tr_b16 a[34:35], v128 offset:9216
    s_add_u32 m0, s57, 147456
    s_add_u32 s58, s58, 1
    s_and_b32 s58, s58, 7
    v_mfma_f32_16x16x32_bf16 v[168:171], a[4:7], a[64:67], v[168:171]
    ds_read_b64_tr_b16 a[36:37], v129 offset:8192
    ds_read_b64_tr_b16 a[38:39], v129 offset:9216
    v_mfma_f32_16x16x32_bf16 v[172:175], a[4:7], a[68:71], v[172:175]
    ds_read_b64_tr_b16 a[40:41], v130 offset:8192
    ds_read_b64_tr_b16 a[42:43], v130 offset:9216
    v_mfma_f32_16x16x32_bf16 v[176:179], a[8:11], a[64:67], v[176:179]
    ds_read_b64_tr_b16 a[44:45], v131 offset:8192
    ds_read_b64_tr_b16 a[46:47], v131 offset:9216
    buffer_load_dwordx4 v32, s[24:27], s5 offen offset:0  lds
    v_mfma_f32_16x16x32_bf16 v[180:183], a[8:11], a[68:71], v[180:183]
    v_mov_b32 v114, 0
    v_mov_b32 v115, 0
    v_mfma_f32_16x16x32_bf16 v[148:151], a[12:15], a[64:67], v[148:151]
    v_mov_b32 v120, 0
    v_mov_b32 v121, 0
    v_mfma_f32_16x16x32_bf16 v[152:155], a[12:15], a[68:71], v[152:155]
    buffer_load_dwordx4 v33, s[24:27], s5 offen offset:1024  lds
    v_mov_b32 v122, 0
    v_mfma_f32_16x16x32_bf16 v[224:227], a[16:19], a[64:67], v[224:227]
    ds_read_b64_tr_b16 a[48:49], v132 offset:8192
    ds_read_b64_tr_b16 a[50:51], v132 offset:9216
    v_mfma_f32_16x16x32_bf16 v[228:231], a[16:19], a[68:71], v[228:231]
    ds_read_b64_tr_b16 a[52:53], v133 offset:8192
    ds_read_b64_tr_b16 a[54:55], v133 offset:9216
    v_mfma_f32_16x16x32_bf16 v[232:235], a[20:23], a[64:67], v[232:235]
    ds_read_b64_tr_b16 a[56:57], v134 offset:8192
    buffer_load_dwordx4 v34, s[24:27], s5 offen offset:2048  lds
    v_mfma_f32_16x16x32_bf16 v[236:239], a[20:23], a[68:71], v[236:239]
    ds_read_b64_tr_b16 a[58:59], v134 offset:9216
    ds_read_b64_tr_b16 a[60:61], v135 offset:8192
    s_waitcnt lgkmcnt(7)
    v_mfma_f32_16x16x32_bf16 v[240:243], a[24:27], a[64:67], v[240:243]
    ds_read_b64_tr_b16 a[62:63], v135 offset:9216
    v_mov_b32 v123, 0
    v_mfma_f32_16x16x32_bf16 v[244:247], a[24:27], a[68:71], v[244:247]
    buffer_load_dwordx4 v35, s[24:27], s5 offen offset:3072  lds
    v_mov_b32 v68, 0
    v_mfma_f32_16x16x32_bf16 v[248:251], a[28:31], a[64:67], v[248:251]
    v_mov_b32 v69, 0
    v_mov_b32 v70, 0
    v_mfma_f32_16x16x32_bf16 v[252:255], a[28:31], a[68:71], v[252:255]
    v_mov_b32 v71, 0
    v_mov_b32 v76, 0
    s_waitcnt lgkmcnt(0)
    v_mfma_f32_16x16x32_bf16 v[160:163], a[32:35], a[72:75], v[160:163]
    s_waitcnt vmcnt(16)
    s_barrier
    v_mfma_f32_16x16x32_bf16 v[164:167], a[32:35], a[76:79], v[164:167]
    ds_read_b128 a[64:67], v144 offset:16384
    ds_read_b128 a[68:71], v144 offset:18432
    s_add_u32 m0, s6, 0
    s_add_u32 s64, s3, 0
    v_mfma_f32_16x16x32_bf16 v[168:171], a[36:39], a[72:75], v[168:171]
    ds_read_b64_tr_b16 a[0:1], v128 offset:16384
    ds_read_b64_tr_b16 a[2:3], v128 offset:17408
    v_mfma_f32_16x16x32_bf16 v[172:175], a[36:39], a[76:79], v[172:175]
    ds_read_b64_tr_b16 a[4:5], v129 offset:16384
    ds_read_b64_tr_b16 a[6:7], v129 offset:17408
    v_mfma_f32_16x16x32_bf16 v[176:179], a[40:43], a[72:75], v[176:179]
    ds_read_b64_tr_b16 a[8:9], v130 offset:16384
    ds_read_b64_tr_b16 a[10:11], v130 offset:17408
    buffer_load_dwordx4 v20, s[28:31], s64 offen offset:0 nt lds
    v_mfma_f32_16x16x32_bf16 v[180:183], a[40:43], a[76:79], v[180:183]
    ds_read_b64_tr_b16 a[12:13], v131 offset:16384
    ds_read_b64_tr_b16 a[14:15], v131 offset:17408
    v_mfma_f32_16x16x32_bf16 v[148:151], a[44:47], a[72:75], v[148:151]
    v_mov_b32 v77, 0
    v_mov_b32 v78, 0
    v_mfma_f32_16x16x32_bf16 v[152:155], a[44:47], a[76:79], v[152:155]
    buffer_load_dwordx4 v21, s[28:31], s64 offen offset:1024 nt lds
    v_mov_b32 v79, 0
    v_mfma_f32_16x16x32_bf16 v[224:227], a[48:51], a[72:75], v[224:227]
    ds_read_b64_tr_b16 a[16:17], v132 offset:16384
    ds_read_b64_tr_b16 a[18:19], v132 offset:17408
    v_mfma_f32_16x16x32_bf16 v[228:231], a[48:51], a[76:79], v[228:231]
    ds_read_b64_tr_b16 a[20:21], v133 offset:16384
    ds_read_b64_tr_b16 a[22:23], v133 offset:17408
    v_mfma_f32_16x16x32_bf16 v[232:235], a[52:55], a[72:75], v[232:235]
    ds_read_b64_tr_b16 a[24:25], v134 offset:16384
    buffer_load_dwordx4 v22, s[28:31], s64 offen offset:2048 nt lds
    v_mfma_f32_16x16x32_bf16 v[236:239], a[52:55], a[76:79], v[236:239]
    ds_read_b64_tr_b16 a[26:27], v134 offset:17408
    ds_read_b64_tr_b16 a[28:29], v135 offset:16384
    v_mfma_f32_16x16x32_bf16 v[240:243], a[56:59], a[72:75], v[240:243]
    ds_read_b64_tr_b16 a[30:31], v135 offset:17408
    v_mov_b32 v84, 0
    v_mfma_f32_16x16x32_bf16 v[244:247], a[56:59], a[76:79], v[244:247]
    buffer_load_dwordx4 v23, s[28:31], s64 offen offset:3072 nt lds
    v_mov_b32 v85, 0
    v_mfma_f32_16x16x32_bf16 v[248:251], a[60:63], a[72:75], v[248:251]
    v_mov_b32 v86, 0
    v_mov_b32 v87, 0
    v_mfma_f32_16x16x32_bf16 v[252:255], a[60:63], a[76:79], v[252:255]
    v_mov_b32 v92, 0
    v_mov_b32 v93, 0
    s_waitcnt lgkmcnt(5)
    v_mfma_f32_16x16x32_bf16 v[160:163], a[0:3], a[64:67], v[160:163]
    ds_read_b128 a[72:75], v145 offset:16384
    ds_read_b128 a[76:79], v145 offset:18432
    s_add_u32 m0, s6, 49152
    s_add_u32 s65, s3, 0
    v_mfma_f32_16x16x32_bf16 v[164:167], a[0:3], a[68:71], v[164:167]
    ds_read_b64_tr_b16 a[32:33], v128 offset:24576
    ds_read_b64_tr_b16 a[34:35], v128 offset:25600
    v_mfma_f32_16x16x32_bf16 v[168:171], a[4:7], a[64:67], v[168:171]
    ds_read_b64_tr_b16 a[36:37], v129 offset:24576
    ds_read_b64_tr_b16 a[38:39], v129 offset:25600
    v_mfma_f32_16x16x32_bf16 v[172:175], a[4:7], a[68:71], v[172:175]
    ds_read_b64_tr_b16 a[40:41], v130 offset:24576
    ds_read_b64_tr_b16 a[42:43], v130 offset:25600
    buffer_load_dwordx4 v24, s[32:35], s65 offen offset:0 nt lds
    v_mfma_f32_16x16x32_bf16 v[176:179], a[8:11], a[64:67], v[176:179]
    ds_read_b64_tr_b16 a[44:45], v131 offset:24576
    ds_read_b64_tr_b16 a[46:47], v131 offset:25600
    v_mfma_f32_16x16x32_bf16 v[180:183], a[8:11], a[68:71], v[180:183]
    v_mov_b32 v94, 0
    v_mov_b32 v95, 0
    v_mfma_f32_16x16x32_bf16 v[148:151], a[12:15], a[64:67], v[148:151]
    buffer_load_dwordx4 v25, s[32:35], s65 offen offset:1024 nt lds
    v_mov_b32 v100, 0
    v_mfma_f32_16x16x32_bf16 v[152:155], a[12:15], a[68:71], v[152:155]
    v_mov_b32 v101, 0
    v_mov_b32 v102, 0
    v_mfma_f32_16x16x32_bf16 v[224:227], a[16:19], a[64:67], v[224:227]
    ds_read_b64_tr_b16 a[48:49], v132 offset:24576
    ds_read_b64_tr_b16 a[50:51], v132 offset:25600
    v_mfma_f32_16x16x32_bf16 v[228:231], a[16:19], a[68:71], v[228:231]
    ds_read_b64_tr_b16 a[52:53], v133 offset:24576
    ds_read_b64_tr_b16 a[54:55], v133 offset:25600
    buffer_load_dwordx4 v26, s[32:35], s65 offen offset:2048 nt lds
    s_waitcnt lgkmcnt(6)
    v_mfma_f32_16x16x32_bf16 v[232:235], a[20:23], a[64:67], v[232:235]
    ds_read_b64_tr_b16 a[56:57], v134 offset:24576
    v_mov_b32 v103, 0
    v_mfma_f32_16x16x32_bf16 v[236:239], a[20:23], a[68:71], v[236:239]
    ds_read_b64_tr_b16 a[58:59], v134 offset:25600
    ds_read_b64_tr_b16 a[60:61], v135 offset:24576
    v_mfma_f32_16x16x32_bf16 v[240:243], a[24:27], a[64:67], v[240:243]
    ds_read_b64_tr_b16 a[62:63], v135 offset:25600
    buffer_load_dwordx4 v27, s[32:35], s65 offen offset:3072 nt lds
    v_mfma_f32_16x16x32_bf16 v[244:247], a[24:27], a[68:71], v[244:247]
    v_mov_b32 v108, 0
    v_mov_b32 v109, 0
    v_mfma_f32_16x16x32_bf16 v[248:251], a[28:31], a[64:67], v[248:251]
    v_mov_b32 v110, 0
    v_mov_b32 v111, 0
    v_mfma_f32_16x16x32_bf16 v[252:255], a[28:31], a[68:71], v[252:255]
    v_mov_b32 v116, 0
    v_mov_b32 v117, 0
    s_waitcnt lgkmcnt(0)
    v_mfma_f32_16x16x32_bf16 v[160:163], a[32:35], a[72:75], v[160:163]
    s_waitcnt vmcnt(16)
    s_barrier
    v_mfma_f32_16x16x32_bf16 v[164:167], a[32:35], a[76:79], v[164:167]
    ds_read_b128 a[64:67], v146 offset:0
    ds_read_b128 a[68:71], v146 offset:2048
    s_add_u32 m0, s6, 16384
    s_add_u32 s64, s3, 16384
    v_mfma_f32_16x16x32_bf16 v[168:171], a[36:39], a[72:75], v[168:171]
    ds_read_b64_tr_b16 a[0:1], v136 offset:0
    ds_read_b64_tr_b16 a[2:3], v136 offset:1024
    v_mfma_f32_16x16x32_bf16 v[172:175], a[36:39], a[76:79], v[172:175]
    ds_read_b64_tr_b16 a[4:5], v137 offset:0
    ds_read_b64_tr_b16 a[6:7], v137 offset:1024
    v_mfma_f32_16x16x32_bf16 v[176:179], a[40:43], a[72:75], v[176:179]
    ds_read_b64_tr_b16 a[8:9], v138 offset:0
    ds_read_b64_tr_b16 a[10:11], v138 offset:1024
    v_mfma_f32_16x16x32_bf16 v[180:183], a[40:43], a[76:79], v[180:183]
    ds_read_b64_tr_b16 a[12:13], v139 offset:0
    ds_read_b64_tr_b16 a[14:15], v139 offset:1024
    v_mfma_f32_16x16x32_bf16 v[148:151], a[44:47], a[72:75], v[148:151]
    v_mov_b32 v118, 0
    v_mov_b32 v119, 0
    v_mfma_f32_16x16x32_bf16 v[152:155], a[44:47], a[76:79], v[152:155]
    buffer_load_dwordx4 v20, s[28:31], s64 offen offset:0 nt lds
    v_mov_b32 v124, 0
    v_mfma_f32_16x16x32_bf16 v[224:227], a[48:51], a[72:75], v[224:227]
    ds_read_b64_tr_b16 a[16:17], v140 offset:0
    ds_read_b64_tr_b16 a[18:19], v140 offset:1024
    v_mfma_f32_16x16x32_bf16 v[228:231], a[48:51], a[76:79], v[228:231]
    ds_read_b64_tr_b16 a[20:21], v141 offset:0
    ds_read_b64_tr_b16 a[22:23], v141 offset:1024
    v_mfma_f32_16x16x32_bf16 v[232:235], a[52:55], a[72:75], v[232:235]
    ds_read_b64_tr_b16 a[24:25], v142 offset:0
    v_mov_b32 v125, 0
    v_mfma_f32_16x16x32_bf16 v[236:239], a[52:55], a[76:79], v[236:239]
    ds_read_b64_tr_b16 a[26:27], v142 offset:1024
    ds_read_b64_tr_b16 a[28:29], v143 offset:0
    v_mfma_f32_16x16x32_bf16 v[240:243], a[56:59], a[72:75], v[240:243]
    ds_read_b64_tr_b16 a[30:31], v143 offset:1024
    v_mov_b32 v126, 0
    v_mfma_f32_16x16x32_bf16 v[244:247], a[56:59], a[76:79], v[244:247]
    buffer_load_dwordx4 v21, s[28:31], s64 offen offset:1024 nt lds
    v_mov_b32 v127, 0
    v_mfma_f32_16x16x32_bf16 v[248:251], a[60:63], a[72:75], v[248:251]
    v_mfma_f32_16x16x32_bf16 v[252:255], a[60:63], a[76:79], v[252:255]
    s_waitcnt lgkmcnt(8)
    v_mfma_f32_16x16x32_bf16 v[160:163], a[0:3], a[64:67], v[160:163]
    ds_read_b128 a[72:75], v147 offset:0
    ds_read_b128 a[76:79], v147 offset:2048
    v_mfma_f32_16x16x32_bf16 v[164:167], a[0:3], a[68:71], v[164:167]
    ds_read_b64_tr_b16 a[32:33], v136 offset:8192
    ds_read_b64_tr_b16 a[34:35], v136 offset:9216
    v_mfma_f32_16x16x32_bf16 v[168:171], a[4:7], a[64:67], v[168:171]
    ds_read_b64_tr_b16 a[36:37], v137 offset:8192
    ds_read_b64_tr_b16 a[38:39], v137 offset:9216
    v_mfma_f32_16x16x32_bf16 v[172:175], a[4:7], a[68:71], v[172:175]
    ds_read_b64_tr_b16 a[40:41], v138 offset:8192
    ds_read_b64_tr_b16 a[42:43], v138 offset:9216
    buffer_load_dwordx4 v22, s[28:31], s64 offen offset:2048 nt lds
    v_mfma_f32_16x16x32_bf16 v[176:179], a[8:11], a[64:67], v[176:179]
    ds_read_b64_tr_b16 a[44:45], v139 offset:8192
    ds_read_b64_tr_b16 a[46:47], v139 offset:9216
    v_mfma_f32_16x16x32_bf16 v[180:183], a[8:11], a[68:71], v[180:183]
    v_mfma_f32_16x16x32_bf16 v[148:151], a[12:15], a[64:67], v[148:151]
    v_mfma_f32_16x16x32_bf16 v[152:155], a[12:15], a[68:71], v[152:155]
    s_waitcnt lgkmcnt(10)
    v_mfma_f32_16x16x32_bf16 v[224:227], a[16:19], a[64:67], v[224:227]
    ds_read_b64_tr_b16 a[48:49], v140 offset:8192
    ds_read_b64_tr_b16 a[50:51], v140 offset:9216
    v_mfma_f32_16x16x32_bf16 v[228:231], a[16:19], a[68:71], v[228:231]
    ds_read_b64_tr_b16 a[52:53], v141 offset:8192
    ds_read_b64_tr_b16 a[54:55], v141 offset:9216
    buffer_load_dwordx4 v23, s[28:31], s64 offen offset:3072 nt lds
    v_mfma_f32_16x16x32_bf16 v[232:235], a[20:23], a[64:67], v[232:235]
    ds_read_b64_tr_b16 a[56:57], v142 offset:8192
    v_mfma_f32_16x16x32_bf16 v[236:239], a[20:23], a[68:71], v[236:239]
    ds_read_b64_tr_b16 a[58:59], v142 offset:9216
    ds_read_b64_tr_b16 a[60:61], v143 offset:8192
    v_mfma_f32_16x16x32_bf16 v[240:243], a[24:27], a[64:67], v[240:243]
    ds_read_b64_tr_b16 a[62:63], v143 offset:9216
    v_mfma_f32_16x16x32_bf16 v[244:247], a[24:27], a[68:71], v[244:247]
    v_mfma_f32_16x16x32_bf16 v[248:251], a[28:31], a[64:67], v[248:251]
    v_mfma_f32_16x16x32_bf16 v[252:255], a[28:31], a[68:71], v[252:255]
    s_waitcnt lgkmcnt(0)
    v_mfma_f32_16x16x32_bf16 v[160:163], a[32:35], a[72:75], v[160:163]
    s_waitcnt vmcnt(12)
    s_barrier
    v_mfma_f32_16x16x32_bf16 v[164:167], a[32:35], a[76:79], v[164:167]
    ds_read_b128 a[64:67], v146 offset:32768
    ds_read_b128 a[68:71], v146 offset:34816
    s_add_u32 m0, s6, 65536
    s_add_u32 s65, s3, 16384
    v_mfma_f32_16x16x32_bf16 v[168:171], a[36:39], a[72:75], v[168:171]
    ds_read_b64_tr_b16 a[0:1], v136 offset:32768
    ds_read_b64_tr_b16 a[2:3], v136 offset:33792
    v_mfma_f32_16x16x32_bf16 v[172:175], a[36:39], a[76:79], v[172:175]
    ds_read_b64_tr_b16 a[4:5], v137 offset:32768
    ds_read_b64_tr_b16 a[6:7], v137 offset:33792
    v_mfma_f32_16x16x32_bf16 v[176:179], a[40:43], a[72:75], v[176:179]
    ds_read_b64_tr_b16 a[8:9], v138 offset:32768
    ds_read_b64_tr_b16 a[10:11], v138 offset:33792
    v_mfma_f32_16x16x32_bf16 v[180:183], a[40:43], a[76:79], v[180:183]
    ds_read_b64_tr_b16 a[12:13], v139 offset:32768
    ds_read_b64_tr_b16 a[14:15], v139 offset:33792
    v_mfma_f32_16x16x32_bf16 v[148:151], a[44:47], a[72:75], v[148:151]
    v_mfma_f32_16x16x32_bf16 v[152:155], a[44:47], a[76:79], v[152:155]
    buffer_load_dwordx4 v24, s[32:35], s65 offen offset:0 nt lds
    v_mfma_f32_16x16x32_bf16 v[224:227], a[48:51], a[72:75], v[224:227]
    ds_read_b128 a[80:83], v147 offset:32768
    ds_read_b128 a[84:87], v147 offset:34816
    v_mfma_f32_16x16x32_bf16 v[228:231], a[48:51], a[76:79], v[228:231]
    ds_read_b64_tr_b16 a[32:33], v136 offset:40960
    ds_read_b64_tr_b16 a[34:35], v136 offset:41984
    v_mfma_f32_16x16x32_bf16 v[232:235], a[52:55], a[72:75], v[232:235]
    ds_read_b64_tr_b16 a[36:37], v137 offset:40960
    ds_read_b64_tr_b16 a[38:39], v137 offset:41984
    v_mfma_f32_16x16x32_bf16 v[236:239], a[52:55], a[76:79], v[236:239]
    ds_read_b64_tr_b16 a[40:41], v138 offset:40960
    ds_read_b64_tr_b16 a[42:43], v138 offset:41984
    v_mfma_f32_16x16x32_bf16 v[240:243], a[56:59], a[72:75], v[240:243]
    ds_read_b64_tr_b16 a[44:45], v139 offset:40960
    ds_read_b64_tr_b16 a[46:47], v139 offset:41984
    v_mfma_f32_16x16x32_bf16 v[244:247], a[56:59], a[76:79], v[244:247]
    buffer_load_dwordx4 v25, s[32:35], s65 offen offset:1024 nt lds
    v_mfma_f32_16x16x32_bf16 v[248:251], a[60:63], a[72:75], v[248:251]
    v_mfma_f32_16x16x32_bf16 v[252:255], a[60:63], a[76:79], v[252:255]
    s_waitcnt lgkmcnt(10)
    v_mfma_f32_16x16x32_bf16 v[160:163], a[0:3], a[64:67], v[160:163]
    ds_read_b64_tr_b16 a[16:17], v140 offset:32768
    ds_read_b64_tr_b16 a[18:19], v140 offset:33792
    v_mfma_f32_16x16x32_bf16 v[164:167], a[0:3], a[68:71], v[164:167]
    ds_read_b64_tr_b16 a[20:21], v141 offset:32768
    ds_read_b64_tr_b16 a[22:23], v141 offset:33792
    v_mfma_f32_16x16x32_bf16 v[168:171], a[4:7], a[64:67], v[168:171]
    ds_read_b64_tr_b16 a[24:25], v142 offset:32768
    v_mfma_f32_16x16x32_bf16 v[172:175], a[4:7], a[68:71], v[172:175]
    ds_read_b64_tr_b16 a[26:27], v142 offset:33792
    ds_read_b64_tr_b16 a[28:29], v143 offset:32768
    buffer_load_dwordx4 v26, s[32:35], s65 offen offset:2048 nt lds
    v_mfma_f32_16x16x32_bf16 v[176:179], a[8:11], a[64:67], v[176:179]
    ds_read_b64_tr_b16 a[30:31], v143 offset:33792
    v_mfma_f32_16x16x32_bf16 v[180:183], a[8:11], a[68:71], v[180:183]
    v_mfma_f32_16x16x32_bf16 v[148:151], a[12:15], a[64:67], v[148:151]
    v_mfma_f32_16x16x32_bf16 v[152:155], a[12:15], a[68:71], v[152:155]
    s_waitcnt lgkmcnt(8)
    v_mfma_f32_16x16x32_bf16 v[160:163], a[32:35], a[80:83], v[160:163]
    ds_read_b64_tr_b16 a[48:49], v140 offset:40960
    ds_read_b64_tr_b16 a[50:51], v140 offset:41984
    v_mfma_f32_16x16x32_bf16 v[164:167], a[32:35], a[84:87], v[164:167]
    ds_read_b64_tr_b16 a[52:53], v141 offset:40960
    ds_read_b64_tr_b16 a[54:55], v141 offset:41984
    buffer_load_dwordx4 v27, s[32:35], s65 offen offset:3072 nt lds
    v_mfma_f32_16x16x32_bf16 v[168:171], a[36:39], a[80:83], v[168:171]
    ds_read_b64_tr_b16 a[56:57], v142 offset:40960
    v_mfma_f32_16x16x32_bf16 v[172:175], a[36:39], a[84:87], v[172:175]
    ds_read_b64_tr_b16 a[58:59], v142 offset:41984
    ds_read_b64_tr_b16 a[60:61], v143 offset:40960
    v_mfma_f32_16x16x32_bf16 v[176:179], a[40:43], a[80:83], v[176:179]
    ds_read_b64_tr_b16 a[62:63], v143 offset:41984
    v_mfma_f32_16x16x32_bf16 v[180:183], a[40:43], a[84:87], v[180:183]
    v_mfma_f32_16x16x32_bf16 v[148:151], a[44:47], a[80:83], v[148:151]
    v_mfma_f32_16x16x32_bf16 v[152:155], a[44:47], a[84:87], v[152:155]
    s_waitcnt lgkmcnt(8)
    v_mfma_f32_16x16x32_bf16 v[224:227], a[16:19], a[64:67], v[224:227]
    s_waitcnt vmcnt(12)
    s_barrier
    v_mfma_f32_16x16x32_bf16 v[228:231], a[16:19], a[68:71], v[228:231]
    ds_read_b128 a[0:3], v8 offset:0
    v_mfma_f32_16x16x32_bf16 v[232:235], a[20:23], a[64:67], v[232:235]
    ds_read_b128 a[16:19], v8 offset:4096
    v_mul_f32 v160, s70, v160
    v_mul_f32 v161, s70, v161
    v_mul_f32 v162, s70, v162
    v_mfma_f32_16x16x32_bf16 v[236:239], a[20:23], a[68:71], v[236:239]
    v_mul_f32 v163, s70, v163
    v_mul_f32 v168, s70, v168
    v_mfma_f32_16x16x32_bf16 v[240:243], a[24:27], a[64:67], v[240:243]
    ds_read_b128 a[4:7], v9 offset:0
    v_mul_f32 v169, s70, v169
    v_mul_f32 v170, s70, v170
    v_mfma_f32_16x16x32_bf16 v[244:247], a[24:27], a[68:71], v[244:247]
    v_mul_f32 v171, s70, v171
    v_mul_f32 v164, s70, v164
    v_mul_f32 v165, s70, v165
    v_mfma_f32_16x16x32_bf16 v[248:251], a[28:31], a[64:67], v[248:251]
    ds_read_b128 a[20:23], v9 offset:4096
    v_mul_f32 v166, s70, v166
    v_mul_f32 v167, s70, v167
    v_mfma_f32_16x16x32_bf16 v[252:255], a[28:31], a[68:71], v[252:255]
    v_mul_f32 v172, s70, v172
    v_mul_f32 v173, s70, v173
    s_waitcnt lgkmcnt(2)
    v_mfma_f32_16x16x32_bf16 v[224:227], a[48:51], a[80:83], v[224:227]
    ds_read_b128 a[8:11], v10 offset:0
    v_mul_f32 v174, s70, v174
    v_mul_f32 v175, s70, v175
    v_mfma_f32_16x16x32_bf16 v[228:231], a[48:51], a[84:87], v[228:231]
    v_mul_f32 v176, s70, v176
    v_mul_f32 v177, s70, v177
    v_mul_f32 v178, s70, v178
    v_mfma_f32_16x16x32_bf16 v[232:235], a[52:55], a[80:83], v[232:235]
    ds_read_b128 a[24:27], v10 offset:4096
    v_mul_f32 v179, s70, v179
    v_mul_f32 v148, s70, v148
    v_mfma_f32_16x16x32_bf16 v[236:239], a[52:55], a[84:87], v[236:239]
    v_mul_f32 v149, s70, v149
    v_mul_f32 v150, s70, v150
    v_mfma_f32_16x16x32_bf16 v[240:243], a[56:59], a[80:83], v[240:243]
    ds_read_b128 a[12:15], v11 offset:0
    v_mul_f32 v151, s70, v151
    v_mul_f32 v180, s70, v180
    v_mul_f32 v181, s70, v181
    v_mfma_f32_16x16x32_bf16 v[244:247], a[56:59], a[84:87], v[244:247]
    v_mul_f32 v182, s70, v182
    v_mul_f32 v183, s70, v183
    v_mfma_f32_16x16x32_bf16 v[248:251], a[60:63], a[80:83], v[248:251]
    ds_read_b128 a[28:31], v11 offset:4096
    v_mul_f32 v152, s70, v152
    v_mul_f32 v153, s70, v153
    v_mfma_f32_16x16x32_bf16 v[252:255], a[60:63], a[84:87], v[252:255]
    v_mul_f32 v154, s70, v154
    v_mul_f32 v155, s70, v155
    s_add_u32 m0, s6, 32768
    s_add_u32 s64, s3, 32768
    v_cvt_pk_bf16_f32 v192, v160, v161
    v_cvt_pk_bf16_f32 v193, v162, v163
    v_cvt_pk_bf16_f32 v194, v168, v169
    v_cvt_pk_bf16_f32 v195, v170, v171
    v_cvt_pk_bf16_f32 v208, v164, v165
    v_cvt_pk_bf16_f32 v209, v166, v167
    v_cvt_pk_bf16_f32 v210, v172, v173
    buffer_load_dwordx4 v20, s[28:31], s64 offen offset:0 nt lds
    v_cvt_pk_bf16_f32 v211, v174, v175
    v_cvt_pk_bf16_f32 v196, v176, v177
    v_cvt_pk_bf16_f32 v197, v178, v179
    v_cvt_pk_bf16_f32 v198, v148, v149
    v_cvt_pk_bf16_f32 v199, v150, v151
    v_cvt_pk_bf16_f32 v212, v180, v181
    v_cvt_pk_bf16_f32 v213, v182, v183
    buffer_load_dwordx4 v21, s[28:31], s64 offen offset:1024 nt lds
    v_cvt_pk_bf16_f32 v214, v152, v153
    v_cvt_pk_bf16_f32 v215, v154, v155
    s_nop 0
    v_permlane32_swap_b32 v192, v194
    v_permlane32_swap_b32 v193, v195
    v_permlane32_swap_b32 v208, v210
    v_permlane32_swap_b32 v209, v211
    buffer_load_dwordx4 v22, s[28:31], s64 offen offset:2048 nt lds
    v_permlane32_swap_b32 v196, v198
    v_permlane32_swap_b32 v197, v199
    v_permlane32_swap_b32 v212, v214
    v_permlane32_swap_b32 v213, v215
    s_nop 0
    v_permlane16_swap_b32 v192, v194
    v_permlane16_swap_b32 v193, v195
    buffer_load_dwordx4 v23, s[28:31], s64 offen offset:3072 nt lds
    v_permlane16_swap_b32 v208, v210
    v_permlane16_swap_b32 v209, v211
    v_permlane16_swap_b32 v196, v198
    v_permlane16_swap_b32 v197, v199
    v_permlane16_swap_b32 v212, v214
    v_permlane16_swap_b32 v213, v215
    s_nop 0
    v_mfma_f32_16x16x32_bf16 v[128:131], a[0:3], v[192:195], 0
    v_mul_f32 v224, s70, v224
    v_mul_f32 v225, s70, v225
    v_mul_f32 v226, s70, v226
    v_mul_f32 v227, s70, v227
    v_mul_f32 v232, s70, v232
    v_mul_f32 v233, s70, v233
    v_mul_f32 v234, s70, v234
    v_mul_f32 v235, s70, v235
    v_mul_f32 v228, s70, v228
    v_mfma_f32_16x16x32_bf16 v[132:135], a[0:3], v[208:211], 0
    ds_read_b128 a[0:3], v8 offset:8192
    v_mul_f32 v229, s70, v229
    v_mul_f32 v230, s70, v230
    v_mul_f32 v231, s70, v231
    v_mul_f32 v236, s70, v236
    v_mul_f32 v237, s70, v237
    v_mul_f32 v238, s70, v238
    v_mul_f32 v239, s70, v239
    v_mul_f32 v240, s70, v240
    v_mfma_f32_16x16x32_bf16 v[136:139], a[16:19], v[192:195], 0
    v_mul_f32 v241, s70, v241
    v_mul_f32 v242, s70, v242
    v_mul_f32 v243, s70, v243
    v_mul_f32 v248, s70, v248
    v_mul_f32 v249, s70, v249
    v_mul_f32 v250, s70, v250
    v_mul_f32 v251, s70, v251
    v_mul_f32 v244, s70, v244
    v_mul_f32 v245, s70, v245
    v_mfma_f32_16x16x32_bf16 v[140:143], a[16:19], v[208:211], 0
    ds_read_b128 a[16:19], v8 offset:12288
    v_mul_f32 v246, s70, v246
    v_mul_f32 v247, s70, v247
    v_mul_f32 v252, s70, v252
    v_mul_f32 v253, s70, v253
    v_mul_f32 v254, s70, v254
    v_mul_f32 v255, s70, v255
    v_cvt_pk_bf16_f32 v200, v224, v225
    v_cvt_pk_bf16_f32 v201, v226, v227
    s_waitcnt lgkmcnt(1)
    v_mfma_f32_16x16x32_bf16 v[128:131], a[4:7], v[196:199], v[128:131]
    v_cvt_pk_bf16_f32 v202, v232, v233
    v_cvt_pk_bf16_f32 v203, v234, v235
    v_cvt_pk_bf16_f32 v216, v228, v229
    v_cvt_pk_bf16_f32 v217, v230, v231
    v_cvt_pk_bf16_f32 v218, v236, v237
    v_cvt_pk_bf16_f32 v219, v238, v239
    v_cvt_pk_bf16_f32 v204, v240, v241
    v_cvt_pk_bf16_f32 v205, v242, v243
    v_mfma_f32_16x16x32_bf16 v[132:135], a[4:7], v[212:215], v[132:135]
    ds_read_b128 a[4:7], v9 offset:8192
    v_cvt_pk_bf16_f32 v206, v248, v249
    v_cvt_pk_bf16_f32 v207, v250, v251
    v_cvt_pk_bf16_f32 v220, v244, v245
    v_cvt_pk_bf16_f32 v221, v246, v247
    v_cvt_pk_bf16_f32 v222, v252, v253
    v_cvt_pk_bf16_f32 v223, v254, v255
    s_nop 0
    v_permlane32_swap_b32 v200, v202
    v_permlane32_swap_b32 v201, v203
    v_mfma_f32_16x16x32_bf16 v[136:139], a[20:23], v[196:199], v[136:139]
    v_permlane32_swap_b32 v216, v218
    v_permlane32_swap_b32 v217, v219
    v_permlane32_swap_b32 v204, v206
    v_permlane32_swap_b32 v205, v207
    v_permlane32_swap_b32 v220, v222
    v_permlane32_swap_b32 v221, v223
    s_nop 0
    v_permlane16_swap_b32 v200, v202
    v_mfma_f32_16x16x32_bf16 v[140:143], a[20:23], v[212:215], v[140:143]
    ds_read_b128 a[20:23], v9 offset:12288
    v_permlane16_swap_b32 v201, v203
    v_permlane16_swap_b32 v216, v218
    v_permlane16_swap_b32 v217, v219
    v_permlane16_swap_b32 v204, v206
    v_permlane16_swap_b32 v205, v207
    v_permlane16_swap_b32 v220, v222
    v_permlane16_swap_b32 v221, v223
    s_nop 0
    v_mfma_f32_16x16x32_bf16 v[128:131], a[8:11], v[200:203], v[128:131]
    v_mov_b32 v168, 0
    v_mfma_f32_16x16x32_bf16 v[132:135], a[8:11], v[216:219], v[132:135]
    ds_read_b128 a[8:11], v10 offset:8192
    v_mov_b32 v169, 0
    v_mfma_f32_16x16x32_bf16 v[136:139], a[24:27], v[200:203], v[136:139]
    v_mov_b32 v170, 0
    v_mfma_f32_16x16x32_bf16 v[140:143], a[24:27], v[216:219], v[140:143]
    ds_read_b128 a[24:27], v10 offset:12288
    v_mov_b32 v171, 0
    v_mfma_f32_16x16x32_bf16 v[128:131], a[12:15], v[204:207], v[128:131]
    v_mov_b32 v172, 0
    v_mfma_f32_16x16x32_bf16 v[132:135], a[12:15], v[220:223], v[132:135]
    ds_read_b128 a[12:15], v11 offset:8192
    v_mov_b32 v173, 0
    v_mfma_f32_16x16x32_bf16 v[136:139], a[28:31], v[204:207], v[136:139]
    v_mov_b32 v174, 0
    v_mfma_f32_16x16x32_bf16 v[140:143], a[28:31], v[220:223], v[140:143]
    ds_read_b128 a[28:31], v11 offset:12288
    v_mov_b32 v175, 0
    s_waitcnt vmcnt(12)
    s_barrier
    s_add_u32 m0, s6, 81920
    s_add_u32 s65, s3, 32768
    ds_read_b64_tr_b16 a[32:33], v12 offset:0
    ds_read_b64_tr_b16 a[34:35], v12 offset:4096
    ds_read_b64_tr_b16 a[36:37], v13 offset:0
    ds_read_b64_tr_b16 a[38:39], v13 offset:4096
    ds_read_b64_tr_b16 a[40:41], v14 offset:0
    ds_read_b64_tr_b16 a[42:43], v14 offset:4096
    ds_read_b64_tr_b16 a[44:45], v15 offset:0
    ds_read_b64_tr_b16 a[46:47], v15 offset:4096
    buffer_load_dwordx4 v24, s[32:35], s65 offen offset:0 nt lds
    buffer_load_dwordx4 v25, s[32:35], s65 offen offset:1024 nt lds
    buffer_load_dwordx4 v26, s[32:35], s65 offen offset:2048 nt lds
    buffer_load_dwordx4 v27, s[32:35], s65 offen offset:3072 nt lds
    v_max3_f32 v48, v128, v129, v130
    v_max3_f32 v48, v48, v131, v136
    v_max3_f32 v48, v48, v137, v138
    v_max_f32 v48, v48, v139
    v_max3_f32 v49, v132, v133, v134
    v_max3_f32 v49, v49, v135, v140
    v_max3_f32 v49, v49, v141, v142
    v_max_f32 v49, v49, v143
    v_mov_b32 v60, v48
    v_mov_b32 v61, v49
    s_nop 1
    v_permlane32_swap_b32 v48, v60
    v_permlane32_swap_b32 v49, v61
    v_max_f32 v48, v48, v60
    v_max_f32 v49, v49, v61
    v_mov_b32 v60, v48
    v_mov_b32 v61, v49
    s_nop 1
    v_permlane16_swap_b32 v48, v60
    v_permlane16_swap_b32 v49, v61
    v_max_f32 v48, v48, v60
    v_max_f32 v49, v49, v61
    v_sub_f32 v160, 0, v48
    v_sub_f32 v161, 0, v48
    v_sub_f32 v162, 0, v48
    v_sub_f32 v163, 0, v48
    v_sub_f32 v164, 0, v49
    v_sub_f32 v165, 0, v49
    v_sub_f32 v166, 0, v49
    v_sub_f32 v167, 0, v49
    v_sub_f32 v128, v128, v48
    v_sub_f32 v129, v129, v48
    v_sub_f32 v130, v130, v48
    v_sub_f32 v131, v131, v48
    v_sub_f32 v136, v136, v48
    v_sub_f32 v137, v137, v48
    v_sub_f32 v138, v138, v48
    v_sub_f32 v139, v139, v48
    v_sub_f32 v132, v132, v49
    v_sub_f32 v133, v133, v49
    v_sub_f32 v134, v134, v49
    v_sub_f32 v135, v135, v49
    v_sub_f32 v140, v140, v49
    v_sub_f32 v141, v141, v49
    v_sub_f32 v142, v142, v49
    v_sub_f32 v143, v143, v49
    v_mfma_f32_16x16x32_bf16 v[144:147], a[0:3], v[192:195], v[160:163]
    v_exp_f32 v128, v128
    v_mfma_f32_16x16x32_bf16 v[148:151], a[0:3], v[208:211], v[164:167]
    v_exp_f32 v129, v129
    s_waitcnt lgkmcnt(0)
    v_mfma_f32_16x16x32_bf16 v[152:155], a[16:19], v[192:195], v[160:163]
    ds_read_b64_tr_b16 a[48:49], v16 offset:0
    ds_read_b64_tr_b16 a[50:51], v16 offset:4096
    v_mfma_f32_16x16x32_bf16 v[156:159], a[16:19], v[208:211], v[164:167]
    v_exp_f32 v130, v130
    v_mfma_f32_16x16x32_bf16 v[144:147], a[4:7], v[196:199], v[144:147]
    v_exp_f32 v131, v131
    v_mfma_f32_16x16x32_bf16 v[148:151], a[4:7], v[212:215], v[148:151]
    ds_read_b64_tr_b16 a[52:53], v17 offset:0
    ds_read_b64_tr_b16 a[54:55], v17 offset:4096
    v_cvt_pk_bf16_f32 v176, v128, v129
    v_mfma_f32_16x16x32_bf16 v[152:155], a[20:23], v[196:199], v[152:155]
    v_exp_f32 v136, v136
    v_mfma_f32_16x16x32_bf16 v[156:159], a[20:23], v[212:215], v[156:159]
    v_exp_f32 v137, v137
    v_mfma_f32_16x16x32_bf16 v[144:147], a[8:11], v[200:203], v[144:147]
    ds_read_b64_tr_b16 a[56:57], v18 offset:0
    ds_read_b64_tr_b16 a[58:59], v18 offset:4096
    v_cvt_pk_bf16_f32 v177, v130, v131
    v_mfma_f32_16x16x32_bf16 v[148:151], a[8:11], v[216:219], v[148:151]
    v_exp_f32 v138, v138
    v_mfma_f32_16x16x32_bf16 v[152:155], a[24:27], v[200:203], v[152:155]
    v_exp_f32 v139, v139
    v_mfma_f32_16x16x32_bf16 v[156:159], a[24:27], v[216:219], v[156:159]
    ds_read_b64_tr_b16 a[60:61], v19 offset:0
    ds_read_b64_tr_b16 a[62:63], v19 offset:4096
    v_cvt_pk_bf16_f32 v178, v136, v137
    v_mfma_f32_16x16x32_bf16 v[144:147], a[12:15], v[204:207], v[144:147]
    v_exp_f32 v132, v132
    v_cvt_pk_bf16_f32 v179, v138, v139
    v_mfma_f32_16x16x32_bf16 v[148:151], a[12:15], v[220:223], v[148:151]
    v_exp_f32 v133, v133
    v_mfma_f32_16x16x32_bf16 v[152:155], a[28:31], v[204:207], v[152:155]
    v_exp_f32 v134, v134
    v_mfma_f32_16x16x32_bf16 v[156:159], a[28:31], v[220:223], v[156:159]
    v_exp_f32 v135, v135
    v_cvt_pk_bf16_f32 v180, v132, v133
    s_mov_b32 s59, 0
    s_mov_b32 s64, 49152
    s_mov_b32 s65, 49152
L_a_2:
    s_waitcnt lgkmcnt(0)
    v_mfma_f32_16x16x32_bf16 v[168:171], v[56:59], v[176:179], v[168:171]
    s_waitcnt vmcnt(12)
    s_barrier
    ds_read_b128 a[0:3], v8 offset:16384
    v_cvt_pk_bf16_f32 v181, v134, v135
    v_mfma_f32_16x16x32_bf16 v[64:67], a[32:35], v[176:179], v[64:67]
    s_add_u32 m0, s57, 0
    v_exp_f32 v140, v140
    v_mfma_f32_16x16x32_bf16 v[72:75], a[36:39], v[176:179], v[72:75]
    ds_read_b128 a[16:19], v8 offset:20480
    ds_read_b128 a[4:7], v9 offset:16384
    v_mfma_f32_16x16x32_bf16 v[80:83], a[40:43], v[176:179], v[80:83]
    v_exp_f32 v141, v141
    v_mfma_f32_16x16x32_bf16 v[88:91], a[44:47], v[176:179], v[88:91]
    ds_read_b128 a[20:23], v9 offset:20480
    v_cvt_pk_bf16_f32 v182, v140, v141
    v_mfma_f32_16x16x32_bf16 v[96:99], a[48:51], v[176:179], v[96:99]
    v_exp_f32 v142, v142
    v_mfma_f32_16x16x32_bf16 v[104:107], a[52:55], v[176:179], v[104:107]
    v_exp_f32 v143, v143
    v_mfma_f32_16x16x32_bf16 v[112:115], a[56:59], v[176:179], v[112:115]
    ds_read_b128 a[8:11], v10 offset:16384
    v_cvt_pk_bf16_f32 v183, v142, v143
    v_mfma_f32_16x16x32_bf16 v[120:123], a[60:63], v[176:179], v[120:123]
    ds_read_b128 a[24:27], v10 offset:20480
    v_max3_f32 v48, v144, v145, v146
    v_mfma_f32_16x16x32_bf16 v[172:175], v[56:59], v[180:183], v[172:175]
    ds_read_b128 a[12:15], v11 offset:16384
    v_max3_f32 v49, v148, v149, v150
    v_mfma_f32_16x16x32_bf16 v[68:71], a[32:35], v[180:183], v[68:71]
    ds_read_b128 a[28:31], v11 offset:20480
    v_max3_f32 v48, v48, v147, v152
    v_mfma_f32_16x16x32_bf16 v[76:79], a[36:39], v[180:183], v[76:79]
    ds_read_b64_tr_b16 a[32:33], v12 offset:8192
    v_max3_f32 v49, v49, v151, v156
    v_mfma_f32_16x16x32_bf16 v[84:87], a[40:43], v[180:183], v[84:87]
    ds_read_b64_tr_b16 a[34:35], v12 offset:12288
    buffer_load_dwordx4 v20, s[28:31], s64 offen offset:0 nt lds
    v_max3_f32 v48, v48, v153, v154
    v_mfma_f32_16x16x32_bf16 v[92:95], a[44:47], v[180:183], v[92:95]
    ds_read_b64_tr_b16 a[36:37], v13 offset:8192
    v_max3_f32 v49, v49, v157, v158
    v_mfma_f32_16x16x32_bf16 v[100:103], a[48:51], v[180:183], v[100:103]
    ds_read_b64_tr_b16 a[38:39], v13 offset:12288
    v_max_f32 v49, v49, v159
    v_mfma_f32_16x16x32_bf16 v[108:111], a[52:55], v[180:183], v[108:111]
    ds_read_b64_tr_b16 a[40:41], v14 offset:8192
    v_max3_f32 v48, v48, v155, v49
    v_mfma_f32_16x16x32_bf16 v[116:119], a[56:59], v[180:183], v[116:119]
    ds_read_b64_tr_b16 a[42:43], v14 offset:12288
    v_cmp_lt_f32 vcc, 0x41000000, v48
    v_mfma_f32_16x16x32_bf16 v[124:127], a[60:63], v[180:183], v[124:127]
    ds_read_b64_tr_b16 a[44:45], v15 offset:8192
    ds_read_b64_tr_b16 a[46:47], v15 offset:12288
    s_cbranch_vccnz L_rs_0_2
L_rsb_0_2:
    s_waitcnt lgkmcnt(7)
    v_mfma_f32_16x16x32_bf16 v[128:131], a[0:3], v[192:195], v[160:163]
    buffer_load_dwordx4 v21, s[28:31], s64 offen offset:1024 nt lds
    v_exp_f32 v144, v144
    v_mfma_f32_16x16x32_bf16 v[132:135], a[0:3], v[208:211], v[164:167]
    v_exp_f32 v145, v145
    v_mfma_f32_16x16x32_bf16 v[136:139], a[16:19], v[192:195], v[160:163]
    ds_read_b64_tr_b16 a[48:49], v16 offset:8192
    ds_read_b64_tr_b16 a[50:51], v16 offset:12288
    v_mfma_f32_16x16x32_bf16 v[140:143], a[16:19], v[208:211], v[164:167]
    v_exp_f32 v146, v146
    v_mfma_f32_16x16x32_bf16 v[128:131], a[4:7], v[196:199], v[128:131]
    v_exp_f32 v147, v147
    v_mfma_f32_16x16x32_bf16 v[132:135], a[4:7], v[212:215], v[132:135]
    ds_read_b64_tr_b16 a[52:53], v17 offset:8192
    ds_read_b64_tr_b16 a[54:55], v17 offset:12288
    v_cvt_pk_bf16_f32 v176, v144, v145
    v_mfma_f32_16x16x32_bf16 v[136:139], a[20:23], v[196:199], v[136:139]
    buffer_load_dwordx4 v22, s[28:31], s64 offen offset:2048 nt lds
    v_exp_f32 v152, v152
    v_mfma_f32_16x16x32_bf16 v[140:143], a[20:23], v[212:215], v[140:143]
    v_exp_f32 v153, v153
    v_mfma_f32_16x16x32_bf16 v[128:131], a[8:11], v[200:203], v[128:131]
    ds_read_b64_tr_b16 a[56:57], v18 offset:8192
    ds_read_b64_tr_b16 a[58:59], v18 offset:12288
    v_cvt_pk_bf16_f32 v177, v146, v147
    v_mfma_f32_16x16x32_bf16 v[132:135], a[8:11], v[216:219], v[132:135]
    v_exp_f32 v154, v154
    v_mfma_f32_16x16x32_bf16 v[136:139], a[24:27], v[200:203], v[136:139]
    v_exp_f32 v155, v155
    v_mfma_f32_16x16x32_bf16 v[140:143], a[24:27], v[216:219], v[140:143]
    ds_read_b64_tr_b16 a[60:61], v19 offset:8192
    ds_read_b64_tr_b16 a[62:63], v19 offset:12288
    v_cvt_pk_bf16_f32 v178, v152, v153
    v_mfma_f32_16x16x32_bf16 v[128:131], a[12:15], v[204:207], v[128:131]
    v_exp_f32 v148, v148
    v_cvt_pk_bf16_f32 v179, v154, v155
    v_mfma_f32_16x16x32_bf16 v[132:135], a[12:15], v[220:223], v[132:135]
    buffer_load_dwordx4 v23, s[28:31], s64 offen offset:3072 nt lds
    v_exp_f32 v149, v149
    v_mfma_f32_16x16x32_bf16 v[136:139], a[28:31], v[204:207], v[136:139]
    v_exp_f32 v150, v150
    v_mfma_f32_16x16x32_bf16 v[140:143], a[28:31], v[220:223], v[140:143]
    s_add_u32 s64, s64, 16384
    v_exp_f32 v151, v151
    v_cvt_pk_bf16_f32 v180, v148, v149
    s_waitcnt lgkmcnt(0)
    v_mfma_f32_16x16x32_bf16 v[168:171], v[56:59], v[176:179], v[168:171]
    s_waitcnt vmcnt(12)
    s_barrier
    ds_read_b128 a[0:3], v8 offset:24576
    v_cvt_pk_bf16_f32 v181, v150, v151
    v_mfma_f32_16x16x32_bf16 v[64:67], a[32:35], v[176:179], v[64:67]
    s_add_u32 m0, s57, 49152
    v_exp_f32 v156, v156
    v_mfma_f32_16x16x32_bf16 v[72:75], a[36:39], v[176:179], v[72:75]
    ds_read_b128 a[16:19], v8 offset:28672
    ds_read_b128 a[4:7], v9 offset:24576
    v_mfma_f32_16x16x32_bf16 v[80:83], a[40:43], v[176:179], v[80:83]
    v_exp_f32 v157, v157
    v_mfma_f32_16x16x32_bf16 v[88:91], a[44:47], v[176:179], v[88:91]
    ds_read_b128 a[20:23], v9 offset:28672
    v_cvt_pk_bf16_f32 v182, v156, v157
    v_mfma_f32_16x16x32_bf16 v[96:99], a[48:51], v[176:179], v[96:99]
    v_exp_f32 v158, v158
    v_mfma_f32_16x16x32_bf16 v[104:107], a[52:55], v[176:179], v[104:107]
    v_exp_f32 v159, v159
    v_mfma_f32_16x16x32_bf16 v[112:115], a[56:59], v[176:179], v[112:115]
    ds_read_b128 a[8:11], v10 offset:24576
    v_cvt_pk_bf16_f32 v183, v158, v159
    v_mfma_f32_16x16x32_bf16 v[120:123], a[60:63], v[176:179], v[120:123]
    ds_read_b128 a[24:27], v10 offset:28672
    v_max3_f32 v48, v128, v129, v130
    v_mfma_f32_16x16x32_bf16 v[172:175], v[56:59], v[180:183], v[172:175]
    ds_read_b128 a[12:15], v11 offset:24576
    v_max3_f32 v49, v132, v133, v134
    v_mfma_f32_16x16x32_bf16 v[68:71], a[32:35], v[180:183], v[68:71]
    ds_read_b128 a[28:31], v11 offset:28672
    v_max3_f32 v48, v48, v131, v136
    v_mfma_f32_16x16x32_bf16 v[76:79], a[36:39], v[180:183], v[76:79]
    ds_read_b64_tr_b16 a[32:33], v12 offset:16384
    v_max3_f32 v49, v49, v135, v140
    v_mfma_f32_16x16x32_bf16 v[84:87], a[40:43], v[180:183], v[84:87]
    ds_read_b64_tr_b16 a[34:35], v12 offset:20480
    buffer_load_dwordx4 v24, s[32:35], s65 offen offset:0 nt lds
    v_max3_f32 v48, v48, v137, v138
    v_mfma_f32_16x16x32_bf16 v[92:95], a[44:47], v[180:183], v[92:95]
    ds_read_b64_tr_b16 a[36:37], v13 offset:16384
    v_max3_f32 v49, v49, v141, v142
    v_mfma_f32_16x16x32_bf16 v[100:103], a[48:51], v[180:183], v[100:103]
    ds_read_b64_tr_b16 a[38:39], v13 offset:20480
    v_max_f32 v49, v49, v143
    v_mfma_f32_16x16x32_bf16 v[108:111], a[52:55], v[180:183], v[108:111]
    ds_read_b64_tr_b16 a[40:41], v14 offset:16384
    v_max3_f32 v48, v48, v139, v49
    v_mfma_f32_16x16x32_bf16 v[116:119], a[56:59], v[180:183], v[116:119]
    ds_read_b64_tr_b16 a[42:43], v14 offset:20480
    v_cmp_lt_f32 vcc, 0x41000000, v48
    v_mfma_f32_16x16x32_bf16 v[124:127], a[60:63], v[180:183], v[124:127]
    ds_read_b64_tr_b16 a[44:45], v15 offset:16384
    ds_read_b64_tr_b16 a[46:47], v15 offset:20480
    s_cbranch_vccnz L_rs_1_2
L_rsb_1_2:
    s_waitcnt lgkmcnt(7)
    v_mfma_f32_16x16x32_bf16 v[144:147], a[0:3], v[192:195], v[160:163]
    buffer_load_dwordx4 v25, s[32:35], s65 offen offset:1024 nt lds
    v_exp_f32 v128, v128
    v_mfma_f32_16x16x32_bf16 v[148:151], a[0:3], v[208:211], v[164:167]
    v_exp_f32 v129, v129
    v_mfma_f32_16x16x32_bf16 v[152:155], a[16:19], v[192:195], v[160:163]
    ds_read_b64_tr_b16 a[48:49], v16 offset:16384
    ds_read_b64_tr_b16 a[50:51], v16 offset:20480
    v_mfma_f32_16x16x32_bf16 v[156:159], a[16:19], v[208:211], v[164:167]
    v_exp_f32 v130, v130
    v_mfma_f32_16x16x32_bf16 v[144:147], a[4:7], v[196:199], v[144:147]
    v_exp_f32 v131, v131
    v_mfma_f32_16x16x32_bf16 v[148:151], a[4:7], v[212:215], v[148:151]
    ds_read_b64_tr_b16 a[52:53], v17 offset:16384
    ds_read_b64_tr_b16 a[54:55], v17 offset:20480
    v_cvt_pk_bf16_f32 v176, v128, v129
    v_mfma_f32_16x16x32_bf16 v[152:155], a[20:23], v[196:199], v[152:155]
    buffer_load_dwordx4 v26, s[32:35], s65 offen offset:2048 nt lds
    v_exp_f32 v136, v136
    v_mfma_f32_16x16x32_bf16 v[156:159], a[20:23], v[212:215], v[156:159]
    v_exp_f32 v137, v137
    v_mfma_f32_16x16x32_bf16 v[144:147], a[8:11], v[200:203], v[144:147]
    ds_read_b64_tr_b16 a[56:57], v18 offset:16384
    ds_read_b64_tr_b16 a[58:59], v18 offset:20480
    v_cvt_pk_bf16_f32 v177, v130, v131
    v_mfma_f32_16x16x32_bf16 v[148:151], a[8:11], v[216:219], v[148:151]
    v_exp_f32 v138, v138
    v_mfma_f32_16x16x32_bf16 v[152:155], a[24:27], v[200:203], v[152:155]
    v_exp_f32 v139, v139
    v_mfma_f32_16x16x32_bf16 v[156:159], a[24:27], v[216:219], v[156:159]
    ds_read_b64_tr_b16 a[60:61], v19 offset:16384
    ds_read_b64_tr_b16 a[62:63], v19 offset:20480
    v_cvt_pk_bf16_f32 v178, v136, v137
    v_mfma_f32_16x16x32_bf16 v[144:147], a[12:15], v[204:207], v[144:147]
    v_exp_f32 v132, v132
    v_cvt_pk_bf16_f32 v179, v138, v139
    v_mfma_f32_16x16x32_bf16 v[148:151], a[12:15], v[220:223], v[148:151]
    buffer_load_dwordx4 v27, s[32:35], s65 offen offset:3072 nt lds
    v_exp_f32 v133, v133
    v_mfma_f32_16x16x32_bf16 v[152:155], a[28:31], v[204:207], v[152:155]
    v_exp_f32 v134, v134
    v_mfma_f32_16x16x32_bf16 v[156:159], a[28:31], v[220:223], v[156:159]
    s_mov_b32 s65, s64
    v_exp_f32 v135, v135
    v_cvt_pk_bf16_f32 v180, v132, v133
    s_call_b64 s[62:63], L_x
    s_waitcnt lgkmcnt(0)
    v_mfma_f32_16x16x32_bf16 v[168:171], v[56:59], v[176:179], v[168:171]
    s_waitcnt vmcnt(12)
    s_barrier
    ds_read_b128 a[0:3], v8 offset:32768
    v_cvt_pk_bf16_f32 v181, v134, v135
    v_mfma_f32_16x16x32_bf16 v[64:67], a[32:35], v[176:179], v[64:67]
    s_add_u32 m0, s57, 16384
    v_exp_f32 v140, v140
    v_mfma_f32_16x16x32_bf16 v[72:75], a[36:39], v[176:179], v[72:75]
    ds_read_b128 a[16:19], v8 offset:36864
    ds_read_b128 a[4:7], v9 offset:32768
    v_mfma_f32_16x16x32_bf16 v[80:83], a[40:43], v[176:179], v[80:83]
    v_exp_f32 v141, v141
    v_mfma_f32_16x16x32_bf16 v[88:91], a[44:47], v[176:179], v[88:91]
    ds_read_b128 a[20:23], v9 offset:36864
    v_cvt_pk_bf16_f32 v182, v140, v141
    v_mfma_f32_16x16x32_bf16 v[96:99], a[48:51], v[176:179], v[96:99]
    v_exp_f32 v142, v142
    v_mfma_f32_16x16x32_bf16 v[104:107], a[52:55], v[176:179], v[104:107]
    v_exp_f32 v143, v143
    v_mfma_f32_16x16x32_bf16 v[112:115], a[56:59], v[176:179], v[112:115]
    ds_read_b128 a[8:11], v10 offset:32768
    v_cvt_pk_bf16_f32 v183, v142, v143
    v_mfma_f32_16x16x32_bf16 v[120:123], a[60:63], v[176:179], v[120:123]
    ds_read_b128 a[24:27], v10 offset:36864
    v_max3_f32 v48, v144, v145, v146
    v_mfma_f32_16x16x32_bf16 v[172:175], v[56:59], v[180:183], v[172:175]
    ds_read_b128 a[12:15], v11 offset:32768
    v_max3_f32 v49, v148, v149, v150
    v_mfma_f32_16x16x32_bf16 v[68:71], a[32:35], v[180:183], v[68:71]
    ds_read_b128 a[28:31], v11 offset:36864
    v_max3_f32 v48, v48, v147, v152
    v_mfma_f32_16x16x32_bf16 v[76:79], a[36:39], v[180:183], v[76:79]
    ds_read_b64_tr_b16 a[32:33], v12 offset:24576
    v_max3_f32 v49, v49, v151, v156
    v_mfma_f32_16x16x32_bf16 v[84:87], a[40:43], v[180:183], v[84:87]
    ds_read_b64_tr_b16 a[34:35], v12 offset:28672
    buffer_load_dwordx4 v20, s[28:31], s64 offen offset:0 nt lds
    v_max3_f32 v48, v48, v153, v154
    v_mfma_f32_16x16x32_bf16 v[92:95], a[44:47], v[180:183], v[92:95]
    ds_read_b64_tr_b16 a[36:37], v13 offset:24576
    v_max3_f32 v49, v49, v157, v158
    v_mfma_f32_16x16x32_bf16 v[100:103], a[48:51], v[180:183], v[100:103]
    ds_read_b64_tr_b16 a[38:39], v13 offset:28672
    v_max_f32 v49, v49, v159
    v_mfma_f32_16x16x32_bf16 v[108:111], a[52:55], v[180:183], v[108:111]
    ds_read_b64_tr_b16 a[40:41], v14 offset:24576
    v_max3_f32 v48, v48, v155, v49
    v_mfma_f32_16x16x32_bf16 v[116:119], a[56:59], v[180:183], v[116:119]
    ds_read_b64_tr_b16 a[42:43], v14 offset:28672
    v_cmp_lt_f32 vcc, 0x41000000, v48
    v_mfma_f32_16x16x32_bf16 v[124:127], a[60:63], v[180:183], v[124:127]
    ds_read_b64_tr_b16 a[44:45], v15 offset:24576
    ds_read_b64_tr_b16 a[46:47], v15 offset:28672
    s_cbranch_vccnz L_rs_2_2
L_rsb_2_2:
    s_waitcnt lgkmcnt(7)
    v_mfma_f32_16x16x32_bf16 v[128:131], a[0:3], v[192:195], v[160:163]
    buffer_load_dwordx4 v21, s[28:31], s64 offen offset:1024 nt lds
    v_exp_f32 v144, v144
    v_mfma_f32_16x16x32_bf16 v[132:135], a[0:3], v[208:211], v[164:167]
    v_exp_f32 v145, v145
    v_mfma_f32_16x16x32_bf16 v[136:139], a[16:19], v[192:195], v[160:163]
    ds_read_b64_tr_b16 a[48:49], v16 offset:24576
    ds_read_b64_tr_b16 a[50:51], v16 offset:28672
    v_mfma_f32_16x16x32_bf16 v[140:143], a[16:19], v[208:211], v[164:167]
    v_exp_f32 v146, v146
    v_mfma_f32_16x16x32_bf16 v[128:131], a[4:7], v[196:199], v[128:131]
    v_exp_f32 v147, v147
    v_mfma_f32_16x16x32_bf16 v[132:135], a[4:7], v[212:215], v[132:135]
    ds_read_b64_tr_b16 a[52:53], v17 offset:24576
    ds_read_b64_tr_b16 a[54:55], v17 offset:28672
    v_cvt_pk_bf16_f32 v176, v144, v145
    v_mfma_f32_16x16x32_bf16 v[136:139], a[20:23], v[196:199], v[136:139]
    buffer_load_dwordx4 v22, s[28:31], s64 offen offset:2048 nt lds
    v_exp_f32 v152, v152
    v_mfma_f32_16x16x32_bf16 v[140:143], a[20:23], v[212:215], v[140:143]
    v_exp_f32 v153, v153
    v_mfma_f32_16x16x32_bf16 v[128:131], a[8:11], v[200:203], v[128:131]
    ds_read_b64_tr_b16 a[56:57], v18 offset:24576
    ds_read_b64_tr_b16 a[58:59], v18 offset:28672
    v_cvt_pk_bf16_f32 v177, v146, v147
    v_mfma_f32_16x16x32_bf16 v[132:135], a[8:11], v[216:219], v[132:135]
    v_exp_f32 v154, v154
    v_mfma_f32_16x16x32_bf16 v[136:139], a[24:27], v[200:203], v[136:139]
    v_exp_f32 v155, v155
    v_mfma_f32_16x16x32_bf16 v[140:143], a[24:27], v[216:219], v[140:143]
    ds_read_b64_tr_b16 a[60:61], v19 offset:24576
    ds_read_b64_tr_b16 a[62:63], v19 offset:28672
    v_cvt_pk_bf16_f32 v178, v152, v153
    v_mfma_f32_16x16x32_bf16 v[128:131], a[12:15], v[204:207], v[128:131]
    v_exp_f32 v148, v148
    v_cvt_pk_bf16_f32 v179, v154, v155
    v_mfma_f32_16x16x32_bf16 v[132:135], a[12:15], v[220:223], v[132:135]
    buffer_load_dwordx4 v23, s[28:31], s64 offen offset:3072 nt lds
    v_exp_f32 v149, v149
    v_mfma_f32_16x16x32_bf16 v[136:139], a[28:31], v[204:207], v[136:139]
    v_exp_f32 v150, v150
    v_mfma_f32_16x16x32_bf16 v[140:143], a[28:31], v[220:223], v[140:143]
    s_add_u32 s64, s64, 16384
    v_exp_f32 v151, v151
    v_cvt_pk_bf16_f32 v180, v148, v149
    s_waitcnt lgkmcnt(0)
    v_mfma_f32_16x16x32_bf16 v[168:171], v[56:59], v[176:179], v[168:171]
    s_waitcnt vmcnt(12)
    s_barrier
    ds_read_b128 a[0:3], v8 offset:40960
    v_cvt_pk_bf16_f32 v181, v150, v151
    v_mfma_f32_16x16x32_bf16 v[64:67], a[32:35], v[176:179], v[64:67]
    s_add_u32 m0, s57, 65536
    v_exp_f32 v156, v156
    v_mfma_f32_16x16x32_bf16 v[72:75], a[36:39], v[176:179], v[72:75]
    ds_read_b128 a[16:19], v8 offset:45056
    ds_read_b128 a[4:7], v9 offset:40960
    v_mfma_f32_16x16x32_bf16 v[80:83], a[40:43], v[176:179], v[80:83]
    v_exp_f32 v157, v157
    v_mfma_f32_16x16x32_bf16 v[88:91], a[44:47], v[176:179], v[88:91]
    ds_read_b128 a[20:23], v9 offset:45056
    v_cvt_pk_bf16_f32 v182, v156, v157
    v_mfma_f32_16x16x32_bf16 v[96:99], a[48:51], v[176:179], v[96:99]
    v_exp_f32 v158, v158
    v_mfma_f32_16x16x32_bf16 v[104:107], a[52:55], v[176:179], v[104:107]
    v_exp_f32 v159, v159
    v_mfma_f32_16x16x32_bf16 v[112:115], a[56:59], v[176:179], v[112:115]
    ds_read_b128 a[8:11], v10 offset:40960
    v_cvt_pk_bf16_f32 v183, v158, v159
    v_mfma_f32_16x16x32_bf16 v[120:123], a[60:63], v[176:179], v[120:123]
    ds_read_b128 a[24:27], v10 offset:45056
    v_max3_f32 v48, v128, v129, v130
    v_mfma_f32_16x16x32_bf16 v[172:175], v[56:59], v[180:183], v[172:175]
    ds_read_b128 a[12:15], v11 offset:40960
    v_max3_f32 v49, v132, v133, v134
    v_mfma_f32_16x16x32_bf16 v[68:71], a[32:35], v[180:183], v[68:71]
    ds_read_b128 a[28:31], v11 offset:45056
    v_max3_f32 v48, v48, v131, v136
    v_mfma_f32_16x16x32_bf16 v[76:79], a[36:39], v[180:183], v[76:79]
    ds_read_b64_tr_b16 a[32:33], v12 offset:32768
    v_max3_f32 v49, v49, v135, v140
    v_mfma_f32_16x16x32_bf16 v[84:87], a[40:43], v[180:183], v[84:87]
    ds_read_b64_tr_b16 a[34:35], v12 offset:36864
    buffer_load_dwordx4 v24, s[32:35], s65 offen offset:0 nt lds
    v_max3_f32 v48, v48, v137, v138
    v_mfma_f32_16x16x32_bf16 v[92:95], a[44:47], v[180:183], v[92:95]
    ds_read_b64_tr_b16 a[36:37], v13 offset:32768
    v_max3_f32 v49, v49, v141, v142
    v_mfma_f32_16x16x32_bf16 v[100:103], a[48:51], v[180:183], v[100:103]
    ds_read_b64_tr_b16 a[38:39], v13 offset:36864
    v_max_f32 v49, v49, v143
    v_mfma_f32_16x16x32_bf16 v[108:111], a[52:55], v[180:183], v[108:111]
    ds_read_b64_tr_b16 a[40:41], v14 offset:32768
    v_max3_f32 v48, v48, v139, v49
    v_mfma_f32_16x16x32_bf16 v[116:119], a[56:59], v[180:183], v[116:119]
    ds_read_b64_tr_b16 a[42:43], v14 offset:36864
    v_cmp_lt_f32 vcc, 0x41000000, v48
    v_mfma_f32_16x16x32_bf16 v[124:127], a[60:63], v[180:183], v[124:127]
    ds_read_b64_tr_b16 a[44:45], v15 offset:32768
    ds_read_b64_tr_b16 a[46:47], v15 offset:36864
    s_cbranch_vccnz L_rs_3_2
L_rsb_3_2:
    s_waitcnt lgkmcnt(7)
    v_mfma_f32_16x16x32_bf16 v[144:147], a[0:3], v[192:195], v[160:163]
    buffer_load_dwordx4 v25, s[32:35], s65 offen offset:1024 nt lds
    v_exp_f32 v128, v128
    v_mfma_f32_16x16x32_bf16 v[148:151], a[0:3], v[208:211], v[164:167]
    v_exp_f32 v129, v129
    v_mfma_f32_16x16x32_bf16 v[152:155], a[16:19], v[192:195], v[160:163]
    ds_read_b64_tr_b16 a[48:49], v16 offset:32768
    ds_read_b64_tr_b16 a[50:51], v16 offset:36864
    v_mfma_f32_16x16x32_bf16 v[156:159], a[16:19], v[208:211], v[164:167]
    v_exp_f32 v130, v130
    v_mfma_f32_16x16x32_bf16 v[144:147], a[4:7], v[196:199], v[144:147]
    v_exp_f32 v131, v131
    v_mfma_f32_16x16x32_bf16 v[148:151], a[4:7], v[212:215], v[148:151]
    ds_read_b64_tr_b16 a[52:53], v17 offset:32768
    ds_read_b64_tr_b16 a[54:55], v17 offset:36864
    v_cvt_pk_bf16_f32 v176, v128, v129
    v_mfma_f32_16x16x32_bf16 v[152:155], a[20:23], v[196:199], v[152:155]
    buffer_load_dwordx4 v26, s[32:35], s65 offen offset:2048 nt lds
    v_exp_f32 v136, v136
    v_mfma_f32_16x16x32_bf16 v[156:159], a[20:23], v[212:215], v[156:159]
    v_exp_f32 v137, v137
    v_mfma_f32_16x16x32_bf16 v[144:147], a[8:11], v[200:203], v[144:147]
    ds_read_b64_tr_b16 a[56:57], v18 offset:32768
    ds_read_b64_tr_b16 a[58:59], v18 offset:36864
    v_cvt_pk_bf16_f32 v177, v130, v131
    v_mfma_f32_16x16x32_bf16 v[148:151], a[8:11], v[216:219], v[148:151]
    v_exp_f32 v138, v138
    v_mfma_f32_16x16x32_bf16 v[152:155], a[24:27], v[200:203], v[152:155]
    v_exp_f32 v139, v139
    v_mfma_f32_16x16x32_bf16 v[156:159], a[24:27], v[216:219], v[156:159]
    ds_read_b64_tr_b16 a[60:61], v19 offset:32768
    ds_read_b64_tr_b16 a[62:63], v19 offset:36864
    v_cvt_pk_bf16_f32 v178, v136, v137
    v_mfma_f32_16x16x32_bf16 v[144:147], a[12:15], v[204:207], v[144:147]
    v_exp_f32 v132, v132
    v_cvt_pk_bf16_f32 v179, v138, v139
    v_mfma_f32_16x16x32_bf16 v[148:151], a[12:15], v[220:223], v[148:151]
    buffer_load_dwordx4 v27, s[32:35], s65 offen offset:3072 nt lds
    v_exp_f32 v133, v133
    v_mfma_f32_16x16x32_bf16 v[152:155], a[28:31], v[204:207], v[152:155]
    v_exp_f32 v134, v134
    v_mfma_f32_16x16x32_bf16 v[156:159], a[28:31], v[220:223], v[156:159]
    s_mov_b32 s65, s64
    v_exp_f32 v135, v135
    v_cvt_pk_bf16_f32 v180, v132, v133
    s_waitcnt lgkmcnt(0)
    v_mfma_f32_16x16x32_bf16 v[168:171], v[56:59], v[176:179], v[168:171]
    s_waitcnt vmcnt(12)
    s_barrier
    ds_read_b128 a[0:3], v8 offset:0
    v_cvt_pk_bf16_f32 v181, v134, v135
    v_mfma_f32_16x16x32_bf16 v[64:67], a[32:35], v[176:179], v[64:67]
    s_add_u32 m0, s57, 32768
    v_exp_f32 v140, v140
    v_mfma_f32_16x16x32_bf16 v[72:75], a[36:39], v[176:179], v[72:75]
    ds_read_b128 a[16:19], v8 offset:4096
    ds_read_b128 a[4:7], v9 offset:0
    v_mfma_f32_16x16x32_bf16 v[80:83], a[40:43], v[176:179], v[80:83]
    v_exp_f32 v141, v141
    v_mfma_f32_16x16x32_bf16 v[88:91], a[44:47], v[176:179], v[88:91]
    ds_read_b128 a[20:23], v9 offset:4096
    v_cvt_pk_bf16_f32 v182, v140, v141
    v_mfma_f32_16x16x32_bf16 v[96:99], a[48:51], v[176:179], v[96:99]
    v_exp_f32 v142, v142
    v_mfma_f32_16x16x32_bf16 v[104:107], a[52:55], v[176:179], v[104:107]
    v_exp_f32 v143, v143
    v_mfma_f32_16x16x32_bf16 v[112:115], a[56:59], v[176:179], v[112:115]
    ds_read_b128 a[8:11], v10 offset:0
    v_cvt_pk_bf16_f32 v183, v142, v143
    v_mfma_f32_16x16x32_bf16 v[120:123], a[60:63], v[176:179], v[120:123]
    ds_read_b128 a[24:27], v10 offset:4096
    v_max3_f32 v48, v144, v145, v146
    v_mfma_f32_16x16x32_bf16 v[172:175], v[56:59], v[180:183], v[172:175]
    ds_read_b128 a[12:15], v11 offset:0
    v_max3_f32 v49, v148, v149, v150
    v_mfma_f32_16x16x32_bf16 v[68:71], a[32:35], v[180:183], v[68:71]
    ds_read_b128 a[28:31], v11 offset:4096
    v_max3_f32 v48, v48, v147, v152
    v_mfma_f32_16x16x32_bf16 v[76:79], a[36:39], v[180:183], v[76:79]
    ds_read_b64_tr_b16 a[32:33], v12 offset:40960
    v_max3_f32 v49, v49, v151, v156
    v_mfma_f32_16x16x32_bf16 v[84:87], a[40:43], v[180:183], v[84:87]
    ds_read_b64_tr_b16 a[34:35], v12 offset:45056
    buffer_load_dwordx4 v20, s[28:31], s64 offen offset:0 nt lds
    v_max3_f32 v48, v48, v153, v154
    v_mfma_f32_16x16x32_bf16 v[92:95], a[44:47], v[180:183], v[92:95]
    ds_read_b64_tr_b16 a[36:37], v13 offset:40960
    v_max3_f32 v49, v49, v157, v158
    v_mfma_f32_16x16x32_bf16 v[100:103], a[48:51], v[180:183], v[100:103]
    ds_read_b64_tr_b16 a[38:39], v13 offset:45056
    v_max_f32 v49, v49, v159
    v_mfma_f32_16x16x32_bf16 v[108:111], a[52:55], v[180:183], v[108:111]
    ds_read_b64_tr_b16 a[40:41], v14 offset:40960
    v_max3_f32 v48, v48, v155, v49
    v_mfma_f32_16x16x32_bf16 v[116:119], a[56:59], v[180:183], v[116:119]
    ds_read_b64_tr_b16 a[42:43], v14 offset:45056
    v_cmp_lt_f32 vcc, 0x41000000, v48
    v_mfma_f32_16x16x32_bf16 v[124:127], a[60:63], v[180:183], v[124:127]
    ds_read_b64_tr_b16 a[44:45], v15 offset:40960
    ds_read_b64_tr_b16 a[46:47], v15 offset:45056
    s_cbranch_vccnz L_rs_4_2
L_rsb_4_2:
    s_waitcnt lgkmcnt(7)
    v_mfma_f32_16x16x32_bf16 v[128:131], a[0:3], v[192:195], v[160:163]
    buffer_load_dwordx4 v21, s[28:31], s64 offen offset:1024 nt lds
    v_exp_f32 v144, v144
    v_mfma_f32_16x16x32_bf16 v[132:135], a[0:3], v[208:211], v[164:167]
    v_exp_f32 v145, v145
    v_mfma_f32_16x16x32_bf16 v[136:139], a[16:19], v[192:195], v[160:163]
    ds_read_b64_tr_b16 a[48:49], v16 offset:40960
    ds_read_b64_tr_b16 a[50:51], v16 offset:45056
    v_mfma_f32_16x16x32_bf16 v[140:143], a[16:19], v[208:211], v[164:167]
    v_exp_f32 v146, v146
    v_mfma_f32_16x16x32_bf16 v[128:131], a[4:7], v[196:199], v[128:131]
    v_exp_f32 v147, v147
    v_mfma_f32_16x16x32_bf16 v[132:135], a[4:7], v[212:215], v[132:135]
    ds_read_b64_tr_b16 a[52:53], v17 offset:40960
    ds_read_b64_tr_b16 a[54:55], v17 offset:45056
    v_cvt_pk_bf16_f32 v176, v144, v145
    v_mfma_f32_16x16x32_bf16 v[136:139], a[20:23], v[196:199], v[136:139]
    buffer_load_dwordx4 v22, s[28:31], s64 offen offset:2048 nt lds
    v_exp_f32 v152, v152
    v_mfma_f32_16x16x32_bf16 v[140:143], a[20:23], v[212:215], v[140:143]
    v_exp_f32 v153, v153
    v_mfma_f32_16x16x32_bf16 v[128:131], a[8:11], v[200:203], v[128:131]
    ds_read_b64_tr_b16 a[56:57], v18 offset:40960
    ds_read_b64_tr_b16 a[58:59], v18 offset:45056
    v_cvt_pk_bf16_f32 v177, v146, v147
    v_mfma_f32_16x16x32_bf16 v[132:135], a[8:11], v[216:219], v[132:135]
    v_exp_f32 v154, v154
    v_mfma_f32_16x16x32_bf16 v[136:139], a[24:27], v[200:203], v[136:139]
    v_exp_f32 v155, v155
    v_mfma_f32_16x16x32_bf16 v[140:143], a[24:27], v[216:219], v[140:143]
    ds_read_b64_tr_b16 a[60:61], v19 offset:40960
    ds_read_b64_tr_b16 a[62:63], v19 offset:45056
    v_cvt_pk_bf16_f32 v178, v152, v153
    v_mfma_f32_16x16x32_bf16 v[128:131], a[12:15], v[204:207], v[128:131]
    v_exp_f32 v148, v148
    v_cvt_pk_bf16_f32 v179, v154, v155
    v_mfma_f32_16x16x32_bf16 v[132:135], a[12:15], v[220:223], v[132:135]
    buffer_load_dwordx4 v23, s[28:31], s64 offen offset:3072 nt lds
    v_exp_f32 v149, v149
    v_mfma_f32_16x16x32_bf16 v[136:139], a[28:31], v[204:207], v[136:139]
    v_exp_f32 v150, v150
    v_mfma_f32_16x16x32_bf16 v[140:143], a[28:31], v[220:223], v[140:143]
    s_add_u32 s64, s64, 16384
    v_exp_f32 v151, v151
    v_cvt_pk_bf16_f32 v180, v148, v149
    s_waitcnt lgkmcnt(0)
    v_mfma_f32_16x16x32_bf16 v[168:171], v[56:59], v[176:179], v[168:171]
    s_waitcnt vmcnt(12)
    s_barrier
    ds_read_b128 a[0:3], v8 offset:8192
    v_cvt_pk_bf16_f32 v181, v150, v151
    v_mfma_f32_16x16x32_bf16 v[64:67], a[32:35], v[176:179], v[64:67]
    s_add_u32 m0, s57, 81920
    v_exp_f32 v156, v156
    v_mfma_f32_16x16x32_bf16 v[72:75], a[36:39], v[176:179], v[72:75]
    ds_read_b128 a[16:19], v8 offset:12288
    ds_read_b128 a[4:7], v9 offset:8192
    v_mfma_f32_16x16x32_bf16 v[80:83], a[40:43], v[176:179], v[80:83]
    v_exp_f32 v157, v157
    v_mfma_f32_16x16x32_bf16 v[88:91], a[44:47], v[176:179], v[88:91]
    ds_read_b128 a[20:23], v9 offset:12288
    v_cvt_pk_bf16_f32 v182, v156, v157
    v_mfma_f32_16x16x32_bf16 v[96:99], a[48:51], v[176:179], v[96:99]
    v_exp_f32 v158, v158
    v_mfma_f32_16x16x32_bf16 v[104:107], a[52:55], v[176:179], v[104:107]
    v_exp_f32 v159, v159
    v_mfma_f32_16x16x32_bf16 v[112:115], a[56:59], v[176:179], v[112:115]
    ds_read_b128 a[8:11], v10 offset:8192
    v_cvt_pk_bf16_f32 v183, v158, v159
    v_mfma_f32_16x16x32_bf16 v[120:123], a[60:63], v[176:179], v[120:123]
    ds_read_b128 a[24:27], v10 offset:12288
    v_max3_f32 v48, v128, v129, v130
    v_mfma_f32_16x16x32_bf16 v[172:175], v[56:59], v[180:183], v[172:175]
    ds_read_b128 a[12:15], v11 offset:8192
    v_max3_f32 v49, v132, v133, v134
    v_mfma_f32_16x16x32_bf16 v[68:71], a[32:35], v[180:183], v[68:71]
    ds_read_b128 a[28:31], v11 offset:12288
    v_max3_f32 v48, v48, v131, v136
    v_mfma_f32_16x16x32_bf16 v[76:79], a[36:39], v[180:183], v[76:79]
    ds_read_b64_tr_b16 a[32:33], v12 offset:0
    v_max3_f32 v49, v49, v135, v140
    v_mfma_f32_16x16x32_bf16 v[84:87], a[40:43], v[180:183], v[84:87]
    ds_read_b64_tr_b16 a[34:35], v12 offset:4096
    buffer_load_dwordx4 v24, s[32:35], s65 offen offset:0 nt lds
    v_max3_f32 v48, v48, v137, v138
    v_mfma_f32_16x16x32_bf16 v[92:95], a[44:47], v[180:183], v[92:95]
    ds_read_b64_tr_b16 a[36:37], v13 offset:0
    v_max3_f32 v49, v49, v141, v142
    v_mfma_f32_16x16x32_bf16 v[100:103], a[48:51], v[180:183], v[100:103]
    ds_read_b64_tr_b16 a[38:39], v13 offset:4096
    v_max_f32 v49, v49, v143
    v_mfma_f32_16x16x32_bf16 v[108:111], a[52:55], v[180:183], v[108:111]
    ds_read_b64_tr_b16 a[40:41], v14 offset:0
    v_max3_f32 v48, v48, v139, v49
    v_mfma_f32_16x16x32_bf16 v[116:119], a[56:59], v[180:183], v[116:119]
    ds_read_b64_tr_b16 a[42:43], v14 offset:4096
    v_cmp_lt_f32 vcc, 0x41000000, v48
    v_mfma_f32_16x16x32_bf16 v[124:127], a[60:63], v[180:183], v[124:127]
    ds_read_b64_tr_b16 a[44:45], v15 offset:0
    ds_read_b64_tr_b16 a[46:47], v15 offset:4096
    s_cbranch_vccnz L_rs_5_2
L_rsb_5_2:
    s_waitcnt lgkmcnt(7)
    v_mfma_f32_16x16x32_bf16 v[144:147], a[0:3], v[192:195], v[160:163]
    buffer_load_dwordx4 v25, s[32:35], s65 offen offset:1024 nt lds
    v_exp_f32 v128, v128
    v_mfma_f32_16x16x32_bf16 v[148:151], a[0:3], v[208:211], v[164:167]
    v_exp_f32 v129, v129
    v_mfma_f32_16x16x32_bf16 v[152:155], a[16:19], v[192:195], v[160:163]
    ds_read_b64_tr_b16 a[48:49], v16 offset:0
    ds_read_b64_tr_b16 a[50:51], v16 offset:4096
    v_mfma_f32_16x16x32_bf16 v[156:159], a[16:19], v[208:211], v[164:167]
    v_exp_f32 v130, v130
    v_mfma_f32_16x16x32_bf16 v[144:147], a[4:7], v[196:199], v[144:147]
    v_exp_f32 v131, v131
    v_mfma_f32_16x16x32_bf16 v[148:151], a[4:7], v[212:215], v[148:151]
    ds_read_b64_tr_b16 a[52:53], v17 offset:0
    ds_read_b64_tr_b16 a[54:55], v17 offset:4096
    v_cvt_pk_bf16_f32 v176, v128, v129
    v_mfma_f32_16x16x32_bf16 v[152:155], a[20:23], v[196:199], v[152:155]
    buffer_load_dwordx4 v26, s[32:35], s65 offen offset:2048 nt lds
    v_exp_f32 v136, v136
    v_mfma_f32_16x16x32_bf16 v[156:159], a[20:23], v[212:215], v[156:159]
    v_exp_f32 v137, v137
    v_mfma_f32_16x16x32_bf16 v[144:147], a[8:11], v[200:203], v[144:147]
    ds_read_b64_tr_b16 a[56:57], v18 offset:0
    ds_read_b64_tr_b16 a[58:59], v18 offset:4096
    v_cvt_pk_bf16_f32 v177, v130, v131
    v_mfma_f32_16x16x32_bf16 v[148:151], a[8:11], v[216:219], v[148:151]
    v_exp_f32 v138, v138
    v_mfma_f32_16x16x32_bf16 v[152:155], a[24:27], v[200:203], v[152:155]
    v_exp_f32 v139, v139
    v_mfma_f32_16x16x32_bf16 v[156:159], a[24:27], v[216:219], v[156:159]
    ds_read_b64_tr_b16 a[60:61], v19 offset:0
    ds_read_b64_tr_b16 a[62:63], v19 offset:4096
    v_cvt_pk_bf16_f32 v178, v136, v137
    v_mfma_f32_16x16x32_bf16 v[144:147], a[12:15], v[204:207], v[144:147]
    v_exp_f32 v132, v132
    v_cvt_pk_bf16_f32 v179, v138, v139
    v_mfma_f32_16x16x32_bf16 v[148:151], a[12:15], v[220:223], v[148:151]
    buffer_load_dwordx4 v27, s[32:35], s65 offen offset:3072 nt lds
    v_exp_f32 v133, v133
    v_mfma_f32_16x16x32_bf16 v[152:155], a[28:31], v[204:207], v[152:155]
    v_exp_f32 v134, v134
    v_mfma_f32_16x16x32_bf16 v[156:159], a[28:31], v[220:223], v[156:159]
    s_mov_b32 s65, s64
    s_add_u32 s59, s59, 1
    s_cmp_lt_u32 s59, 4
    v_exp_f32 v135, v135
    v_cvt_pk_bf16_f32 v180, v132, v133
    s_cbranch_scc1 L_a_2
    s_branch L_last_2
L_one:
    s_waitcnt vmcnt(16)
    s_barrier
    ds_read_b128 a[64:67], v144 offset:0
    ds_read_b64_tr_b16 a[0:1], v128 offset:0
    ds_read_b64_tr_b16 a[2:3], v128 offset:1024
    ds_read_b64_tr_b16 a[4:5], v129 offset:0
    ds_read_b64_tr_b16 a[6:7], v129 offset:1024
    ds_read_b64_tr_b16 a[8:9], v130 offset:0
    ds_read_b64_tr_b16 a[10:11], v130 offset:1024
    ds_read_b64_tr_b16 a[12:13], v131 offset:0
    ds_read_b64_tr_b16 a[14:15], v131 offset:1024
    ds_read_b64_tr_b16 a[16:17], v132 offset:0
    ds_read_b64_tr_b16 a[18:19], v132 offset:1024
    ds_read_b64_tr_b16 a[20:21], v133 offset:0
    ds_read_b64_tr_b16 a[22:23], v133 offset:1024
    ds_read_b64_tr_b16 a[24:25], v134 offset:0
    ds_read_b64_tr_b16 a[26:27], v134 offset:1024
    ds_read_b64_tr_b16 a[28:29], v135 offset:0
    ds_read_b64_tr_b16 a[30:31], v135 offset:1024
    s_waitcnt lgkmcnt(14)
    v_mfma_f32_16x16x32_bf16 v[160:163], a[0:3], a[64:67], 0
    ds_read_b128 a[72:75], v145 offset:0
    ds_read_b64_tr_b16 a[32:33], v128 offset:8192
    ds_read_b64_tr_b16 a[34:35], v128 offset:9216
    s_waitcnt lgkmcnt(15)
    v_mfma_f32_16x16x32_bf16 v[168:171], a[4:7], a[64:67], 0
    ds_read_b64_tr_b16 a[36:37], v129 offset:8192
    ds_read_b64_tr_b16 a[38:39], v129 offset:9216
    s_add_u32 m0, s57, 131072
    s_lshl_b32 s4, s58, 7
    s_lshl_b32 s5, s58, 19
    buffer_load_dwordx4 v28, s[20:23], s4 offen offset:0  lds
    s_waitcnt lgkmcnt(13)
    v_mfma_f32_16x16x32_bf16 v[176:179], a[8:11], a[64:67], 0
    ds_read_b64_tr_b16 a[40:41], v130 offset:8192
    ds_read_b64_tr_b16 a[42:43], v130 offset:9216
    buffer_load_dwordx4 v29, s[20:23], s4 offen offset:1024  lds
    v_mfma_f32_16x16x32_bf16 v[148:151], a[12:15], a[64:67], 0
    ds_read_b64_tr_b16 a[44:45], v131 offset:8192
    ds_read_b64_tr_b16 a[46:47], v131 offset:9216
    s_add_u32 m0, s57, 147456
    s_add_u32 s58, s58, 1
    s_and_b32 s58, s58, 7
    s_waitcnt lgkmcnt(8)
    v_mfma_f32_16x16x32_bf16 v[224:227], a[16:19], a[64:67], 0
    ds_read_b64_tr_b16 a[48:49], v132 offset:8192
    ds_read_b64_tr_b16 a[50:51], v132 offset:9216
    buffer_load_dwordx4 v32, s[24:27], s5 offen offset:0  lds
    v_mfma_f32_16x16x32_bf16 v[232:235], a[20:23], a[64:67], 0
    ds_read_b64_tr_b16 a[52:53], v133 offset:8192
    ds_read_b64_tr_b16 a[54:55], v133 offset:9216
    buffer_load_dwordx4 v33, s[24:27], s5 offen offset:1024  lds
    v_mfma_f32_16x16x32_bf16 v[240:243], a[24:27], a[64:67], 0
    ds_read_b64_tr_b16 a[56:57], v134 offset:8192
    ds_read_b64_tr_b16 a[58:59], v134 offset:9216
    buffer_load_dwordx4 v34, s[24:27], s5 offen offset:2048  lds
    v_mfma_f32_16x16x32_bf16 v[248:251], a[28:31], a[64:67], 0
    ds_read_b64_tr_b16 a[60:61], v135 offset:8192
    ds_read_b64_tr_b16 a[62:63], v135 offset:9216
    buffer_load_dwordx4 v35, s[24:27], s5 offen offset:3072  lds
    s_waitcnt lgkmcnt(0)
    v_mfma_f32_16x16x32_bf16 v[160:163], a[32:35], a[72:75], v[160:163]
    s_waitcnt vmcnt(14)
    s_barrier
    ds_read_b128 a[64:67], v144 offset:16384
    ds_read_b64_tr_b16 a[0:1], v128 offset:16384
    ds_read_b64_tr_b16 a[2:3], v128 offset:17408
    v_add_u32 v12, 49152, v12
    v_xor_b32 v13, 32, v12
    v_mfma_f32_16x16x32_bf16 v[168:171], a[36:39], a[72:75], v[168:171]
    ds_read_b64_tr_b16 a[4:5], v129 offset:16384
    ds_read_b64_tr_b16 a[6:7], v129 offset:17408
    s_add_u32 m0, s57, 16384
    s_lshl_b32 s4, s58, 7
    s_lshl_b32 s5, s58, 19
    v_xor_b32 v14, 64, v12
    v_xor_b32 v15, 96, v12
    v_mfma_f32_16x16x32_bf16 v[176:179], a[40:43], a[72:75], v[176:179]
    ds_read_b64_tr_b16 a[8:9], v130 offset:16384
    ds_read_b64_tr_b16 a[10:11], v130 offset:17408
    buffer_load_dwordx4 v28, s[20:23], s4 offen offset:0  lds
    v_xor_b32 v16, 128, v12
    v_xor_b32 v17, 160, v12
    v_mfma_f32_16x16x32_bf16 v[148:151], a[44:47], a[72:75], v[148:151]
    ds_read_b64_tr_b16 a[12:13], v131 offset:16384
    ds_read_b64_tr_b16 a[14:15], v131 offset:17408
    v_xor_b32 v18, 192, v12
    v_xor_b32 v19, 224, v12
    v_mfma_f32_16x16x32_bf16 v[224:227], a[48:51], a[72:75], v[224:227]
    ds_read_b64_tr_b16 a[16:17], v132 offset:16384
    ds_read_b64_tr_b16 a[18:19], v132 offset:17408
    buffer_load_dwordx4 v29, s[20:23], s4 offen offset:1024  lds
    v_xor_b32 v6, v2, v3
    v_lshlrev_b32 v6, 4, v6
    v_mfma_f32_16x16x32_bf16 v[232:235], a[52:55], a[72:75], v[232:235]
    ds_read_b64_tr_b16 a[20:21], v133 offset:16384
    ds_read_b64_tr_b16 a[22:23], v133 offset:17408
    v_lshl_add_u32 v8, v3, 8, v6
    v_xor_b32 v9, 64, v8
    v_mfma_f32_16x16x32_bf16 v[240:243], a[56:59], a[72:75], v[240:243]
    ds_read_b64_tr_b16 a[24:25], v134 offset:16384
    ds_read_b64_tr_b16 a[26:27], v134 offset:17408
    s_add_u32 m0, s57, 65536
    s_add_u32 s58, s58, 1
    s_and_b32 s58, s58, 7
    v_xor_b32 v10, 128, v8
    v_xor_b32 v11, 192, v8
    v_mfma_f32_16x16x32_bf16 v[248:251], a[60:63], a[72:75], v[248:251]
    ds_read_b64_tr_b16 a[28:29], v135 offset:16384
    ds_read_b64_tr_b16 a[30:31], v135 offset:17408
    v_lshlrev_b32 v6, 1, v2
    v_xor_b32 v6, v6, v7
    s_waitcnt lgkmcnt(6)
    v_mfma_f32_16x16x32_bf16 v[160:163], a[0:3], a[64:67], v[160:163]
    ds_read_b128 a[72:75], v145 offset:16384
    ds_read_b64_tr_b16 a[32:33], v128 offset:24576
    ds_read_b64_tr_b16 a[34:35], v128 offset:25600
    buffer_load_dwordx4 v32, s[24:27], s5 offen offset:0  lds
    v_lshlrev_b32 v6, 4, v6
    v_lshl_add_u32 v36, v5, 10, v6
    v_mfma_f32_16x16x32_bf16 v[168:171], a[4:7], a[64:67], v[168:171]
    ds_read_b64_tr_b16 a[36:37], v129 offset:24576
    ds_read_b64_tr_b16 a[38:39], v129 offset:25600
    v_add_u32 v37, 7168, v36
    v_add_u32 v38, 14336, v36
    v_mfma_f32_16x16x32_bf16 v[176:179], a[8:11], a[64:67], v[176:179]
    ds_read_b64_tr_b16 a[40:41], v130 offset:24576
    ds_read_b64_tr_b16 a[42:43], v130 offset:25600
    buffer_load_dwordx4 v33, s[24:27], s5 offen offset:1024  lds
    v_add_u32 v39, 21504, v36
    v_and_b32 v6, 1, v2
    v_mfma_f32_16x16x32_bf16 v[148:151], a[12:15], a[64:67], v[148:151]
    ds_read_b64_tr_b16 a[44:45], v131 offset:24576
    ds_read_b64_tr_b16 a[46:47], v131 offset:25600
    v_lshlrev_b32 v6, 1, v6
    v_lshrrev_b32 v4, 1, v60
    v_mfma_f32_16x16x32_bf16 v[224:227], a[16:19], a[64:67], v[224:227]
    ds_read_b64_tr_b16 a[48:49], v132 offset:24576
    ds_read_b64_tr_b16 a[50:51], v132 offset:25600
    buffer_load_dwordx4 v34, s[24:27], s5 offen offset:2048  lds
    v_or_b32 v6, v6, v4
    v_xor_b32 v6, s56, v6
    s_waitcnt lgkmcnt(6)
    v_mfma_f32_16x16x32_bf16 v[232:235], a[20:23], a[64:67], v[232:235]
    ds_read_b64_tr_b16 a[52:53], v133 offset:24576
    ds_read_b64_tr_b16 a[54:55], v133 offset:25600
    v_lshlrev_b32 v6, 5, v6
    v_lshl_add_u32 v6, v61, 3, v6
    v_mfma_f32_16x16x32_bf16 v[240:243], a[24:27], a[64:67], v[240:243]
    ds_read_b64_tr_b16 a[56:57], v134 offset:24576
    ds_read_b64_tr_b16 a[58:59], v134 offset:25600
    buffer_load_dwordx4 v35, s[24:27], s5 offen offset:3072  lds
    v_lshl_add_u32 v6, v60, 7, v6
    v_lshl_add_u32 v40, v2, 9, v6
    v_mfma_f32_16x16x32_bf16 v[248:251], a[28:31], a[64:67], v[248:251]
    ds_read_b64_tr_b16 a[60:61], v135 offset:24576
    ds_read_b64_tr_b16 a[62:63], v135 offset:25600
    v_xor_b32 v41, 32, v40
    v_xor_b32 v42, 64, v40
    s_waitcnt lgkmcnt(0)
    v_mfma_f32_16x16x32_bf16 v[160:163], a[32:35], a[72:75], v[160:163]
    s_waitcnt vmcnt(12)
    s_barrier
    ds_read_b128 a[64:67], v146 offset:0
    ds_read_b64_tr_b16 a[0:1], v136 offset:0
    ds_read_b64_tr_b16 a[2:3], v136 offset:1024
    v_xor_b32 v43, 96, v40
    v_and_b32 v6, 1, v2
    v_mfma_f32_16x16x32_bf16 v[168:171], a[36:39], a[72:75], v[168:171]
    ds_read_b64_tr_b16 a[4:5], v137 offset:0
    ds_read_b64_tr_b16 a[6:7], v137 offset:1024
    s_add_u32 m0, s57, 32768
    s_lshl_b32 s4, s58, 7
    s_lshl_b32 s5, s58, 19
    v_lshl_add_u32 v6, v6, 4, v3
    v_lshlrev_b32 v6, 10, v6
    v_mfma_f32_16x16x32_bf16 v[176:179], a[40:43], a[72:75], v[176:179]
    ds_read_b64_tr_b16 a[8:9], v138 offset:0
    ds_read_b64_tr_b16 a[10:11], v138 offset:1024
    buffer_load_dwordx4 v28, s[20:23], s4 offen offset:0  lds
    v_lshl_add_u32 v6, s52, 15, v6
    v_add_u32 v6, s68, v6
    v_mfma_f32_16x16x32_bf16 v[148:151], a[44:47], a[72:75], v[148:151]
    ds_read_b64_tr_b16 a[12:13], v139 offset:0
    ds_read_b64_tr_b16 a[14:15], v139 offset:1024
    v_lshl_add_u32 v6, s56, 5, v6
    v_lshrrev_b32 v4, 1, v2
    v_mfma_f32_16x16x32_bf16 v[224:227], a[48:51], a[72:75], v[224:227]
    ds_read_b64_tr_b16 a[16:17], v140 offset:0
    ds_read_b64_tr_b16 a[18:19], v140 offset:1024
    buffer_load_dwordx4 v29, s[20:23], s4 offen offset:1024  lds
    v_lshl_add_u32 v54, v4, 4, v6
    v_lshlrev_b32 v53, 4, v0
    v_mfma_f32_16x16x32_bf16 v[232:235], a[52:55], a[72:75], v[232:235]
    ds_read_b64_tr_b16 a[20:21], v141 offset:0
    ds_read_b64_tr_b16 a[22:23], v141 offset:1024
    v_mov_b32 v56, 0x3f803f80
    v_mov_b32 v57, 0x3f803f80
    v_mfma_f32_16x16x32_bf16 v[240:243], a[56:59], a[72:75], v[240:243]
    ds_read_b64_tr_b16 a[24:25], v142 offset:0
    ds_read_b64_tr_b16 a[26:27], v142 offset:1024
    s_add_u32 m0, s57, 81920
    s_add_u32 s58, s58, 1
    s_and_b32 s58, s58, 7
    v_mov_b32 v58, 0x3f803f80
    v_mov_b32 v59, 0x3f803f80
    v_mfma_f32_16x16x32_bf16 v[248:251], a[60:63], a[72:75], v[248:251]
    ds_read_b64_tr_b16 a[28:29], v143 offset:0
    ds_read_b64_tr_b16 a[30:31], v143 offset:1024
    v_mov_b32 v64, 0
    v_mov_b32 v65, 0
    s_waitcnt lgkmcnt(6)
    v_mfma_f32_16x16x32_bf16 v[160:163], a[0:3], a[64:67], v[160:163]
    ds_read_b128 a[72:75], v147 offset:0
    ds_read_b64_tr_b16 a[32:33], v136 offset:8192
    ds_read_b64_tr_b16 a[34:35], v136 offset:9216
    buffer_load_dwordx4 v32, s[24:27], s5 offen offset:0  lds
    v_mov_b32 v66, 0
    v_mov_b32 v67, 0
    v_mfma_f32_16x16x32_bf16 v[168:171], a[4:7], a[64:67], v[168:171]
    ds_read_b64_tr_b16 a[36:37], v137 offset:8192
    ds_read_b64_tr_b16 a[38:39], v137 offset:9216
    v_mov_b32 v72, 0
    v_mov_b32 v73, 0
    v_mfma_f32_16x16x32_bf16 v[176:179], a[8:11], a[64:67], v[176:179]
    ds_read_b64_tr_b16 a[40:41], v138 offset:8192
    ds_read_b64_tr_b16 a[42:43], v138 offset:9216
    buffer_load_dwordx4 v33, s[24:27], s5 offen offset:1024  lds
    v_mov_b32 v74, 0
    v_mov_b32 v75, 0
    v_mfma_f32_16x16x32_bf16 v[148:151], a[12:15], a[64:67], v[148:151]
    ds_read_b64_tr_b16 a[44:45], v139 offset:8192
    ds_read_b64_tr_b16 a[46:47], v139 offset:9216
    v_mov_b32 v80, 0
    v_mov_b32 v81, 0
    v_mfma_f32_16x16x32_bf16 v[224:227], a[16:19], a[64:67], v[224:227]
    ds_read_b64_tr_b16 a[48:49], v140 offset:8192
    ds_read_b64_tr_b16 a[50:51], v140 offset:9216
    buffer_load_dwordx4 v34, s[24:27], s5 offen offset:2048  lds
    v_mov_b32 v82, 0
    v_mov_b32 v83, 0
    s_waitcnt lgkmcnt(6)
    v_mfma_f32_16x16x32_bf16 v[232:235], a[20:23], a[64:67], v[232:235]
    ds_read_b64_tr_b16 a[52:53], v141 offset:8192
    ds_read_b64_tr_b16 a[54:55], v141 offset:9216
    v_mov_b32 v88, 0
    v_mov_b32 v89, 0
    v_mfma_f32_16x16x32_bf16 v[240:243], a[24:27], a[64:67], v[240:243]
    ds_read_b64_tr_b16 a[56:57], v142 offset:8192
    ds_read_b64_tr_b16 a[58:59], v142 offset:9216
    buffer_load_dwordx4 v35, s[24:27], s5 offen offset:3072  lds
    v_mov_b32 v90, 0
    v_mov_b32 v91, 0
    v_mfma_f32_16x16x32_bf16 v[248:251], a[28:31], a[64:67], v[248:251]
    ds_read_b64_tr_b16 a[60:61], v143 offset:8192
    ds_read_b64_tr_b16 a[62:63], v143 offset:9216
    v_mov_b32 v96, 0
    v_mov_b32 v97, 0
    s_waitcnt lgkmcnt(0)
    v_mfma_f32_16x16x32_bf16 v[160:163], a[32:35], a[72:75], v[160:163]
    s_waitcnt vmcnt(12)
    s_barrier
    ds_read_b128 a[64:67], v146 offset:32768
    ds_read_b64_tr_b16 a[0:1], v136 offset:32768
    ds_read_b64_tr_b16 a[2:3], v136 offset:33792
    v_mov_b32 v98, 0
    v_mov_b32 v99, 0
    v_mfma_f32_16x16x32_bf16 v[168:171], a[36:39], a[72:75], v[168:171]
    ds_read_b64_tr_b16 a[4:5], v137 offset:32768
    ds_read_b64_tr_b16 a[6:7], v137 offset:33792
    s_add_u32 m0, s57, 98304
    s_lshl_b32 s4, s58, 7
    s_lshl_b32 s5, s58, 19
    v_mov_b32 v104, 0
    v_mov_b32 v105, 0
    v_mfma_f32_16x16x32_bf16 v[176:179], a[40:43], a[72:75], v[176:179]
    ds_read_b64_tr_b16 a[8:9], v138 offset:32768
    ds_read_b64_tr_b16 a[10:11], v138 offset:33792
    buffer_load_dwordx4 v28, s[20:23], s4 offen offset:0  lds
    v_mov_b32 v106, 0
    v_mov_b32 v107, 0
    v_mfma_f32_16x16x32_bf16 v[148:151], a[44:47], a[72:75], v[148:151]
    ds_read_b64_tr_b16 a[12:13], v139 offset:32768
    ds_read_b64_tr_b16 a[14:15], v139 offset:33792
    v_mov_b32 v112, 0
    v_mov_b32 v113, 0
    v_mfma_f32_16x16x32_bf16 v[224:227], a[48:51], a[72:75], v[224:227]
    ds_read_b64_tr_b16 a[16:17], v140 offset:32768
    ds_read_b64_tr_b16 a[18:19], v140 offset:33792
    buffer_load_dwordx4 v29, s[20:23], s4 offen offset:1024  lds
    v_mov_b32 v114, 0
    v_mov_b32 v115, 0
    v_mfma_f32_16x16x32_bf16 v[232:235], a[52:55], a[72:75], v[232:235]
    ds_read_b64_tr_b16 a[20:21], v141 offset:32768
    ds_read_b64_tr_b16 a[22:23], v141 offset:33792
    v_mov_b32 v120, 0
    v_mov_b32 v121, 0
    v_mfma_f32_16x16x32_bf16 v[240:243], a[56:59], a[72:75], v[240:243]
    ds_read_b64_tr_b16 a[24:25], v142 offset:32768
    ds_read_b64_tr_b16 a[26:27], v142 offset:33792
    s_add_u32 m0, s57, 114688
    s_add_u32 s58, s58, 1
    s_and_b32 s58, s58, 7
    v_mov_b32 v122, 0
    v_mov_b32 v123, 0
    v_mfma_f32_16x16x32_bf16 v[248:251], a[60:63], a[72:75], v[248:251]
    ds_read_b64_tr_b16 a[28:29], v143 offset:32768
    ds_read_b64_tr_b16 a[30:31], v143 offset:33792
    s_waitcnt lgkmcnt(6)
    v_mfma_f32_16x16x32_bf16 v[160:163], a[0:3], a[64:67], v[160:163]
    ds_read_b128 a[72:75], v147 offset:32768
    ds_read_b64_tr_b16 a[32:33], v136 offset:40960
    ds_read_b64_tr_b16 a[34:35], v136 offset:41984
    buffer_load_dwordx4 v32, s[24:27], s5 offen offset:0  lds
    v_mfma_f32_16x16x32_bf16 v[168:171], a[4:7], a[64:67], v[168:171]
    ds_read_b64_tr_b16 a[36:37], v137 offset:40960
    ds_read_b64_tr_b16 a[38:39], v137 offset:41984
    v_mfma_f32_16x16x32_bf16 v[176:179], a[8:11], a[64:67], v[176:179]
    ds_read_b64_tr_b16 a[40:41], v138 offset:40960
    ds_read_b64_tr_b16 a[42:43], v138 offset:41984
    buffer_load_dwordx4 v33, s[24:27], s5 offen offset:1024  lds
    v_mfma_f32_16x16x32_bf16 v[148:151], a[12:15], a[64:67], v[148:151]
    ds_read_b64_tr_b16 a[44:45], v139 offset:40960
    ds_read_b64_tr_b16 a[46:47], v139 offset:41984
    v_mfma_f32_16x16x32_bf16 v[224:227], a[16:19], a[64:67], v[224:227]
    ds_read_b64_tr_b16 a[48:49], v140 offset:40960
    ds_read_b64_tr_b16 a[50:51], v140 offset:41984
    buffer_load_dwordx4 v34, s[24:27], s5 offen offset:2048  lds
    s_waitcnt lgkmcnt(11)
    v_mfma_f32_16x16x32_bf16 v[232:235], a[20:23], a[64:67], v[232:235]
    ds_read_b64_tr_b16 a[52:53], v141 offset:40960
    ds_read_b64_tr_b16 a[54:55], v141 offset:41984
    v_mfma_f32_16x16x32_bf16 v[240:243], a[24:27], a[64:67], v[240:243]
    ds_read_b64_tr_b16 a[56:57], v142 offset:40960
    ds_read_b64_tr_b16 a[58:59], v142 offset:41984
    buffer_load_dwordx4 v35, s[24:27], s5 offen offset:3072  lds
    v_mfma_f32_16x16x32_bf16 v[248:251], a[28:31], a[64:67], v[248:251]
    ds_read_b64_tr_b16 a[60:61], v143 offset:40960
    ds_read_b64_tr_b16 a[62:63], v143 offset:41984
    s_waitcnt lgkmcnt(0)
    v_mfma_f32_16x16x32_bf16 v[160:163], a[32:35], a[72:75], v[160:163]
    s_waitcnt vmcnt(12)
    s_barrier
    ds_read_b128 a[64:67], v144 offset:0
    ds_read_b64_tr_b16 a[0:1], v128 offset:0
    ds_read_b64_tr_b16 a[2:3], v128 offset:1024
    v_mfma_f32_16x16x32_bf16 v[168:171], a[36:39], a[72:75], v[168:171]
    ds_read_b64_tr_b16 a[4:5], v129 offset:0
    ds_read_b64_tr_b16 a[6:7], v129 offset:1024
    buffer_load_dword v49, v49, s[36:39], 0 offen
    v_mfma_f32_16x16x32_bf16 v[176:179], a[40:43], a[72:75], v[176:179]
    ds_read_b64_tr_b16 a[8:9], v130 offset:0
    ds_read_b64_tr_b16 a[10:11], v130 offset:1024
    s_add_u32 m0, s57, 131072
    s_lshl_b32 s4, s58, 7
    s_lshl_b32 s5, s58, 19
    v_mfma_f32_16x16x32_bf16 v[148:151], a[44:47], a[72:75], v[148:151]
    ds_read_b64_tr_b16 a[12:13], v131 offset:0
    ds_read_b64_tr_b16 a[14:15], v131 offset:1024
    v_mfma_f32_16x16x32_bf16 v[224:227], a[48:51], a[72:75], v[224:227]
    ds_read_b64_tr_b16 a[16:17], v132 offset:0
    ds_read_b64_tr_b16 a[18:19], v132 offset:1024
    buffer_load_dwordx4 v28, s[20:23], s4 offen offset:0  lds
    v_mfma_f32_16x16x32_bf16 v[232:235], a[52:55], a[72:75], v[232:235]
    ds_read_b64_tr_b16 a[20:21], v133 offset:0
    ds_read_b64_tr_b16 a[22:23], v133 offset:1024
    v_mfma_f32_16x16x32_bf16 v[240:243], a[56:59], a[72:75], v[240:243]
    ds_read_b64_tr_b16 a[24:25], v134 offset:0
    ds_read_b64_tr_b16 a[26:27], v134 offset:1024
    buffer_load_dwordx4 v29, s[20:23], s4 offen offset:1024  lds
    v_mfma_f32_16x16x32_bf16 v[248:251], a[60:63], a[72:75], v[248:251]
    ds_read_b64_tr_b16 a[28:29], v135 offset:0
    ds_read_b64_tr_b16 a[30:31], v135 offset:1024
    s_add_u32 m0, s57, 147456
    s_add_u32 s58, s58, 1
    s_and_b32 s58, s58, 7
    s_waitcnt lgkmcnt(10)
    v_mfma_f32_16x16x32_bf16 v[160:163], a[0:3], a[64:67], v[160:163]
    ds_read_b128 a[72:75], v145 offset:0
    ds_read_b64_tr_b16 a[32:33], v128 offset:8192
    ds_read_b64_tr_b16 a[34:35], v128 offset:9216
    v_mfma_f32_16x16x32_bf16 v[168:171], a[4:7], a[64:67], v[168:171]
    ds_read_b64_tr_b16 a[36:37], v129 offset:8192
    ds_read_b64_tr_b16 a[38:39], v129 offset:9216
    buffer_load_dwordx4 v32, s[24:27], s5 offen offset:0  lds
    v_mfma_f32_16x16x32_bf16 v[176:179], a[8:11], a[64:67], v[176:179]
    ds_read_b64_tr_b16 a[40:41], v130 offset:8192
    ds_read_b64_tr_b16 a[42:43], v130 offset:9216
    s_waitcnt lgkmcnt(10)
    v_mfma_f32_16x16x32_bf16 v[148:151], a[12:15], a[64:67], v[148:151]
    ds_read_b64_tr_b16 a[44:45], v131 offset:8192
    ds_read_b64_tr_b16 a[46:47], v131 offset:9216
    buffer_load_dwordx4 v33, s[24:27], s5 offen offset:1024  lds
    v_mfma_f32_16x16x32_bf16 v[224:227], a[16:19], a[64:67], v[224:227]
    ds_read_b64_tr_b16 a[48:49], v132 offset:8192
    ds_read_b64_tr_b16 a[50:51], v132 offset:9216
    buffer_load_dwordx4 v34, s[24:27], s5 offen offset:2048  lds
    v_mfma_f32_16x16x32_bf16 v[232:235], a[20:23], a[64:67], v[232:235]
    ds_read_b64_tr_b16 a[52:53], v133 offset:8192
    ds_read_b64_tr_b16 a[54:55], v133 offset:9216
    s_waitcnt lgkmcnt(11)
    v_mfma_f32_16x16x32_bf16 v[240:243], a[24:27], a[64:67], v[240:243]
    ds_read_b64_tr_b16 a[56:57], v134 offset:8192
    ds_read_b64_tr_b16 a[58:59], v134 offset:9216
    buffer_load_dwordx4 v35, s[24:27], s5 offen offset:3072  lds
    v_mfma_f32_16x16x32_bf16 v[248:251], a[28:31], a[64:67], v[248:251]
    ds_read_b64_tr_b16 a[60:61], v135 offset:8192
    ds_read_b64_tr_b16 a[62:63], v135 offset:9216
    s_waitcnt lgkmcnt(0)
    v_mfma_f32_16x16x32_bf16 v[160:163], a[32:35], a[72:75], v[160:163]
    s_waitcnt vmcnt(12)
    s_barrier
    ds_read_b128 a[64:67], v144 offset:16384
    ds_read_b64_tr_b16 a[0:1], v128 offset:16384
    ds_read_b64_tr_b16 a[2:3], v128 offset:17408
    v_mfma_f32_16x16x32_bf16 v[168:171], a[36:39], a[72:75], v[168:171]
    ds_read_b64_tr_b16 a[4:5], v129 offset:16384
    ds_read_b64_tr_b16 a[6:7], v129 offset:17408
    s_add_u32 m0, s6, 0
    s_add_u32 s64, s3, 0
    v_mfma_f32_16x16x32_bf16 v[176:179], a[40:43], a[72:75], v[176:179]
    ds_read_b64_tr_b16 a[8:9], v130 offset:16384
    ds_read_b64_tr_b16 a[10:11], v130 offset:17408
    buffer_load_dwordx4 v20, s[28:31], s64 offen offset:0 nt lds
    v_mfma_f32_16x16x32_bf16 v[148:151], a[44:47], a[72:75], v[148:151]
    ds_read_b64_tr_b16 a[12:13], v131 offset:16384
    ds_read_b64_tr_b16 a[14:15], v131 offset:17408
    v_mfma_f32_16x16x32_bf16 v[224:227], a[48:51], a[72:75], v[224:227]
    ds_read_b64_tr_b16 a[16:17], v132 offset:16384
    ds_read_b64_tr_b16 a[18:19], v132 offset:17408
    buffer_load_dwordx4 v21, s[28:31], s64 offen offset:1024 nt lds
    v_mfma_f32_16x16x32_bf16 v[232:235], a[52:55], a[72:75], v[232:235]
    ds_read_b64_tr_b16 a[20:21], v133 offset:16384
    ds_read_b64_tr_b16 a[22:23], v133 offset:17408
    buffer_load_dwordx4 v22, s[28:31], s64 offen offset:2048 nt lds
    v_mfma_f32_16x16x32_bf16 v[240:243], a[56:59], a[72:75], v[240:243]
    ds_read_b64_tr_b16 a[24:25], v134 offset:16384
    ds_read_b64_tr_b16 a[26:27], v134 offset:17408
    v_mfma_f32_16x16x32_bf16 v[248:251], a[60:63], a[72:75], v[248:251]
    ds_read_b64_tr_b16 a[28:29], v135 offset:16384
    ds_read_b64_tr_b16 a[30:31], v135 offset:17408
    buffer_load_dwordx4 v23, s[28:31], s64 offen offset:3072 nt lds
    s_waitcnt lgkmcnt(10)
    v_mfma_f32_16x16x32_bf16 v[160:163], a[0:3], a[64:67], v[160:163]
    ds_read_b128 a[72:75], v145 offset:16384
    ds_read_b64_tr_b16 a[32:33], v128 offset:24576
    ds_read_b64_tr_b16 a[34:35], v128 offset:25600
    s_add_u32 m0, s6, 49152
    s_add_u32 s65, s3, 0
    v_mfma_f32_16x16x32_bf16 v[168:171], a[4:7], a[64:67], v[168:171]
    ds_read_b64_tr_b16 a[36:37], v129 offset:24576
    ds_read_b64_tr_b16 a[38:39], v129 offset:25600
    v_mfma_f32_16x16x32_bf16 v[176:179], a[8:11], a[64:67], v[176:179]
    ds_read_b64_tr_b16 a[40:41], v130 offset:24576
    ds_read_b64_tr_b16 a[42:43], v130 offset:25600
    buffer_load_dwordx4 v24, s[32:35], s65 offen offset:0 nt lds
    s_waitcnt lgkmcnt(11)
    v_mfma_f32_16x16x32_bf16 v[148:151], a[12:15], a[64:67], v[148:151]
    ds_read_b64_tr_b16 a[44:45], v131 offset:24576
    ds_read_b64_tr_b16 a[46:47], v131 offset:25600
    buffer_load_dwordx4 v25, s[32:35], s65 offen offset:1024 nt lds
    v_mfma_f32_16x16x32_bf16 v[224:227], a[16:19], a[64:67], v[224:227]
    ds_read_b64_tr_b16 a[48:49], v132 offset:24576
    ds_read_b64_tr_b16 a[50:51], v132 offset:25600
    v_mfma_f32_16x16x32_bf16 v[232:235], a[20:23], a[64:67], v[232:235]
    ds_read_b64_tr_b16 a[52:53], v133 offset:24576
    ds_read_b64_tr_b16 a[54:55], v133 offset:25600
    buffer_load_dwordx4 v26, s[32:35], s65 offen offset:2048 nt lds
    s_waitcnt lgkmcnt(10)
    v_mfma_f32_16x16x32_bf16 v[240:243], a[24:27], a[64:67], v[240:243]
    ds_read_b64_tr_b16 a[56:57], v134 offset:24576
    ds_read_b64_tr_b16 a[58:59], v134 offset:25600
    buffer_load_dwordx4 v27, s[32:35], s65 offen offset:3072 nt lds
    v_mfma_f32_16x16x32_bf16 v[248:251], a[28:31], a[64:67], v[248:251]
    ds_read_b64_tr_b16 a[60:61], v135 offset:24576
    ds_read_b64_tr_b16 a[62:63], v135 offset:25600
    s_waitcnt lgkmcnt(0)
    v_mfma_f32_16x16x32_bf16 v[160:163], a[32:35], a[72:75], v[160:163]
    s_waitcnt vmcnt(14)
    s_barrier
    ds_read_b128 a[64:67], v146 offset:0
    ds_read_b64_tr_b16 a[0:1], v136 offset:0
    ds_read_b64_tr_b16 a[2:3], v136 offset:1024
    v_mfma_f32_16x16x32_bf16 v[168:171], a[36:39], a[72:75], v[168:171]
    ds_read_b64_tr_b16 a[4:5], v137 offset:0
    ds_read_b64_tr_b16 a[6:7], v137 offset:1024
    s_add_u32 m0, s6, 16384
    s_add_u32 s64, s3, 16384
    v_mfma_f32_16x16x32_bf16 v[176:179], a[40:43], a[72:75], v[176:179]
    ds_read_b64_tr_b16 a[8:9], v138 offset:0
    ds_read_b64_tr_b16 a[10:11], v138 offset:1024
    v_mfma_f32_16x16x32_bf16 v[148:151], a[44:47], a[72:75], v[148:151]
    ds_read_b64_tr_b16 a[12:13], v139 offset:0
    ds_read_b64_tr_b16 a[14:15], v139 offset:1024
    v_mfma_f32_16x16x32_bf16 v[224:227], a[48:51], a[72:75], v[224:227]
    ds_read_b64_tr_b16 a[16:17], v140 offset:0
    ds_read_b64_tr_b16 a[18:19], v140 offset:1024
    buffer_load_dwordx4 v20, s[28:31], s64 offen offset:0 nt lds
    v_mfma_f32_16x16x32_bf16 v[232:235], a[52:55], a[72:75], v[232:235]
    ds_read_b64_tr_b16 a[20:21], v141 offset:0
    ds_read_b64_tr_b16 a[22:23], v141 offset:1024
    v_mfma_f32_16x16x32_bf16 v[240:243], a[56:59], a[72:75], v[240:243]
    ds_read_b64_tr_b16 a[24:25], v142 offset:0
    ds_read_b64_tr_b16 a[26:27], v142 offset:1024
    v_mfma_f32_16x16x32_bf16 v[248:251], a[60:63], a[72:75], v[248:251]
    ds_read_b64_tr_b16 a[28:29], v143 offset:0
    ds_read_b64_tr_b16 a[30:31], v143 offset:1024
    buffer_load_dwordx4 v21, s[28:31], s64 offen offset:1024 nt lds
    s_waitcnt lgkmcnt(12)
    v_mfma_f32_16x16x32_bf16 v[160:163], a[0:3], a[64:67], v[160:163]
    ds_read_b128 a[72:75], v147 offset:0
    ds_read_b64_tr_b16 a[32:33], v136 offset:8192
    ds_read_b64_tr_b16 a[34:35], v136 offset:9216
    v_mfma_f32_16x16x32_bf16 v[168:171], a[4:7], a[64:67], v[168:171]
    ds_read_b64_tr_b16 a[36:37], v137 offset:8192
    ds_read_b64_tr_b16 a[38:39], v137 offset:9216
    s_waitcnt lgkmcnt(12)
    v_mfma_f32_16x16x32_bf16 v[176:179], a[8:11], a[64:67], v[176:179]
    ds_read_b64_tr_b16 a[40:41], v138 offset:8192
    ds_read_b64_tr_b16 a[42:43], v138 offset:9216
    buffer_load_dwordx4 v22, s[28:31], s64 offen offset:2048 nt lds
    v_mfma_f32_16x16x32_bf16 v[148:151], a[12:15], a[64:67], v[148:151]
    ds_read_b64_tr_b16 a[44:45], v139 offset:8192
    ds_read_b64_tr_b16 a[46:47], v139 offset:9216
    s_waitcnt lgkmcnt(12)
    v_mfma_f32_16x16x32_bf16 v[224:227], a[16:19], a[64:67], v[224:227]
    ds_read_b64_tr_b16 a[48:49], v140 offset:8192
    ds_read_b64_tr_b16 a[50:51], v140 offset:9216
    v_mfma_f32_16x16x32_bf16 v[232:235], a[20:23], a[64:67], v[232:235]
    ds_read_b64_tr_b16 a[52:53], v141 offset:8192
    ds_read_b64_tr_b16 a[54:55], v141 offset:9216
    buffer_load_dwordx4 v23, s[28:31], s64 offen offset:3072 nt lds
    s_waitcnt lgkmcnt(12)
    v_mfma_f32_16x16x32_bf16 v[240:243], a[24:27], a[64:67], v[240:243]
    ds_read_b64_tr_b16 a[56:57], v142 offset:8192
    ds_read_b64_tr_b16 a[58:59], v142 offset:9216
    v_mfma_f32_16x16x32_bf16 v[248:251], a[28:31], a[64:67], v[248:251]
    ds_read_b64_tr_b16 a[60:61], v143 offset:8192
    ds_read_b64_tr_b16 a[62:63], v143 offset:9216
    s_waitcnt lgkmcnt(0)
    v_mfma_f32_16x16x32_bf16 v[160:163], a[32:35], a[72:75], v[160:163]
    s_waitcnt vmcnt(12)
    s_barrier
    ds_read_b128 a[64:67], v146 offset:32768
    ds_read_b64_tr_b16 a[0:1], v136 offset:32768
    ds_read_b64_tr_b16 a[2:3], v136 offset:33792
    v_mfma_f32_16x16x32_bf16 v[168:171], a[36:39], a[72:75], v[168:171]
    ds_read_b64_tr_b16 a[4:5], v137 offset:32768
    ds_read_b64_tr_b16 a[6:7], v137 offset:33792
    s_add_u32 m0, s6, 65536
    s_add_u32 s65, s3, 16384
    v_mfma_f32_16x16x32_bf16 v[176:179], a[40:43], a[72:75], v[176:179]
    ds_read_b64_tr_b16 a[8:9], v138 offset:32768
    ds_read_b64_tr_b16 a[10:11], v138 offset:33792
    v_mfma_f32_16x16x32_bf16 v[148:151], a[44:47], a[72:75], v[148:151]
    ds_read_b64_tr_b16 a[12:13], v139 offset:32768
    ds_read_b64_tr_b16 a[14:15], v139 offset:33792
    v_mfma_f32_16x16x32_bf16 v[224:227], a[48:51], a[72:75], v[224:227]
    ds_read_b128 a[80:83], v147 offset:32768
    ds_read_b64_tr_b16 a[32:33], v136 offset:40960
    ds_read_b64_tr_b16 a[34:35], v136 offset:41984
    buffer_load_dwordx4 v24, s[32:35], s65 offen offset:0 nt lds
    v_mfma_f32_16x16x32_bf16 v[232:235], a[52:55], a[72:75], v[232:235]
    ds_read_b64_tr_b16 a[36:37], v137 offset:40960
    ds_read_b64_tr_b16 a[38:39], v137 offset:41984
    v_mfma_f32_16x16x32_bf16 v[240:243], a[56:59], a[72:75], v[240:243]
    ds_read_b64_tr_b16 a[40:41], v138 offset:40960
    ds_read_b64_tr_b16 a[42:43], v138 offset:41984
    v_mfma_f32_16x16x32_bf16 v[248:251], a[60:63], a[72:75], v[248:251]
    ds_read_b64_tr_b16 a[44:45], v139 offset:40960
    ds_read_b64_tr_b16 a[46:47], v139 offset:41984
    buffer_load_dwordx4 v25, s[32:35], s65 offen offset:1024 nt lds
    s_waitcnt lgkmcnt(12)
    v_mfma_f32_16x16x32_bf16 v[160:163], a[0:3], a[64:67], v[160:163]
    ds_read_b64_tr_b16 a[16:17], v140 offset:32768
    ds_read_b64_tr_b16 a[18:19], v140 offset:33792
    v_mfma_f32_16x16x32_bf16 v[168:171], a[4:7], a[64:67], v[168:171]
    ds_read_b64_tr_b16 a[20:21], v141 offset:32768
    ds_read_b64_tr_b16 a[22:23], v141 offset:33792
    s_waitcnt lgkmcnt(12)
    v_mfma_f32_16x16x32_bf16 v[176:179], a[8:11], a[64:67], v[176:179]
    ds_read_b64_tr_b16 a[24:25], v142 offset:32768
    ds_read_b64_tr_b16 a[26:27], v142 offset:33792
    buffer_load_dwordx4 v26, s[32:35], s65 offen offset:2048 nt lds
    v_mfma_f32_16x16x32_bf16 v[148:151], a[12:15], a[64:67], v[148:151]
    ds_read_b64_tr_b16 a[28:29], v143 offset:32768
    ds_read_b64_tr_b16 a[30:31], v143 offset:33792
    s_waitcnt lgkmcnt(12)
    v_mfma_f32_16x16x32_bf16 v[160:163], a[32:35], a[80:83], v[160:163]
    ds_read_b64_tr_b16 a[48:49], v140 offset:40960
    ds_read_b64_tr_b16 a[50:51], v140 offset:41984
    v_mfma_f32_16x16x32_bf16 v[168:171], a[36:39], a[80:83], v[168:171]
    ds_read_b64_tr_b16 a[52:53], v141 offset:40960
    ds_read_b64_tr_b16 a[54:55], v141 offset:41984
    buffer_load_dwordx4 v27, s[32:35], s65 offen offset:3072 nt lds
    s_waitcnt lgkmcnt(12)
    v_mfma_f32_16x16x32_bf16 v[176:179], a[40:43], a[80:83], v[176:179]
    ds_read_b64_tr_b16 a[56:57], v142 offset:40960
    ds_read_b64_tr_b16 a[58:59], v142 offset:41984
    v_mfma_f32_16x16x32_bf16 v[148:151], a[44:47], a[80:83], v[148:151]
    ds_read_b64_tr_b16 a[60:61], v143 offset:40960
    ds_read_b64_tr_b16 a[62:63], v143 offset:41984
    s_waitcnt lgkmcnt(12)
    v_mfma_f32_16x16x32_bf16 v[224:227], a[16:19], a[64:67], v[224:227]
    s_waitcnt vmcnt(12)
    s_barrier
    v_mfma_f32_16x16x32_bf16 v[232:235], a[20:23], a[64:67], v[232:235]
    ds_read_b128 a[16:19], v8 offset:4096
    ds_read_b128 a[0:3], v8 offset:0
    s_waitcnt lgkmcnt(10)
    v_mfma_f32_16x16x32_bf16 v[240:243], a[24:27], a[64:67], v[240:243]
    ds_read_b128 a[4:7], v9 offset:0
    v_mfma_f32_16x16x32_bf16 v[248:251], a[28:31], a[64:67], v[248:251]
    ds_read_b128 a[20:23], v9 offset:4096
    v_mul_f32 v160, s70, v160
    v_mul_f32 v161, s70, v161
    v_mul_f32 v162, s70, v162
    v_mul_f32 v163, s70, v163
    s_waitcnt lgkmcnt(8)
    v_mfma_f32_16x16x32_bf16 v[224:227], a[48:51], a[80:83], v[224:227]
    ds_read_b128 a[8:11], v10 offset:0
    v_mul_f32 v168, s70, v168
    v_mul_f32 v169, s70, v169
    v_mul_f32 v170, s70, v170
    v_mfma_f32_16x16x32_bf16 v[232:235], a[52:55], a[80:83], v[232:235]
    ds_read_b128 a[24:27], v10 offset:4096
    v_mul_f32 v171, s70, v171
    v_mul_f32 v176, s70, v176
    v_mul_f32 v177, s70, v177
    s_waitcnt lgkmcnt(5)
    v_mfma_f32_16x16x32_bf16 v[240:243], a[56:59], a[80:83], v[240:243]
    ds_read_b128 a[12:15], v11 offset:0
    v_mul_f32 v178, s70, v178
    v_mul_f32 v179, s70, v179
    v_mul_f32 v148, s70, v148
    v_mfma_f32_16x16x32_bf16 v[248:251], a[60:63], a[80:83], v[248:251]
    ds_read_b128 a[28:31], v11 offset:4096
    v_mul_f32 v149, s70, v149
    v_mul_f32 v150, s70, v150
    v_mul_f32 v151, s70, v151
    s_add_u32 m0, s6, 32768
    s_add_u32 s64, s3, 32768
    v_cvt_pk_bf16_f32 v192, v160, v161
    v_cvt_pk_bf16_f32 v193, v162, v163
    v_cvt_pk_bf16_f32 v194, v168, v169
    v_cvt_pk_bf16_f32 v195, v170, v171
    buffer_load_dwordx4 v20, s[28:31], s64 offen offset:0 nt lds
    v_cvt_pk_bf16_f32 v196, v176, v177
    v_cvt_pk_bf16_f32 v197, v178, v179
    v_cvt_pk_bf16_f32 v198, v148, v149
    v_cvt_pk_bf16_f32 v199, v150, v151
    buffer_load_dwordx4 v21, s[28:31], s64 offen offset:1024 nt lds
    s_nop 0
    v_permlane32_swap_b32 v192, v194
    v_permlane32_swap_b32 v193, v195
    buffer_load_dwordx4 v22, s[28:31], s64 offen offset:2048 nt lds
    v_permlane32_swap_b32 v196, v198
    v_permlane32_swap_b32 v197, v199
    s_nop 0
    v_permlane16_swap_b32 v192, v194
    buffer_load_dwordx4 v23, s[28:31], s64 offen offset:3072 nt lds
    v_permlane16_swap_b32 v193, v195
    v_permlane16_swap_b32 v196, v198
    v_permlane16_swap_b32 v197, v199
    s_nop 0
    s_waitcnt lgkmcnt(0)
    v_mfma_f32_16x16x32_bf16 v[128:131], a[0:3], v[192:195], 0
    ds_read_b128 a[0:3], v8 offset:8192
    v_mul_f32 v224, s70, v224
    v_mul_f32 v225, s70, v225
    v_mul_f32 v226, s70, v226
    v_mul_f32 v227, s70, v227
    v_mul_f32 v232, s70, v232
    v_mul_f32 v233, s70, v233
    v_mul_f32 v234, s70, v234
    v_mul_f32 v235, s70, v235
    v_mul_f32 v240, s70, v240
    v_mfma_f32_16x16x32_bf16 v[136:139], a[16:19], v[192:195], 0
    ds_read_b128 a[16:19], v8 offset:12288
    v_mul_f32 v241, s70, v241
    v_mul_f32 v242, s70, v242
    v_mul_f32 v243, s70, v243
    v_mul_f32 v248, s70, v248
    v_mul_f32 v249, s70, v249
    v_mul_f32 v250, s70, v250
    v_mul_f32 v251, s70, v251
    v_cvt_pk_bf16_f32 v200, v224, v225
    v_cvt_pk_bf16_f32 v201, v226, v227
    v_mfma_f32_16x16x32_bf16 v[128:131], a[4:7], v[196:199], v[128:131]
    ds_read_b128 a[4:7], v9 offset:8192
    v_cvt_pk_bf16_f32 v202, v232, v233
    v_cvt_pk_bf16_f32 v203, v234, v235
    v_cvt_pk_bf16_f32 v204, v240, v241
    v_cvt_pk_bf16_f32 v205, v242, v243
    v_cvt_pk_bf16_f32 v206, v248, v249
    v_cvt_pk_bf16_f32 v207, v250, v251
    s_nop 0
    v_permlane32_swap_b32 v200, v202
    v_permlane32_swap_b32 v201, v203
    v_mfma_f32_16x16x32_bf16 v[136:139], a[20:23], v[196:199], v[136:139]
    ds_read_b128 a[20:23], v9 offset:12288
    v_permlane32_swap_b32 v204, v206
    v_permlane32_swap_b32 v205, v207
    s_nop 0
    v_permlane16_swap_b32 v200, v202
    v_permlane16_swap_b32 v201, v203
    v_permlane16_swap_b32 v204, v206
    v_permlane16_swap_b32 v205, v207
    s_nop 0
    v_mfma_f32_16x16x32_bf16 v[128:131], a[8:11], v[200:203], v[128:131]
    ds_read_b128 a[8:11], v10 offset:8192
    v_mov_b32 v168, 0
    v_mfma_f32_16x16x32_bf16 v[136:139], a[24:27], v[200:203], v[136:139]
    ds_read_b128 a[24:27], v10 offset:12288
    v_mov_b32 v169, 0
    v_mfma_f32_16x16x32_bf16 v[128:131], a[12:15], v[204:207], v[128:131]
    ds_read_b128 a[12:15], v11 offset:8192
    v_mov_b32 v170, 0
    v_mfma_f32_16x16x32_bf16 v[136:139], a[28:31], v[204:207], v[136:139]
    ds_read_b128 a[28:31], v11 offset:12288
    v_mov_b32 v171, 0
    s_waitcnt vmcnt(12)
    s_barrier
    s_add_u32 m0, s6, 81920
    s_add_u32 s65, s3, 32768
    ds_read_b64_tr_b16 a[32:33], v12 offset:0
    ds_read_b64_tr_b16 a[34:35], v12 offset:4096
    ds_read_b64_tr_b16 a[36:37], v13 offset:0
    ds_read_b64_tr_b16 a[38:39], v13 offset:4096
    ds_read_b64_tr_b16 a[40:41], v14 offset:0
    ds_read_b64_tr_b16 a[42:43], v14 offset:4096
    ds_read_b64_tr_b16 a[44:45], v15 offset:0
    ds_read_b64_tr_b16 a[46:47], v15 offset:4096
    buffer_load_dwordx4 v24, s[32:35], s65 offen offset:0 nt lds
    buffer_load_dwordx4 v25, s[32:35], s65 offen offset:1024 nt lds
    buffer_load_dwordx4 v26, s[32:35], s65 offen offset:2048 nt lds
    buffer_load_dwordx4 v27, s[32:35], s65 offen offset:3072 nt lds
    v_max3_f32 v48, v128, v129, v130
    v_max3_f32 v48, v48, v131, v136
    v_max3_f32 v48, v48, v137, v138
    v_max_f32 v48, v48, v139
    v_mov_b32 v60, v48
    s_nop 1
    v_permlane32_swap_b32 v48, v60
    v_max_f32 v48, v48, v60
    v_mov_b32 v60, v48
    s_nop 1
    v_permlane16_swap_b32 v48, v60
    v_max_f32 v48, v48, v60
    v_sub_f32 v160, 0, v48
    v_sub_f32 v161, 0, v48
    v_sub_f32 v162, 0, v48
    v_sub_f32 v163, 0, v48
    v_sub_f32 v128, v128, v48
    v_sub_f32 v129, v129, v48
    v_sub_f32 v130, v130, v48
    v_sub_f32 v131, v131, v48
    v_sub_f32 v136, v136, v48
    v_sub_f32 v137, v137, v48
    v_sub_f32 v138, v138, v48
    v_sub_f32 v139, v139, v48
    s_waitcnt lgkmcnt(0)
    v_mfma_f32_16x16x32_bf16 v[144:147], a[0:3], v[192:195], v[160:163]
    ds_read_b64_tr_b16 a[48:49], v16 offset:0
    ds_read_b64_tr_b16 a[50:51], v16 offset:4096
    v_exp_f32 v128, v128
    v_exp_f32 v129, v129
    v_mfma_f32_16x16x32_bf16 v[152:155], a[16:19], v[192:195], v[160:163]
    ds_read_b64_tr_b16 a[52:53], v17 offset:0
    ds_read_b64_tr_b16 a[54:55], v17 offset:4096
    v_exp_f32 v130, v130
    v_cvt_pk_bf16_f32 v176, v128, v129
    v_mfma_f32_16x16x32_bf16 v[144:147], a[4:7], v[196:199], v[144:147]
    ds_read_b64_tr_b16 a[56:57], v18 offset:0
    ds_read_b64_tr_b16 a[58:59], v18 offset:4096
    v_exp_f32 v131, v131
    v_exp_f32 v136, v136
    v_mfma_f32_16x16x32_bf16 v[152:155], a[20:23], v[196:199], v[152:155]
    ds_read_b64_tr_b16 a[60:61], v19 offset:0
    ds_read_b64_tr_b16 a[62:63], v19 offset:4096
    v_cvt_pk_bf16_f32 v177, v130, v131
    v_exp_f32 v137, v137
    v_mfma_f32_16x16x32_bf16 v[144:147], a[8:11], v[200:203], v[144:147]
    v_exp_f32 v138, v138
    v_cvt_pk_bf16_f32 v178, v136, v137
    v_mfma_f32_16x16x32_bf16 v[152:155], a[24:27], v[200:203], v[152:155]
    v_exp_f32 v139, v139
    v_mfma_f32_16x16x32_bf16 v[144:147], a[12:15], v[204:207], v[144:147]
    v_cvt_pk_bf16_f32 v179, v138, v139
    v_mfma_f32_16x16x32_bf16 v[152:155], a[28:31], v[204:207], v[152:155]
    s_nop 0
    s_mov_b32 s59, 0
    s_mov_b32 s64, 49152
    s_mov_b32 s65, 49152
L_a_1:
    s_waitcnt lgkmcnt(0)
    v_mfma_f32_16x16x32_bf16 v[168:171], v[56:59], v[176:179], v[168:171]
    s_waitcnt vmcnt(12)
    s_barrier
    ds_read_b128 a[0:3], v8 offset:16384
    v_mfma_f32_16x16x32_bf16 v[64:67], a[32:35], v[176:179], v[64:67]
    ds_read_b128 a[16:19], v8 offset:20480
    s_add_u32 m0, s57, 0
    ds_read_b64_tr_b16 a[32:33], v12 offset:8192
    ds_read_b64_tr_b16 a[34:35], v12 offset:12288
    v_mfma_f32_16x16x32_bf16 v[72:75], a[36:39], v[176:179], v[72:75]
    ds_read_b128 a[4:7], v9 offset:16384
    ds_read_b64_tr_b16 a[36:37], v13 offset:8192
    ds_read_b64_tr_b16 a[38:39], v13 offset:12288
    v_mfma_f32_16x16x32_bf16 v[80:83], a[40:43], v[176:179], v[80:83]
    ds_read_b128 a[20:23], v9 offset:20480
    buffer_load_dwordx4 v20, s[28:31], s64 offen offset:0 nt lds
    ds_read_b64_tr_b16 a[40:41], v14 offset:8192
    ds_read_b64_tr_b16 a[42:43], v14 offset:12288
    v_mfma_f32_16x16x32_bf16 v[88:91], a[44:47], v[176:179], v[88:91]
    ds_read_b128 a[8:11], v10 offset:16384
    ds_read_b64_tr_b16 a[44:45], v15 offset:8192
    ds_read_b64_tr_b16 a[46:47], v15 offset:12288
    v_max3_f32 v48, v144, v145, v146
    v_mfma_f32_16x16x32_bf16 v[96:99], a[48:51], v[176:179], v[96:99]
    ds_read_b128 a[24:27], v10 offset:20480
    v_max3_f32 v48, v48, v147, v152
    v_mfma_f32_16x16x32_bf16 v[104:107], a[52:55], v[176:179], v[104:107]
    ds_read_b128 a[12:15], v11 offset:16384
    v_max3_f32 v48, v48, v153, v154
    v_mfma_f32_16x16x32_bf16 v[112:115], a[56:59], v[176:179], v[112:115]
    ds_read_b128 a[28:31], v11 offset:20480
    v_max_f32 v48, v48, v155
    v_mfma_f32_16x16x32_bf16 v[120:123], a[60:63], v[176:179], v[120:123]
    v_cmp_lt_f32 vcc, 0x41000000, v48
    s_cbranch_vccnz L_rs_0_1
L_rsb_0_1:
    s_waitcnt lgkmcnt(8)
    v_mfma_f32_16x16x32_bf16 v[128:131], a[0:3], v[192:195], v[160:163]
    ds_read_b64_tr_b16 a[48:49], v16 offset:8192
    ds_read_b64_tr_b16 a[50:51], v16 offset:12288
    v_exp_f32 v144, v144
    v_exp_f32 v145, v145
    v_mfma_f32_16x16x32_bf16 v[136:139], a[16:19], v[192:195], v[160:163]
    ds_read_b64_tr_b16 a[52:53], v17 offset:8192
    ds_read_b64_tr_b16 a[54:55], v17 offset:12288
    v_exp_f32 v146, v146
    v_cvt_pk_bf16_f32 v176, v144, v145
    v_mfma_f32_16x16x32_bf16 v[128:131], a[4:7], v[196:199], v[128:131]
    ds_read_b64_tr_b16 a[56:57], v18 offset:8192
    ds_read_b64_tr_b16 a[58:59], v18 offset:12288
    v_exp_f32 v147, v147
    v_exp_f32 v152, v152
    v_mfma_f32_16x16x32_bf16 v[136:139], a[20:23], v[196:199], v[136:139]
    ds_read_b64_tr_b16 a[60:61], v19 offset:8192
    ds_read_b64_tr_b16 a[62:63], v19 offset:12288
    v_cvt_pk_bf16_f32 v177, v146, v147
    v_exp_f32 v153, v153
    s_waitcnt lgkmcnt(8)
    v_mfma_f32_16x16x32_bf16 v[128:131], a[8:11], v[200:203], v[128:131]
    buffer_load_dwordx4 v21, s[28:31], s64 offen offset:1024 nt lds
    v_exp_f32 v154, v154
    v_cvt_pk_bf16_f32 v178, v152, v153
    v_mfma_f32_16x16x32_bf16 v[136:139], a[24:27], v[200:203], v[136:139]
    buffer_load_dwordx4 v22, s[28:31], s64 offen offset:2048 nt lds
    v_exp_f32 v155, v155
    v_mfma_f32_16x16x32_bf16 v[128:131], a[12:15], v[204:207], v[128:131]
    buffer_load_dwordx4 v23, s[28:31], s64 offen offset:3072 nt lds
    v_cvt_pk_bf16_f32 v179, v154, v155
    v_mfma_f32_16x16x32_bf16 v[136:139], a[28:31], v[204:207], v[136:139]
    s_add_u32 s64, s64, 16384
    s_nop 0
    s_waitcnt lgkmcnt(0)
    v_mfma_f32_16x16x32_bf16 v[168:171], v[56:59], v[176:179], v[168:171]
    s_waitcnt vmcnt(12)
    s_barrier
    ds_read_b128 a[0:3], v8 offset:24576
    v_mfma_f32_16x16x32_bf16 v[64:67], a[32:35], v[176:179], v[64:67]
    ds_read_b128 a[16:19], v8 offset:28672
    s_add_u32 m0, s57, 49152
    ds_read_b64_tr_b16 a[32:33], v12 offset:16384
    ds_read_b64_tr_b16 a[34:35], v12 offset:20480
    v_mfma_f32_16x16x32_bf16 v[72:75], a[36:39], v[176:179], v[72:75]
    ds_read_b128 a[4:7], v9 offset:24576
    ds_read_b64_tr_b16 a[36:37], v13 offset:16384
    ds_read_b64_tr_b16 a[38:39], v13 offset:20480
    v_mfma_f32_16x16x32_bf16 v[80:83], a[40:43], v[176:179], v[80:83]
    ds_read_b128 a[20:23], v9 offset:28672
    buffer_load_dwordx4 v24, s[32:35], s65 offen offset:0 nt lds
    ds_read_b64_tr_b16 a[40:41], v14 offset:16384
    ds_read_b64_tr_b16 a[42:43], v14 offset:20480
    v_mfma_f32_16x16x32_bf16 v[88:91], a[44:47], v[176:179], v[88:91]
    ds_read_b128 a[8:11], v10 offset:24576
    ds_read_b64_tr_b16 a[44:45], v15 offset:16384
    ds_read_b64_tr_b16 a[46:47], v15 offset:20480
    v_max3_f32 v48, v128, v129, v130
    v_mfma_f32_16x16x32_bf16 v[96:99], a[48:51], v[176:179], v[96:99]
    ds_read_b128 a[24:27], v10 offset:28672
    v_max3_f32 v48, v48, v131, v136
    v_mfma_f32_16x16x32_bf16 v[104:107], a[52:55], v[176:179], v[104:107]
    ds_read_b128 a[12:15], v11 offset:24576
    v_max3_f32 v48, v48, v137, v138
    v_mfma_f32_16x16x32_bf16 v[112:115], a[56:59], v[176:179], v[112:115]
    ds_read_b128 a[28:31], v11 offset:28672
    v_max_f32 v48, v48, v139
    v_mfma_f32_16x16x32_bf16 v[120:123], a[60:63], v[176:179], v[120:123]
    v_cmp_lt_f32 vcc, 0x41000000, v48
    s_cbranch_vccnz L_rs_1_1
L_rsb_1_1:
    s_waitcnt lgkmcnt(8)
    v_mfma_f32_16x16x32_bf16 v[144:147], a[0:3], v[192:195], v[160:163]
    ds_read_b64_tr_b16 a[48:49], v16 offset:16384
    ds_read_b64_tr_b16 a[50:51], v16 offset:20480
    v_exp_f32 v128, v128
    v_exp_f32 v129, v129
    v_mfma_f32_16x16x32_bf16 v[152:155], a[16:19], v[192:195], v[160:163]
    ds_read_b64_tr_b16 a[52:53], v17 offset:16384
    ds_read_b64_tr_b16 a[54:55], v17 offset:20480
    v_exp_f32 v130, v130
    v_cvt_pk_bf16_f32 v176, v128, v129
    v_mfma_f32_16x16x32_bf16 v[144:147], a[4:7], v[196:199], v[144:147]
    ds_read_b64_tr_b16 a[56:57], v18 offset:16384
    ds_read_b64_tr_b16 a[58:59], v18 offset:20480
    v_exp_f32 v131, v131
    v_exp_f32 v136, v136
    v_mfma_f32_16x16x32_bf16 v[152:155], a[20:23], v[196:199], v[152:155]
    ds_read_b64_tr_b16 a[60:61], v19 offset:16384
    ds_read_b64_tr_b16 a[62:63], v19 offset:20480
    v_cvt_pk_bf16_f32 v177, v130, v131
    v_exp_f32 v137, v137
    s_waitcnt lgkmcnt(8)
    v_mfma_f32_16x16x32_bf16 v[144:147], a[8:11], v[200:203], v[144:147]
    buffer_load_dwordx4 v25, s[32:35], s65 offen offset:1024 nt lds
    v_exp_f32 v138, v138
    v_cvt_pk_bf16_f32 v178, v136, v137
    v_mfma_f32_16x16x32_bf16 v[152:155], a[24:27], v[200:203], v[152:155]
    buffer_load_dwordx4 v26, s[32:35], s65 offen offset:2048 nt lds
    v_exp_f32 v139, v139
    v_mfma_f32_16x16x32_bf16 v[144:147], a[12:15], v[204:207], v[144:147]
    buffer_load_dwordx4 v27, s[32:35], s65 offen offset:3072 nt lds
    v_cvt_pk_bf16_f32 v179, v138, v139
    v_mfma_f32_16x16x32_bf16 v[152:155], a[28:31], v[204:207], v[152:155]
    s_mov_b32 s65, s64
    s_nop 0
    s_call_b64 s[62:63], L_x
    s_waitcnt lgkmcnt(0)
    v_mfma_f32_16x16x32_bf16 v[168:171], v[56:59], v[176:179], v[168:171]
    s_waitcnt vmcnt(12)
    s_barrier
    ds_read_b128 a[0:3], v8 offset:32768
    v_mfma_f32_16x16x32_bf16 v[64:67], a[32:35], v[176:179], v[64:67]
    ds_read_b128 a[16:19], v8 offset:36864
    s_add_u32 m0, s57, 16384
    ds_read_b64_tr_b16 a[32:33], v12 offset:24576
    ds_read_b64_tr_b16 a[34:35], v12 offset:28672
    v_mfma_f32_16x16x32_bf16 v[72:75], a[36:39], v[176:179], v[72:75]
    ds_read_b128 a[4:7], v9 offset:32768
    ds_read_b64_tr_b16 a[36:37], v13 offset:24576
    ds_read_b64_tr_b16 a[38:39], v13 offset:28672
    v_mfma_f32_16x16x32_bf16 v[80:83], a[40:43], v[176:179], v[80:83]
    ds_read_b128 a[20:23], v9 offset:36864
    buffer_load_dwordx4 v20, s[28:31], s64 offen offset:0 nt lds
    ds_read_b64_tr_b16 a[40:41], v14 offset:24576
    ds_read_b64_tr_b16 a[42:43], v14 offset:28672
    v_mfma_f32_16x16x32_bf16 v[88:91], a[44:47], v[176:179], v[88:91]
    ds_read_b128 a[8:11], v10 offset:32768
    ds_read_b64_tr_b16 a[44:45], v15 offset:24576
    ds_read_b64_tr_b16 a[46:47], v15 offset:28672
    v_max3_f32 v48, v144, v145, v146
    v_mfma_f32_16x16x32_bf16 v[96:99], a[48:51], v[176:179], v[96:99]
    ds_read_b128 a[24:27], v10 offset:36864
    v_max3_f32 v48, v48, v147, v152
    v_mfma_f32_16x16x32_bf16 v[104:107], a[52:55], v[176:179], v[104:107]
    ds_read_b128 a[12:15], v11 offset:32768
    v_max3_f32 v48, v48, v153, v154
    v_mfma_f32_16x16x32_bf16 v[112:115], a[56:59], v[176:179], v[112:115]
    ds_read_b128 a[28:31], v11 offset:36864
    v_max_f32 v48, v48, v155
    v_mfma_f32_16x16x32_bf16 v[120:123], a[60:63], v[176:179], v[120:123]
    v_cmp_lt_f32 vcc, 0x41000000, v48
    s_cbranch_vccnz L_rs_2_1
L_rsb_2_1:
    s_waitcnt lgkmcnt(8)
    v_mfma_f32_16x16x32_bf16 v[128:131], a[0:3], v[192:195], v[160:163]
    ds_read_b64_tr_b16 a[48:49], v16 offset:24576
    ds_read_b64_tr_b16 a[50:51], v16 offset:28672
    v_exp_f32 v144, v144
    v_exp_f32 v145, v145
    v_mfma_f32_16x16x32_bf16 v[136:139], a[16:19], v[192:195], v[160:163]
    ds_read_b64_tr_b16 a[52:53], v17 offset:24576
    ds_read_b64_tr_b16 a[54:55], v17 offset:28672
    v_exp_f32 v146, v146
    v_cvt_pk_bf16_f32 v176, v144, v145
    v_mfma_f32_16x16x32_bf16 v[128:131], a[4:7], v[196:199], v[128:131]
    ds_read_b64_tr_b16 a[56:57], v18 offset:24576
    ds_read_b64_tr_b16 a[58:59], v18 offset:28672
    v_exp_f32 v147, v147
    v_exp_f32 v152, v152
    v_mfma_f32_16x16x32_bf16 v[136:139], a[20:23], v[196:199], v[136:139]
    ds_read_b64_tr_b16 a[60:61], v19 offset:24576
    ds_read_b64_tr_b16 a[62:63], v19 offset:28672
    v_cvt_pk_bf16_f32 v177, v146, v147
    v_exp_f32 v153, v153
    s_waitcnt lgkmcnt(8)
    v_mfma_f32_16x16x32_bf16 v[128:131], a[8:11], v[200:203], v[128:131]
    buffer_load_dwordx4 v21, s[28:31], s64 offen offset:1024 nt lds
    v_exp_f32 v154, v154
    v_cvt_pk_bf16_f32 v178, v152, v153
    v_mfma_f32_16x16x32_bf16 v[136:139], a[24:27], v[200:203], v[136:139]
    buffer_load_dwordx4 v22, s[28:31], s64 offen offset:2048 nt lds
    v_exp_f32 v155, v155
    v_mfma_f32_16x16x32_bf16 v[128:131], a[12:15], v[204:207], v[128:131]
    buffer_load_dwordx4 v23, s[28:31], s64 offen offset:3072 nt lds
    v_cvt_pk_bf16_f32 v179, v154, v155
    v_mfma_f32_16x16x32_bf16 v[136:139], a[28:31], v[204:207], v[136:139]
    s_add_u32 s64, s64, 16384
    s_nop 0
    s_waitcnt lgkmcnt(0)
    v_mfma_f32_16x16x32_bf16 v[168:171], v[56:59], v[176:179], v[168:171]
    s_waitcnt vmcnt(12)
    s_barrier
    ds_read_b128 a[0:3], v8 offset:40960
    v_mfma_f32_16x16x32_bf16 v[64:67], a[32:35], v[176:179], v[64:67]
    ds_read_b128 a[16:19], v8 offset:45056
    s_add_u32 m0, s57, 65536
    ds_read_b64_tr_b16 a[32:33], v12 offset:32768
    ds_read_b64_tr_b16 a[34:35], v12 offset:36864
    v_mfma_f32_16x16x32_bf16 v[72:75], a[36:39], v[176:179], v[72:75]
    ds_read_b128 a[4:7], v9 offset:40960
    ds_read_b64_tr_b16 a[36:37], v13 offset:32768
    ds_read_b64_tr_b16 a[38:39], v13 offset:36864
    v_mfma_f32_16x16x32_bf16 v[80:83], a[40:43], v[176:179], v[80:83]
    ds_read_b128 a[20:23], v9 offset:45056
    buffer_load_dwordx4 v24, s[32:35], s65 offen offset:0 nt lds
    ds_read_b64_tr_b16 a[40:41], v14 offset:32768
    ds_read_b64_tr_b16 a[42:43], v14 offset:36864
    v_mfma_f32_16x16x32_bf16 v[88:91], a[44:47], v[176:179], v[88:91]
    ds_read_b128 a[8:11], v10 offset:40960
    ds_read_b64_tr_b16 a[44:45], v15 offset:32768
    ds_read_b64_tr_b16 a[46:47], v15 offset:36864
    v_max3_f32 v48, v128, v129, v130
    v_mfma_f32_16x16x32_bf16 v[96:99], a[48:51], v[176:179], v[96:99]
    ds_read_b128 a[24:27], v10 offset:45056
    v_max3_f32 v48, v48, v131, v136
    v_mfma_f32_16x16x32_bf16 v[104:107], a[52:55], v[176:179], v[104:107]
    ds_read_b128 a[12:15], v11 offset:40960
    v_max3_f32 v48, v48, v137, v138
    v_mfma_f32_16x16x32_bf16 v[112:115], a[56:59], v[176:179], v[112:115]
    ds_read_b128 a[28:31], v11 offset:45056
    v_max_f32 v48, v48, v139
    v_mfma_f32_16x16x32_bf16 v[120:123], a[60:63], v[176:179], v[120:123]
    v_cmp_lt_f32 vcc, 0x41000000, v48
    s_cbranch_vccnz L_rs_3_1
L_rsb_3_1:
    s_waitcnt lgkmcnt(8)
    v_mfma_f32_16x16x32_bf16 v[144:147], a[0:3], v[192:195], v[160:163]
    ds_read_b64_tr_b16 a[48:49], v16 offset:32768
    ds_read_b64_tr_b16 a[50:51], v16 offset:36864
    v_exp_f32 v128, v128
    v_exp_f32 v129, v129
    v_mfma_f32_16x16x32_bf16 v[152:155], a[16:19], v[192:195], v[160:163]
    ds_read_b64_tr_b16 a[52:53], v17 offset:32768
    ds_read_b64_tr_b16 a[54:55], v17 offset:36864
    v_exp_f32 v130, v130
    v_cvt_pk_bf16_f32 v176, v128, v129
    v_mfma_f32_16x16x32_bf16 v[144:147], a[4:7], v[196:199], v[144:147]
    ds_read_b64_tr_b16 a[56:57], v18 offset:32768
    ds_read_b64_tr_b16 a[58:59], v18 offset:36864
    v_exp_f32 v131, v131
    v_exp_f32 v136, v136
    v_mfma_f32_16x16x32_bf16 v[152:155], a[20:23], v[196:199], v[152:155]
    ds_read_b64_tr_b16 a[60:61], v19 offset:32768
    ds_read_b64_tr_b16 a[62:63], v19 offset:36864
    v_cvt_pk_bf16_f32 v177, v130, v131
    v_exp_f32 v137, v137
    s_waitcnt lgkmcnt(8)
    v_mfma_f32_16x16x32_bf16 v[144:147], a[8:11], v[200:203], v[144:147]
    buffer_load_dwordx4 v25, s[32:35], s65 offen offset:1024 nt lds
    v_exp_f32 v138, v138
    v_cvt_pk_bf16_f32 v178, v136, v137
    v_mfma_f32_16x16x32_bf16 v[152:155], a[24:27], v[200:203], v[152:155]
    buffer_load_dwordx4 v26, s[32:35], s65 offen offset:2048 nt lds
    v_exp_f32 v139, v139
    v_mfma_f32_16x16x32_bf16 v[144:147], a[12:15], v[204:207], v[144:147]
    buffer_load_dwordx4 v27, s[32:35], s65 offen offset:3072 nt lds
    v_cvt_pk_bf16_f32 v179, v138, v139
    v_mfma_f32_16x16x32_bf16 v[152:155], a[28:31], v[204:207], v[152:155]
    s_mov_b32 s65, s64
    s_nop 0
    s_waitcnt lgkmcnt(0)
    v_mfma_f32_16x16x32_bf16 v[168:171], v[56:59], v[176:179], v[168:171]
    s_waitcnt vmcnt(12)
    s_barrier
    ds_read_b128 a[0:3], v8 offset:0
    v_mfma_f32_16x16x32_bf16 v[64:67], a[32:35], v[176:179], v[64:67]
    ds_read_b128 a[16:19], v8 offset:4096
    s_add_u32 m0, s57, 32768
    ds_read_b64_tr_b16 a[32:33], v12 offset:40960
    ds_read_b64_tr_b16 a[34:35], v12 offset:45056
    v_mfma_f32_16x16x32_bf16 v[72:75], a[36:39], v[176:179], v[72:75]
    ds_read_b128 a[4:7], v9 offset:0
    ds_read_b64_tr_b16 a[36:37], v13 offset:40960
    ds_read_b64_tr_b16 a[38:39], v13 offset:45056
    v_mfma_f32_16x16x32_bf16 v[80:83], a[40:43], v[176:179], v[80:83]
    ds_read_b128 a[20:23], v9 offset:4096
    buffer_load_dwordx4 v20, s[28:31], s64 offen offset:0 nt lds
    ds_read_b64_tr_b16 a[40:41], v14 offset:40960
    ds_read_b64_tr_b16 a[42:43], v14 offset:45056
    v_mfma_f32_16x16x32_bf16 v[88:91], a[44:47], v[176:179], v[88:91]
    ds_read_b128 a[8:11], v10 offset:0
    ds_read_b64_tr_b16 a[44:45], v15 offset:40960
    ds_read_b64_tr_b16 a[46:47], v15 offset:45056
    v_max3_f32 v48, v144, v145, v146
    v_mfma_f32_16x16x32_bf16 v[96:99], a[48:51], v[176:179], v[96:99]
    ds_read_b128 a[24:27], v10 offset:4096
    v_max3_f32 v48, v48, v147, v152
    v_mfma_f32_16x16x32_bf16 v[104:107], a[52:55], v[176:179], v[104:107]
    ds_read_b128 a[12:15], v11 offset:0
    v_max3_f32 v48, v48, v153, v154
    v_mfma_f32_16x16x32_bf16 v[112:115], a[56:59], v[176:179], v[112:115]
    ds_read_b128 a[28:31], v11 offset:4096
    v_max_f32 v48, v48, v155
    v_mfma_f32_16x16x32_bf16 v[120:123], a[60:63], v[176:179], v[120:123]
    v_cmp_lt_f32 vcc, 0x41000000, v48
    s_cbranch_vccnz L_rs_4_1
L_rsb_4_1:
    s_waitcnt lgkmcnt(8)
    v_mfma_f32_16x16x32_bf16 v[128:131], a[0:3], v[192:195], v[160:163]
    ds_read_b64_tr_b16 a[48:49], v16 offset:40960
    ds_read_b64_tr_b16 a[50:51], v16 offset:45056
    v_exp_f32 v144, v144
    v_exp_f32 v145, v145
    v_mfma_f32_16x16x32_bf16 v[136:139], a[16:19], v[192:195], v[160:163]
    ds_read_b64_tr_b16 a[52:53], v17 offset:40960
    ds_read_b64_tr_b16 a[54:55], v17 offset:45056
    v_exp_f32 v146, v146
    v_cvt_pk_bf16_f32 v176, v144, v145
    v_mfma_f32_16x16x32_bf16 v[128:131], a[4:7], v[196:199], v[128:131]
    ds_read_b64_tr_b16 a[56:57], v18 offset:40960
    ds_read_b64_tr_b16 a[58:59], v18 offset:45056
    v_exp_f32 v147, v147
    v_exp_f32 v152, v152
    v_mfma_f32_16x16x32_bf16 v[136:139], a[20:23], v[196:199], v[136:139]
    ds_read_b64_tr_b16 a[60:61], v19 offset:40960
    ds_read_b64_tr_b16 a[62:63], v19 offset:45056
    v_cvt_pk_bf16_f32 v177, v146, v147
    v_exp_f32 v153, v153
    s_waitcnt lgkmcnt(8)
    v_mfma_f32_16x16x32_bf16 v[128:131], a[8:11], v[200:203], v[128:131]
    buffer_load_dwordx4 v21, s[28:31], s64 offen offset:1024 nt lds
    v_exp_f32 v154, v154
    v_cvt_pk_bf16_f32 v178, v152, v153
    v_mfma_f32_16x16x32_bf16 v[136:139], a[24:27], v[200:203], v[136:139]
    buffer_load_dwordx4 v22, s[28:31], s64 offen offset:2048 nt lds
    v_exp_f32 v155, v155
    v_mfma_f32_16x16x32_bf16 v[128:131], a[12:15], v[204:207], v[128:131]
    buffer_load_dwordx4 v23, s[28:31], s64 offen offset:3072 nt lds
    v_cvt_pk_bf16_f32 v179, v154, v155
    v_mfma_f32_16x16x32_bf16 v[136:139], a[28:31], v[204:207], v[136:139]
    s_add_u32 s64, s64, 16384
    s_nop 0
    s_waitcnt lgkmcnt(0)
    v_mfma_f32_16x16x32_bf16 v[168:171], v[56:59], v[176:179], v[168:171]
    s_waitcnt vmcnt(12)
    s_barrier
    ds_read_b128 a[0:3], v8 offset:8192
    v_mfma_f32_16x16x32_bf16 v[64:67], a[32:35], v[176:179], v[64:67]
    ds_read_b128 a[16:19], v8 offset:12288
    s_add_u32 m0, s57, 81920
    ds_read_b64_tr_b16 a[32:33], v12 offset:0
    ds_read_b64_tr_b16 a[34:35], v12 offset:4096
    v_mfma_f32_16x16x32_bf16 v[72:75], a[36:39], v[176:179], v[72:75]
    ds_read_b128 a[4:7], v9 offset:8192
    ds_read_b64_tr_b16 a[36:37], v13 offset:0
    ds_read_b64_tr_b16 a[38:39], v13 offset:4096
    v_mfma_f32_16x16x32_bf16 v[80:83], a[40:43], v[176:179], v[80:83]
    ds_read_b128 a[20:23], v9 offset:12288
    buffer_load_dwordx4 v24, s[32:35], s65 offen offset:0 nt lds
    ds_read_b64_tr_b16 a[40:41], v14 offset:0
    ds_read_b64_tr_b16 a[42:43], v14 offset:4096
    v_mfma_f32_16x16x32_bf16 v[88:91], a[44:47], v[176:179], v[88:91]
    ds_read_b128 a[8:11], v10 offset:8192
    ds_read_b64_tr_b16 a[44:45], v15 offset:0
    ds_read_b64_tr_b16 a[46:47], v15 offset:4096
    v_max3_f32 v48, v128, v129, v130
    v_mfma_f32_16x16x32_bf16 v[96:99], a[48:51], v[176:179], v[96:99]
    ds_read_b128 a[24:27], v10 offset:12288
    v_max3_f32 v48, v48, v131, v136
    v_mfma_f32_16x16x32_bf16 v[104:107], a[52:55], v[176:179], v[104:107]
    ds_read_b128 a[12:15], v11 offset:8192
    v_max3_f32 v48, v48, v137, v138
    v_mfma_f32_16x16x32_bf16 v[112:115], a[56:59], v[176:179], v[112:115]
    ds_read_b128 a[28:31], v11 offset:12288
    v_max_f32 v48, v48, v139
    v_mfma_f32_16x16x32_bf16 v[120:123], a[60:63], v[176:179], v[120:123]
    v_cmp_lt_f32 vcc, 0x41000000, v48
    s_cbranch_vccnz L_rs_5_1
L_rsb_5_1:
    s_waitcnt lgkmcnt(8)
    v_mfma_f32_16x16x32_bf16 v[144:147], a[0:3], v[192:195], v[160:163]
    ds_read_b64_tr_b16 a[48:49], v16 offset:0
    ds_read_b64_tr_b16 a[50:51], v16 offset:4096
    v_exp_f32 v128, v128
    v_exp_f32 v129, v129
    v_mfma_f32_16x16x32_bf16 v[152:155], a[16:19], v[192:195], v[160:163]
    ds_read_b64_tr_b16 a[52:53], v17 offset:0
    ds_read_b64_tr_b16 a[54:55], v17 offset:4096
    v_exp_f32 v130, v130
    v_cvt_pk_bf16_f32 v176, v128, v129
    v_mfma_f32_16x16x32_bf16 v[144:147], a[4:7], v[196:199], v[144:147]
    ds_read_b64_tr_b16 a[56:57], v18 offset:0
    ds_read_b64_tr_b16 a[58:59], v18 offset:4096
    v_exp_f32 v131, v131
    v_exp_f32 v136, v136
    v_mfma_f32_16x16x32_bf16 v[152:155], a[20:23], v[196:199], v[152:155]
    ds_read_b64_tr_b16 a[60:61], v19 offset:0
    ds_read_b64_tr_b16 a[62:63], v19 offset:4096
    v_cvt_pk_bf16_f32 v177, v130, v131
    v_exp_f32 v137, v137
    s_waitcnt lgkmcnt(8)
    v_mfma_f32_16x16x32_bf16 v[144:147], a[8:11], v[200:203], v[144:147]
    buffer_load_dwordx4 v25, s[32:35], s65 offen offset:1024 nt lds
    v_exp_f32 v138, v138
    v_cvt_pk_bf16_f32 v178, v136, v137
    v_mfma_f32_16x16x32_bf16 v[152:155], a[24:27], v[200:203], v[152:155]
    buffer_load_dwordx4 v26, s[32:35], s65 offen offset:2048 nt lds
    v_exp_f32 v139, v139
    v_mfma_f32_16x16x32_bf16 v[144:147], a[12:15], v[204:207], v[144:147]
    buffer_load_dwordx4 v27, s[32:35], s65 offen offset:3072 nt lds
    v_cvt_pk_bf16_f32 v179, v138, v139
    v_mfma_f32_16x16x32_bf16 v[152:155], a[28:31], v[204:207], v[152:155]
    s_mov_b32 s65, s64
    s_add_u32 s59, s59, 1
    s_cmp_lt_u32 s59, 4
    s_nop 0
    s_cbranch_scc1 L_a_1
    s_branch L_last_1
L_x:
    s_lshl_b32 s61, s59, 17
    s_lshl_b32 s60, s59, 14
    s_add_u32 s60, s60, 98304
    s_add_u32 m0, s60, s57
    s_or_b32 s60, s59, s72
    buffer_load_dwordx4 v36, s[36:39], s61 offen offset:0  lds
    buffer_load_dwordx4 v37, s[36:39], s61 offen offset:1024  lds
    buffer_load_dwordx4 v38, s[36:39], s61 offen offset:2048  lds
    buffer_load_dwordx4 v39, s[36:39], s61 offen offset:3072  lds
    s_cbranch_scc0 L_x_tag
    s_cmp_eq_u32 s59, 3
    s_cbranch_scc1 L_x_pf
    s_setpc_b64 s[62:63]
L_x_tag:
    s_mov_b32 s60, 0x9e3779b9
    v_add_co_u32 v184, vcc, 0x7f4a7c15, v184
    v_mov_b32 v1, s60
    v_mov_b32 v2, 0
    v_addc_co_u32 v185, vcc, v1, v185, vcc
    v_or_b32 v184, 1, v184
    v_or_b32 v185, 1, v185
    s_mov_b64 exec, 1
    buffer_store_dwordx2 v[184:185], v2, s[48:51], 0 offen sc1
    buffer_store_dwordx2 v[184:185], v50, s[40:43], 0 offen sc1
    s_mov_b64 exec, -1
    s_setpc_b64 s[62:63]
L_x_pf:
    s_getpc_b64 s[60:61]
L_pcref2:
    v_lshlrev_b32 v1, 3, v53
    v_lshl_add_u32 v1, s52, 13, v1
    v_min_u32 v1, L_tail_end - L_pcref2 - 4, v1
    global_load_dword v186, v1, s[60:61]
    s_setpc_b64 s[62:63]
L_hot_end:
L_last_2:
    s_waitcnt lgkmcnt(0)
    v_mfma_f32_16x16x32_bf16 v[168:171], v[56:59], v[176:179], v[168:171]
    s_waitcnt vmcnt(12)
    s_barrier
    ds_read_b128 a[0:3], v8 offset:16384
    v_cvt_pk_bf16_f32 v181, v134, v135
    v_mfma_f32_16x16x32_bf16 v[64:67], a[32:35], v[176:179], v[64:67]
    s_add_u32 m0, s57, 0
    v_exp_f32 v140, v140
    v_mfma_f32_16x16x32_bf16 v[72:75], a[36:39], v[176:179], v[72:75]
    ds_read_b128 a[16:19], v8 offset:20480
    ds_read_b128 a[4:7], v9 offset:16384
    v_mfma_f32_16x16x32_bf16 v[80:83], a[40:43], v[176:179], v[80:83]
    v_exp_f32 v141, v141
    v_mfma_f32_16x16x32_bf16 v[88:91], a[44:47], v[176:179], v[88:91]
    ds_read_b128 a[20:23], v9 offset:20480
    v_cvt_pk_bf16_f32 v182, v140, v141
    v_mfma_f32_16x16x32_bf16 v[96:99], a[48:51], v[176:179], v[96:99]
    v_exp_f32 v142, v142
    v_mfma_f32_16x16x32_bf16 v[104:107], a[52:55], v[176:179], v[104:107]
    v_exp_f32 v143, v143
    v_mfma_f32_16x16x32_bf16 v[112:115], a[56:59], v[176:179], v[112:115]
    ds_read_b128 a[8:11], v10 offset:16384
    v_cvt_pk_bf16_f32 v183, v142, v143
    v_mfma_f32_16x16x32_bf16 v[120:123], a[60:63], v[176:179], v[120:123]
    ds_read_b128 a[24:27], v10 offset:20480
    v_max3_f32 v48, v144, v145, v146
    v_mfma_f32_16x16x32_bf16 v[172:175], v[56:59], v[180:183], v[172:175]
    ds_read_b128 a[12:15], v11 offset:16384
    v_max3_f32 v49, v148, v149, v150
    v_mfma_f32_16x16x32_bf16 v[68:71], a[32:35], v[180:183], v[68:71]
    ds_read_b128 a[28:31], v11 offset:20480
    v_max3_f32 v48, v48, v147, v152
    v_mfma_f32_16x16x32_bf16 v[76:79], a[36:39], v[180:183], v[76:79]
    ds_read_b64_tr_b16 a[32:33], v12 offset:8192
    v_max3_f32 v49, v49, v151, v156
    v_mfma_f32_16x16x32_bf16 v[84:87], a[40:43], v[180:183], v[84:87]
    ds_read_b64_tr_b16 a[34:35], v12 offset:12288
    buffer_load_dwordx4 v20, s[28:31], s64 offen offset:0 nt lds
    v_max3_f32 v48, v48, v153, v154
    v_mfma_f32_16x16x32_bf16 v[92:95], a[44:47], v[180:183], v[92:95]
    ds_read_b64_tr_b16 a[36:37], v13 offset:8192
    v_max3_f32 v49, v49, v157, v158
    v_mfma_f32_16x16x32_bf16 v[100:103], a[48:51], v[180:183], v[100:103]
    ds_read_b64_tr_b16 a[38:39], v13 offset:12288
    v_max_f32 v49, v49, v159
    v_mfma_f32_16x16x32_bf16 v[108:111], a[52:55], v[180:183], v[108:111]
    ds_read_b64_tr_b16 a[40:41], v14 offset:8192
    v_max3_f32 v48, v48, v155, v49
    v_mfma_f32_16x16x32_bf16 v[116:119], a[56:59], v[180:183], v[116:119]
    ds_read_b64_tr_b16 a[42:43], v14 offset:12288
    v_cmp_lt_f32 vcc, 0x41000000, v48
    v_mfma_f32_16x16x32_bf16 v[124:127], a[60:63], v[180:183], v[124:127]
    ds_read_b64_tr_b16 a[44:45], v15 offset:8192
    ds_read_b64_tr_b16 a[46:47], v15 offset:12288
    s_cbranch_vccnz L_rs_6_2
L_rsb_6_2:
    s_waitcnt lgkmcnt(7)
    v_mfma_f32_16x16x32_bf16 v[128:131], a[0:3], v[192:195], v[160:163]
    buffer_load_dwordx4 v21, s[28:31], s64 offen offset:1024 nt lds
    v_exp_f32 v144, v144
    v_mfma_f32_16x16x32_bf16 v[132:135], a[0:3], v[208:211], v[164:167]
    v_exp_f32 v145, v145
    v_mfma_f32_16x16x32_bf16 v[136:139], a[16:19], v[192:195], v[160:163]
    ds_read_b64_tr_b16 a[48:49], v16 offset:8192
    ds_read_b64_tr_b16 a[50:51], v16 offset:12288
    v_mfma_f32_16x16x32_bf16 v[140:143], a[16:19], v[208:211], v[164:167]
    v_exp_f32 v146, v146
    v_mfma_f32_16x16x32_bf16 v[128:131], a[4:7], v[196:199], v[128:131]
    v_exp_f32 v147, v147
    v_mfma_f32_16x16x32_bf16 v[132:135], a[4:7], v[212:215], v[132:135]
    ds_read_b64_tr_b16 a[52:53], v17 offset:8192
    ds_read_b64_tr_b16 a[54:55], v17 offset:12288
    v_cvt_pk_bf16_f32 v176, v144, v145
    v_mfma_f32_16x16x32_bf16 v[136:139], a[20:23], v[196:199], v[136:139]
    buffer_load_dwordx4 v22, s[28:31], s64 offen offset:2048 nt lds
    v_exp_f32 v152, v152
    v_mfma_f32_16x16x32_bf16 v[140:143], a[20:23], v[212:215], v[140:143]
    v_exp_f32 v153, v153
    v_mfma_f32_16x16x32_bf16 v[128:131], a[8:11], v[200:203], v[128:131]
    ds_read_b64_tr_b16 a[56:57], v18 offset:8192
    ds_read_b64_tr_b16 a[58:59], v18 offset:12288
    v_cvt_pk_bf16_f32 v177, v146, v147
    v_mfma_f32_16x16x32_bf16 v[132:135], a[8:11], v[216:219], v[132:135]
    v_exp_f32 v154, v154
    v_mfma_f32_16x16x32_bf16 v[136:139], a[24:27], v[200:203], v[136:139]
    v_exp_f32 v155, v155
    v_mfma_f32_16x16x32_bf16 v[140:143], a[24:27], v[216:219], v[140:143]
    ds_read_b64_tr_b16 a[60:61], v19 offset:8192
    ds_read_b64_tr_b16 a[62:63], v19 offset:12288
    v_cvt_pk_bf16_f32 v178, v152, v153
    v_mfma_f32_16x16x32_bf16 v[128:131], a[12:15], v[204:207], v[128:131]
    v_exp_f32 v148, v148
    v_cvt_pk_bf16_f32 v179, v154, v155
    v_mfma_f32_16x16x32_bf16 v[132:135], a[12:15], v[220:223], v[132:135]
    buffer_load_dwordx4 v23, s[28:31], s64 offen offset:3072 nt lds
    v_exp_f32 v149, v149
    v_mfma_f32_16x16x32_bf16 v[136:139], a[28:31], v[204:207], v[136:139]
    v_exp_f32 v150, v150
    v_mfma_f32_16x16x32_bf16 v[140:143], a[28:31], v[220:223], v[140:143]
    v_mov_b32 v2, 0
    v_exp_f32 v151, v151
    v_cvt_pk_bf16_f32 v180, v148, v149
    s_waitcnt lgkmcnt(0)
    v_mfma_f32_16x16x32_bf16 v[168:171], v[56:59], v[176:179], v[168:171]
    s_waitcnt vmcnt(12)
    s_barrier
    ds_read_b128 a[0:3], v8 offset:24576
    v_cvt_pk_bf16_f32 v181, v150, v151
    v_mfma_f32_16x16x32_bf16 v[64:67], a[32:35], v[176:179], v[64:67]
    s_add_u32 m0, s57, 49152
    v_exp_f32 v156, v156
    v_mfma_f32_16x16x32_bf16 v[72:75], a[36:39], v[176:179], v[72:75]
    ds_read_b128 a[16:19], v8 offset:28672
    ds_read_b128 a[4:7], v9 offset:24576
    v_mfma_f32_16x16x32_bf16 v[80:83], a[40:43], v[176:179], v[80:83]
    v_exp_f32 v157, v157
    v_mfma_f32_16x16x32_bf16 v[88:91], a[44:47], v[176:179], v[88:91]
    ds_read_b128 a[20:23], v9 offset:28672
    v_cvt_pk_bf16_f32 v182, v156, v157
    v_mfma_f32_16x16x32_bf16 v[96:99], a[48:51], v[176:179], v[96:99]
    v_exp_f32 v158, v158
    v_mfma_f32_16x16x32_bf16 v[104:107], a[52:55], v[176:179], v[104:107]
    v_exp_f32 v159, v159
    v_mfma_f32_16x16x32_bf16 v[112:115], a[56:59], v[176:179], v[112:115]
    ds_read_b128 a[8:11], v10 offset:24576
    v_cvt_pk_bf16_f32 v183, v158, v159
    v_mfma_f32_16x16x32_bf16 v[120:123], a[60:63], v[176:179], v[120:123]
    ds_read_b128 a[24:27], v10 offset:28672
    v_max3_f32 v48, v128, v129, v130
    v_mfma_f32_16x16x32_bf16 v[172:175], v[56:59], v[180:183], v[172:175]
    ds_read_b128 a[12:15], v11 offset:24576
    v_max3_f32 v49, v132, v133, v134
    v_mfma_f32_16x16x32_bf16 v[68:71], a[32:35], v[180:183], v[68:71]
    ds_read_b128 a[28:31], v11 offset:28672
    v_max3_f32 v48, v48, v131, v136
    v_mfma_f32_16x16x32_bf16 v[76:79], a[36:39], v[180:183], v[76:79]
    ds_read_b64_tr_b16 a[32:33], v12 offset:16384
    v_max3_f32 v49, v49, v135, v140
    v_mfma_f32_16x16x32_bf16 v[84:87], a[40:43], v[180:183], v[84:87]
    ds_read_b64_tr_b16 a[34:35], v12 offset:20480
    buffer_load_dwordx4 v24, s[32:35], s65 offen offset:0 nt lds
    v_max3_f32 v48, v48, v137, v138
    v_mfma_f32_16x16x32_bf16 v[92:95], a[44:47], v[180:183], v[92:95]
    ds_read_b64_tr_b16 a[36:37], v13 offset:16384
    v_max3_f32 v49, v49, v141, v142
    v_mfma_f32_16x16x32_bf16 v[100:103], a[48:51], v[180:183], v[100:103]
    ds_read_b64_tr_b16 a[38:39], v13 offset:20480
    v_max_f32 v49, v49, v143
    v_mfma_f32_16x16x32_bf16 v[108:111], a[52:55], v[180:183], v[108:111]
    ds_read_b64_tr_b16 a[40:41], v14 offset:16384
    v_max3_f32 v48, v48, v139, v49
    v_mfma_f32_16x16x32_bf16 v[116:119], a[56:59], v[180:183], v[116:119]
    ds_read_b64_tr_b16 a[42:43], v14 offset:20480
    v_cmp_lt_f32 vcc, 0x41000000, v48
    v_mfma_f32_16x16x32_bf16 v[124:127], a[60:63], v[180:183], v[124:127]
    ds_read_b64_tr_b16 a[44:45], v15 offset:16384
    ds_read_b64_tr_b16 a[46:47], v15 offset:20480
    s_cbranch_vccnz L_rs_7_2
L_rsb_7_2:
    s_waitcnt lgkmcnt(7)
    v_mfma_f32_16x16x32_bf16 v[144:147], a[0:3], v[192:195], v[160:163]
    buffer_load_dwordx4 v25, s[32:35], s65 offen offset:1024 nt lds
    v_exp_f32 v128, v128
    v_mfma_f32_16x16x32_bf16 v[148:151], a[0:3], v[208:211], v[164:167]
    v_exp_f32 v129, v129
    v_mfma_f32_16x16x32_bf16 v[152:155], a[16:19], v[192:195], v[160:163]
    ds_read_b64_tr_b16 a[48:49], v16 offset:16384
    ds_read_b64_tr_b16 a[50:51], v16 offset:20480
    v_mfma_f32_16x16x32_bf16 v[156:159], a[16:19], v[208:211], v[164:167]
    v_exp_f32 v130, v130
    v_mfma_f32_16x16x32_bf16 v[144:147], a[4:7], v[196:199], v[144:147]
    v_exp_f32 v131, v131
    v_mfma_f32_16x16x32_bf16 v[148:151], a[4:7], v[212:215], v[148:151]
    ds_read_b64_tr_b16 a[52:53], v17 offset:16384
    ds_read_b64_tr_b16 a[54:55], v17 offset:20480
    v_cvt_pk_bf16_f32 v176, v128, v129
    v_mfma_f32_16x16x32_bf16 v[152:155], a[20:23], v[196:199], v[152:155]
    buffer_load_dwordx4 v26, s[32:35], s65 offen offset:2048 nt lds
    v_exp_f32 v136, v136
    v_mfma_f32_16x16x32_bf16 v[156:159], a[20:23], v[212:215], v[156:159]
    v_exp_f32 v137, v137
    v_mfma_f32_16x16x32_bf16 v[144:147], a[8:11], v[200:203], v[144:147]
    ds_read_b64_tr_b16 a[56:57], v18 offset:16384
    ds_read_b64_tr_b16 a[58:59], v18 offset:20480
    v_cvt_pk_bf16_f32 v177, v130, v131
    v_mfma_f32_16x16x32_bf16 v[148:151], a[8:11], v[216:219], v[148:151]
    v_exp_f32 v138, v138
    v_mfma_f32_16x16x32_bf16 v[152:155], a[24:27], v[200:203], v[152:155]
    v_exp_f32 v139, v139
    v_mfma_f32_16x16x32_bf16 v[156:159], a[24:27], v[216:219], v[156:159]
    ds_read_b64_tr_b16 a[60:61], v19 offset:16384
    ds_read_b64_tr_b16 a[62:63], v19 offset:20480
    v_cvt_pk_bf16_f32 v178, v136, v137
    v_mfma_f32_16x16x32_bf16 v[144:147], a[12:15], v[204:207], v[144:147]
    v_exp_f32 v132, v132
    v_cvt_pk_bf16_f32 v179, v138, v139
    v_mfma_f32_16x16x32_bf16 v[148:151], a[12:15], v[220:223], v[148:151]
    buffer_load_dwordx4 v27, s[32:35], s65 offen offset:3072 nt lds
    v_exp_f32 v133, v133
    v_mfma_f32_16x16x32_bf16 v[152:155], a[28:31], v[204:207], v[152:155]
    v_exp_f32 v134, v134
    v_mfma_f32_16x16x32_bf16 v[156:159], a[28:31], v[220:223], v[156:159]
    buffer_load_dwordx2 v[184:185], v2, s[48:51], 0 offen sc1
    s_mov_b32 s64, 524288
    v_exp_f32 v135, v135
    v_cvt_pk_bf16_f32 v180, v132, v133
    s_waitcnt lgkmcnt(0)
    v_mfma_f32_16x16x32_bf16 v[168:171], v[56:59], v[176:179], v[168:171]
    s_waitcnt vmcnt(12)
    s_barrier
    ds_read_b128 a[0:3], v8 offset:32768
    v_cvt_pk_bf16_f32 v181, v134, v135
    v_mfma_f32_16x16x32_bf16 v[64:67], a[32:35], v[176:179], v[64:67]
    s_add_u32 m0, s57, 16384
    v_exp_f32 v140, v140
    v_mfma_f32_16x16x32_bf16 v[72:75], a[36:39], v[176:179], v[72:75]
    ds_read_b128 a[16:19], v8 offset:36864
    ds_read_b128 a[4:7], v9 offset:32768
    v_mfma_f32_16x16x32_bf16 v[80:83], a[40:43], v[176:179], v[80:83]
    v_exp_f32 v141, v141
    v_mfma_f32_16x16x32_bf16 v[88:91], a[44:47], v[176:179], v[88:91]
    ds_read_b128 a[20:23], v9 offset:36864
    v_cvt_pk_bf16_f32 v182, v140, v141
    v_mfma_f32_16x16x32_bf16 v[96:99], a[48:51], v[176:179], v[96:99]
    v_exp_f32 v142, v142
    v_mfma_f32_16x16x32_bf16 v[104:107], a[52:55], v[176:179], v[104:107]
    v_exp_f32 v143, v143
    v_mfma_f32_16x16x32_bf16 v[112:115], a[56:59], v[176:179], v[112:115]
    ds_read_b128 a[8:11], v10 offset:32768
    v_cvt_pk_bf16_f32 v183, v142, v143
    v_mfma_f32_16x16x32_bf16 v[120:123], a[60:63], v[176:179], v[120:123]
    ds_read_b128 a[24:27], v10 offset:36864
    v_max3_f32 v48, v144, v145, v146
    v_mfma_f32_16x16x32_bf16 v[172:175], v[56:59], v[180:183], v[172:175]
    ds_read_b128 a[12:15], v11 offset:32768
    v_max3_f32 v49, v148, v149, v150
    v_mfma_f32_16x16x32_bf16 v[68:71], a[32:35], v[180:183], v[68:71]
    ds_read_b128 a[28:31], v11 offset:36864
    v_max3_f32 v48, v48, v147, v152
    v_mfma_f32_16x16x32_bf16 v[76:79], a[36:39], v[180:183], v[76:79]
    ds_read_b64_tr_b16 a[32:33], v12 offset:24576
    v_max3_f32 v49, v49, v151, v156
    v_mfma_f32_16x16x32_bf16 v[84:87], a[40:43], v[180:183], v[84:87]
    ds_read_b64_tr_b16 a[34:35], v12 offset:28672
    buffer_load_dwordx4 v36, s[36:39], s64 offen offset:0  lds
    v_max3_f32 v48, v48, v153, v154
    v_mfma_f32_16x16x32_bf16 v[92:95], a[44:47], v[180:183], v[92:95]
    ds_read_b64_tr_b16 a[36:37], v13 offset:24576
    v_max3_f32 v49, v49, v157, v158
    v_mfma_f32_16x16x32_bf16 v[100:103], a[48:51], v[180:183], v[100:103]
    ds_read_b64_tr_b16 a[38:39], v13 offset:28672
    v_max_f32 v49, v49, v159
    v_mfma_f32_16x16x32_bf16 v[108:111], a[52:55], v[180:183], v[108:111]
    ds_read_b64_tr_b16 a[40:41], v14 offset:24576
    v_max3_f32 v48, v48, v155, v49
    v_mfma_f32_16x16x32_bf16 v[116:119], a[56:59], v[180:183], v[116:119]
    ds_read_b64_tr_b16 a[42:43], v14 offset:28672
    v_cmp_lt_f32 vcc, 0x41000000, v48
    v_mfma_f32_16x16x32_bf16 v[124:127], a[60:63], v[180:183], v[124:127]
    ds_read_b64_tr_b16 a[44:45], v15 offset:24576
    ds_read_b64_tr_b16 a[46:47], v15 offset:28672
    s_cbranch_vccnz L_rs_8_2
L_rsb_8_2:
    s_waitcnt lgkmcnt(7)
    v_mfma_f32_16x16x32_bf16 v[128:131], a[0:3], v[192:195], v[160:163]
    buffer_load_dwordx4 v37, s[36:39], s64 offen offset:1024  lds
    v_exp_f32 v144, v144
    v_mfma_f32_16x16x32_bf16 v[132:135], a[0:3], v[208:211], v[164:167]
    v_exp_f32 v145, v145
    v_mfma_f32_16x16x32_bf16 v[136:139], a[16:19], v[192:195], v[160:163]
    ds_read_b64_tr_b16 a[48:49], v16 offset:24576
    ds_read_b64_tr_b16 a[50:51], v16 offset:28672
    v_mfma_f32_16x16x32_bf16 v[140:143], a[16:19], v[208:211], v[164:167]
    v_exp_f32 v146, v146
    v_mfma_f32_16x16x32_bf16 v[128:131], a[4:7], v[196:199], v[128:131]
    v_exp_f32 v147, v147
    v_mfma_f32_16x16x32_bf16 v[132:135], a[4:7], v[212:215], v[132:135]
    ds_read_b64_tr_b16 a[52:53], v17 offset:24576
    ds_read_b64_tr_b16 a[54:55], v17 offset:28672
    v_cvt_pk_bf16_f32 v176, v144, v145
    v_mfma_f32_16x16x32_bf16 v[136:139], a[20:23], v[196:199], v[136:139]
    buffer_load_dwordx4 v38, s[36:39], s64 offen offset:2048  lds
    v_exp_f32 v152, v152
    v_mfma_f32_16x16x32_bf16 v[140:143], a[20:23], v[212:215], v[140:143]
    v_exp_f32 v153, v153
    v_mfma_f32_16x16x32_bf16 v[128:131], a[8:11], v[200:203], v[128:131]
    ds_read_b64_tr_b16 a[56:57], v18 offset:24576
    ds_read_b64_tr_b16 a[58:59], v18 offset:28672
    v_cvt_pk_bf16_f32 v177, v146, v147
    v_mfma_f32_16x16x32_bf16 v[132:135], a[8:11], v[216:219], v[132:135]
    v_exp_f32 v154, v154
    v_mfma_f32_16x16x32_bf16 v[136:139], a[24:27], v[200:203], v[136:139]
    v_exp_f32 v155, v155
    v_mfma_f32_16x16x32_bf16 v[140:143], a[24:27], v[216:219], v[140:143]
    ds_read_b64_tr_b16 a[60:61], v19 offset:24576
    ds_read_b64_tr_b16 a[62:63], v19 offset:28672
    v_cvt_pk_bf16_f32 v178, v152, v153
    v_mfma_f32_16x16x32_bf16 v[128:131], a[12:15], v[204:207], v[128:131]
    v_exp_f32 v148, v148
    v_cvt_pk_bf16_f32 v179, v154, v155
    v_mfma_f32_16x16x32_bf16 v[132:135], a[12:15], v[220:223], v[132:135]
    buffer_load_dwordx4 v39, s[36:39], s64 offen offset:3072  lds
    v_exp_f32 v149, v149
    v_mfma_f32_16x16x32_bf16 v[136:139], a[28:31], v[204:207], v[136:139]
    v_exp_f32 v150, v150
    v_mfma_f32_16x16x32_bf16 v[140:143], a[28:31], v[220:223], v[140:143]
    s_mov_b32 s64, 655360
    v_exp_f32 v151, v151
    v_cvt_pk_bf16_f32 v180, v148, v149
    s_waitcnt lgkmcnt(0)
    v_mfma_f32_16x16x32_bf16 v[168:171], v[56:59], v[176:179], v[168:171]
    s_waitcnt vmcnt(12)
    s_barrier
    ds_read_b128 a[0:3], v8 offset:40960
    v_cvt_pk_bf16_f32 v181, v150, v151
    v_mfma_f32_16x16x32_bf16 v[64:67], a[32:35], v[176:179], v[64:67]
    s_add_u32 m0, s57, 65536
    v_exp_f32 v156, v156
    v_mfma_f32_16x16x32_bf16 v[72:75], a[36:39], v[176:179], v[72:75]
    ds_read_b128 a[16:19], v8 offset:45056
    ds_read_b128 a[4:7], v9 offset:40960
    v_mfma_f32_16x16x32_bf16 v[80:83], a[40:43], v[176:179], v[80:83]
    v_exp_f32 v157, v157
    v_mfma_f32_16x16x32_bf16 v[88:91], a[44:47], v[176:179], v[88:91]
    ds_read_b128 a[20:23], v9 offset:45056
    v_cvt_pk_bf16_f32 v182, v156, v157
    v_mfma_f32_16x16x32_bf16 v[96:99], a[48:51], v[176:179], v[96:99]
    v_exp_f32 v158, v158
    v_mfma_f32_16x16x32_bf16 v[104:107], a[52:55], v[176:179], v[104:107]
    v_exp_f32 v159, v159
    v_mfma_f32_16x16x32_bf16 v[112:115], a[56:59], v[176:179], v[112:115]
    ds_read_b128 a[8:11], v10 offset:40960
    v_cvt_pk_bf16_f32 v183, v158, v159
    v_mfma_f32_16x16x32_bf16 v[120:123], a[60:63], v[176:179], v[120:123]
    ds_read_b128 a[24:27], v10 offset:45056
    v_max3_f32 v48, v128, v129, v130
    v_mfma_f32_16x16x32_bf16 v[172:175], v[56:59], v[180:183], v[172:175]
    ds_read_b128 a[12:15], v11 offset:40960
    v_max3_f32 v49, v132, v133, v134
    v_mfma_f32_16x16x32_bf16 v[68:71], a[32:35], v[180:183], v[68:71]
    ds_read_b128 a[28:31], v11 offset:45056
    v_max3_f32 v48, v48, v131, v136
    v_mfma_f32_16x16x32_bf16 v[76:79], a[36:39], v[180:183], v[76:79]
    ds_read_b64_tr_b16 a[32:33], v12 offset:32768
    v_max3_f32 v49, v49, v135, v140
    v_mfma_f32_16x16x32_bf16 v[84:87], a[40:43], v[180:183], v[84:87]
    ds_read_b64_tr_b16 a[34:35], v12 offset:36864
    buffer_load_dwordx4 v36, s[36:39], s64 offen offset:0  lds
    v_max3_f32 v48, v48, v137, v138
    v_mfma_f32_16x16x32_bf16 v[92:95], a[44:47], v[180:183], v[92:95]
    ds_read_b64_tr_b16 a[36:37], v13 offset:32768
    v_max3_f32 v49, v49, v141, v142
    v_mfma_f32_16x16x32_bf16 v[100:103], a[48:51], v[180:183], v[100:103]
    ds_read_b64_tr_b16 a[38:39], v13 offset:36864
    v_max_f32 v49, v49, v143
    v_mfma_f32_16x16x32_bf16 v[108:111], a[52:55], v[180:183], v[108:111]
    ds_read_b64_tr_b16 a[40:41], v14 offset:32768
    v_max3_f32 v48, v48, v139, v49
    v_mfma_f32_16x16x32_bf16 v[116:119], a[56:59], v[180:183], v[116:119]
    ds_read_b64_tr_b16 a[42:43], v14 offset:36864
    v_cmp_lt_f32 vcc, 0x41000000, v48
    v_mfma_f32_16x16x32_bf16 v[124:127], a[60:63], v[180:183], v[124:127]
    ds_read_b64_tr_b16 a[44:45], v15 offset:32768
    ds_read_b64_tr_b16 a[46:47], v15 offset:36864
    s_cbranch_vccnz L_rs_9_2
L_rsb_9_2:
    s_waitcnt lgkmcnt(7)
    v_mfma_f32_16x16x32_bf16 v[144:147], a[0:3], v[192:195], v[160:163]
    buffer_load_dwordx4 v37, s[36:39], s64 offen offset:1024  lds
    v_exp_f32 v128, v128
    v_mfma_f32_16x16x32_bf16 v[148:151], a[0:3], v[208:211], v[164:167]
    v_exp_f32 v129, v129
    v_mfma_f32_16x16x32_bf16 v[152:155], a[16:19], v[192:195], v[160:163]
    ds_read_b64_tr_b16 a[48:49], v16 offset:32768
    ds_read_b64_tr_b16 a[50:51], v16 offset:36864
    v_mfma_f32_16x16x32_bf16 v[156:159], a[16:19], v[208:211], v[164:167]
    v_exp_f32 v130, v130
    v_mfma_f32_16x16x32_bf16 v[144:147], a[4:7], v[196:199], v[144:147]
    v_exp_f32 v131, v131
    v_mfma_f32_16x16x32_bf16 v[148:151], a[4:7], v[212:215], v[148:151]
    ds_read_b64_tr_b16 a[52:53], v17 offset:32768
    ds_read_b64_tr_b16 a[54:55], v17 offset:36864
    v_cvt_pk_bf16_f32 v176, v128, v129
    v_mfma_f32_16x16x32_bf16 v[152:155], a[20:23], v[196:199], v[152:155]
    buffer_load_dwordx4 v38, s[36:39], s64 offen offset:2048  lds
    v_exp_f32 v136, v136
    v_mfma_f32_16x16x32_bf16 v[156:159], a[20:23], v[212:215], v[156:159]
    v_exp_f32 v137, v137
    v_mfma_f32_16x16x32_bf16 v[144:147], a[8:11], v[200:203], v[144:147]
    ds_read_b64_tr_b16 a[56:57], v18 offset:32768
    ds_read_b64_tr_b16 a[58:59], v18 offset:36864
    v_cvt_pk_bf16_f32 v177, v130, v131
    v_mfma_f32_16x16x32_bf16 v[148:151], a[8:11], v[216:219], v[148:151]
    v_exp_f32 v138, v138
    v_mfma_f32_16x16x32_bf16 v[152:155], a[24:27], v[200:203], v[152:155]
    v_exp_f32 v139, v139
    v_mfma_f32_16x16x32_bf16 v[156:159], a[24:27], v[216:219], v[156:159]
    ds_read_b64_tr_b16 a[60:61], v19 offset:32768
    ds_read_b64_tr_b16 a[62:63], v19 offset:36864
    v_cvt_pk_bf16_f32 v178, v136, v137
    v_mfma_f32_16x16x32_bf16 v[144:147], a[12:15], v[204:207], v[144:147]
    v_exp_f32 v132, v132
    v_cvt_pk_bf16_f32 v179, v138, v139
    v_mfma_f32_16x16x32_bf16 v[148:151], a[12:15], v[220:223], v[148:151]
    buffer_load_dwordx4 v39, s[36:39], s64 offen offset:3072  lds
    v_exp_f32 v133, v133
    v_mfma_f32_16x16x32_bf16 v[152:155], a[28:31], v[204:207], v[152:155]
    v_exp_f32 v134, v134
    v_mfma_f32_16x16x32_bf16 v[156:159], a[28:31], v[220:223], v[156:159]
    s_mov_b32 s64, 786432
    v_exp_f32 v135, v135
    v_cvt_pk_bf16_f32 v180, v132, v133
    s_waitcnt lgkmcnt(0)
    v_mfma_f32_16x16x32_bf16 v[168:171], v[56:59], v[176:179], v[168:171]
    s_waitcnt vmcnt(12)
    s_barrier
    ds_read_b128 a[0:3], v8 offset:0
    v_cvt_pk_bf16_f32 v181, v134, v135
    v_mfma_f32_16x16x32_bf16 v[64:67], a[32:35], v[176:179], v[64:67]
    s_add_u32 m0, s57, 32768
    v_exp_f32 v140, v140
    v_mfma_f32_16x16x32_bf16 v[72:75], a[36:39], v[176:179], v[72:75]
    ds_read_b128 a[16:19], v8 offset:4096
    ds_read_b128 a[4:7], v9 offset:0
    v_mfma_f32_16x16x32_bf16 v[80:83], a[40:43], v[176:179], v[80:83]
    v_exp_f32 v141, v141
    v_mfma_f32_16x16x32_bf16 v[88:91], a[44:47], v[176:179], v[88:91]
    ds_read_b128 a[20:23], v9 offset:4096
    v_cvt_pk_bf16_f32 v182, v140, v141
    v_mfma_f32_16x16x32_bf16 v[96:99], a[48:51], v[176:179], v[96:99]
    v_exp_f32 v142, v142
    v_mfma_f32_16x16x32_bf16 v[104:107], a[52:55], v[176:179], v[104:107]
    v_exp_f32 v143, v143
    v_mfma_f32_16x16x32_bf16 v[112:115], a[56:59], v[176:179], v[112:115]
    ds_read_b128 a[8:11], v10 offset:0
    v_cvt_pk_bf16_f32 v183, v142, v143
    v_mfma_f32_16x16x32_bf16 v[120:123], a[60:63], v[176:179], v[120:123]
    ds_read_b128 a[24:27], v10 offset:4096
    v_max3_f32 v48, v144, v145, v146
    v_mfma_f32_16x16x32_bf16 v[172:175], v[56:59], v[180:183], v[172:175]
    ds_read_b128 a[12:15], v11 offset:0
    v_max3_f32 v49, v148, v149, v150
    v_mfma_f32_16x16x32_bf16 v[68:71], a[32:35], v[180:183], v[68:71]
    ds_read_b128 a[28:31], v11 offset:4096
    v_max3_f32 v48, v48, v147, v152
    v_mfma_f32_16x16x32_bf16 v[76:79], a[36:39], v[180:183], v[76:79]
    ds_read_b64_tr_b16 a[32:33], v12 offset:40960
    v_max3_f32 v49, v49, v151, v156
    v_mfma_f32_16x16x32_bf16 v[84:87], a[40:43], v[180:183], v[84:87]
    ds_read_b64_tr_b16 a[34:35], v12 offset:45056
    buffer_load_dwordx4 v36, s[36:39], s64 offen offset:0  lds
    v_max3_f32 v48, v48, v153, v154
    v_mfma_f32_16x16x32_bf16 v[92:95], a[44:47], v[180:183], v[92:95]
    ds_read_b64_tr_b16 a[36:37], v13 offset:40960
    v_max3_f32 v49, v49, v157, v158
    v_mfma_f32_16x16x32_bf16 v[100:103], a[48:51], v[180:183], v[100:103]
    ds_read_b64_tr_b16 a[38:39], v13 offset:45056
    v_max_f32 v49, v49, v159
    v_mfma_f32_16x16x32_bf16 v[108:111], a[52:55], v[180:183], v[108:111]
    ds_read_b64_tr_b16 a[40:41], v14 offset:40960
    v_max3_f32 v48, v48, v155, v49
    v_mfma_f32_16x16x32_bf16 v[116:119], a[56:59], v[180:183], v[116:119]
    ds_read_b64_tr_b16 a[42:43], v14 offset:45056
    v_cmp_lt_f32 vcc, 0x41000000, v48
    v_mfma_f32_16x16x32_bf16 v[124:127], a[60:63], v[180:183], v[124:127]
    ds_read_b64_tr_b16 a[44:45], v15 offset:40960
    ds_read_b64_tr_b16 a[46:47], v15 offset:45056
    s_cbranch_vccnz L_rs_10_2
L_rsb_10_2:
    s_waitcnt lgkmcnt(7)
    v_mfma_f32_16x16x32_bf16 v[128:131], a[0:3], v[192:195], v[160:163]
    buffer_load_dwordx4 v37, s[36:39], s64 offen offset:1024  lds
    v_exp_f32 v144, v144
    v_mfma_f32_16x16x32_bf16 v[132:135], a[0:3], v[208:211], v[164:167]
    v_exp_f32 v145, v145
    v_mfma_f32_16x16x32_bf16 v[136:139], a[16:19], v[192:195], v[160:163]
    ds_read_b64_tr_b16 a[48:49], v16 offset:40960
    ds_read_b64_tr_b16 a[50:51], v16 offset:45056
    v_mfma_f32_16x16x32_bf16 v[140:143], a[16:19], v[208:211], v[164:167]
    v_exp_f32 v146, v146
    v_mfma_f32_16x16x32_bf16 v[128:131], a[4:7], v[196:199], v[128:131]
    v_exp_f32 v147, v147
    v_mfma_f32_16x16x32_bf16 v[132:135], a[4:7], v[212:215], v[132:135]
    ds_read_b64_tr_b16 a[52:53], v17 offset:40960
    ds_read_b64_tr_b16 a[54:55], v17 offset:45056
    v_cvt_pk_bf16_f32 v176, v144, v145
    v_mfma_f32_16x16x32_bf16 v[136:139], a[20:23], v[196:199], v[136:139]
    buffer_load_dwordx4 v38, s[36:39], s64 offen offset:2048  lds
    v_exp_f32 v152, v152
    v_mfma_f32_16x16x32_bf16 v[140:143], a[20:23], v[212:215], v[140:143]
    v_exp_f32 v153, v153
    v_mfma_f32_16x16x32_bf16 v[128:131], a[8:11], v[200:203], v[128:131]
    ds_read_b64_tr_b16 a[56:57], v18 offset:40960
    ds_read_b64_tr_b16 a[58:59], v18 offset:45056
    v_cvt_pk_bf16_f32 v177, v146, v147
    v_mfma_f32_16x16x32_bf16 v[132:135], a[8:11], v[216:219], v[132:135]
    v_exp_f32 v154, v154
    v_mfma_f32_16x16x32_bf16 v[136:139], a[24:27], v[200:203], v[136:139]
    v_exp_f32 v155, v155
    v_mfma_f32_16x16x32_bf16 v[140:143], a[24:27], v[216:219], v[140:143]
    ds_read_b64_tr_b16 a[60:61], v19 offset:40960
    ds_read_b64_tr_b16 a[62:63], v19 offset:45056
    v_cvt_pk_bf16_f32 v178, v152, v153
    v_mfma_f32_16x16x32_bf16 v[128:131], a[12:15], v[204:207], v[128:131]
    v_exp_f32 v148, v148
    v_cvt_pk_bf16_f32 v179, v154, v155
    v_mfma_f32_16x16x32_bf16 v[132:135], a[12:15], v[220:223], v[132:135]
    buffer_load_dwordx4 v39, s[36:39], s64 offen offset:3072  lds
    v_exp_f32 v149, v149
    v_mfma_f32_16x16x32_bf16 v[136:139], a[28:31], v[204:207], v[136:139]
    v_exp_f32 v150, v150
    v_mfma_f32_16x16x32_bf16 v[140:143], a[28:31], v[220:223], v[140:143]
    s_mov_b32 s64, 917504
    v_exp_f32 v151, v151
    v_cvt_pk_bf16_f32 v180, v148, v149
    s_waitcnt lgkmcnt(0)
    v_mfma_f32_16x16x32_bf16 v[168:171], v[56:59], v[176:179], v[168:171]
    s_waitcnt vmcnt(12)
    s_barrier
    ds_read_b128 a[0:3], v8 offset:8192
    v_cvt_pk_bf16_f32 v181, v150, v151
    v_mfma_f32_16x16x32_bf16 v[64:67], a[32:35], v[176:179], v[64:67]
    s_add_u32 m0, s57, 81920
    v_exp_f32 v156, v156
    v_mfma_f32_16x16x32_bf16 v[72:75], a[36:39], v[176:179], v[72:75]
    ds_read_b128 a[16:19], v8 offset:12288
    ds_read_b128 a[4:7], v9 offset:8192
    v_mfma_f32_16x16x32_bf16 v[80:83], a[40:43], v[176:179], v[80:83]
    v_exp_f32 v157, v157
    v_mfma_f32_16x16x32_bf16 v[88:91], a[44:47], v[176:179], v[88:91]
    ds_read_b128 a[20:23], v9 offset:12288
    v_cvt_pk_bf16_f32 v182, v156, v157
    v_mfma_f32_16x16x32_bf16 v[96:99], a[48:51], v[176:179], v[96:99]
    v_exp_f32 v158, v158
    v_mfma_f32_16x16x32_bf16 v[104:107], a[52:55], v[176:179], v[104:107]
    v_exp_f32 v159, v159
    v_mfma_f32_16x16x32_bf16 v[112:115], a[56:59], v[176:179], v[112:115]
    ds_read_b128 a[8:11], v10 offset:8192
    v_cvt_pk_bf16_f32 v183, v158, v159
    v_mfma_f32_16x16x32_bf16 v[120:123], a[60:63], v[176:179], v[120:123]
    ds_read_b128 a[24:27], v10 offset:12288
    v_max3_f32 v48, v128, v129, v130
    v_mfma_f32_16x16x32_bf16 v[172:175], v[56:59], v[180:183], v[172:175]
    ds_read_b128 a[12:15], v11 offset:8192
    v_max3_f32 v49, v132, v133, v134
    v_mfma_f32_16x16x32_bf16 v[68:71], a[32:35], v[180:183], v[68:71]
    ds_read_b128 a[28:31], v11 offset:12288
    v_max3_f32 v48, v48, v131, v136
    v_mfma_f32_16x16x32_bf16 v[76:79], a[36:39], v[180:183], v[76:79]
    ds_read_b64_tr_b16 a[32:33], v12 offset:0
    v_max3_f32 v49, v49, v135, v140
    v_mfma_f32_16x16x32_bf16 v[84:87], a[40:43], v[180:183], v[84:87]
    ds_read_b64_tr_b16 a[34:35], v12 offset:4096
    buffer_load_dwordx4 v36, s[36:39], s64 offen offset:0  lds
    v_max3_f32 v48, v48, v137, v138
    v_mfma_f32_16x16x32_bf16 v[92:95], a[44:47], v[180:183], v[92:95]
    ds_read_b64_tr_b16 a[36:37], v13 offset:0
    v_max3_f32 v49, v49, v141, v142
    v_mfma_f32_16x16x32_bf16 v[100:103], a[48:51], v[180:183], v[100:103]
    ds_read_b64_tr_b16 a[38:39], v13 offset:4096
    v_max_f32 v49, v49, v143
    v_mfma_f32_16x16x32_bf16 v[108:111], a[52:55], v[180:183], v[108:111]
    ds_read_b64_tr_b16 a[40:41], v14 offset:0
    v_max3_f32 v48, v48, v139, v49
    v_mfma_f32_16x16x32_bf16 v[116:119], a[56:59], v[180:183], v[116:119]
    ds_read_b64_tr_b16 a[42:43], v14 offset:4096
    v_cmp_lt_f32 vcc, 0x41000000, v48
    v_mfma_f32_16x16x32_bf16 v[124:127], a[60:63], v[180:183], v[124:127]
    ds_read_b64_tr_b16 a[44:45], v15 offset:0
    ds_read_b64_tr_b16 a[46:47], v15 offset:4096
    s_cbranch_vccnz L_rs_11_2
L_rsb_11_2:
    s_waitcnt lgkmcnt(7)
    v_mfma_f32_16x16x32_bf16 v[144:147], a[0:3], v[192:195], v[160:163]
    buffer_load_dwordx4 v37, s[36:39], s64 offen offset:1024  lds
    v_exp_f32 v128, v128
    v_mfma_f32_16x16x32_bf16 v[148:151], a[0:3], v[208:211], v[164:167]
    v_exp_f32 v129, v129
    v_mfma_f32_16x16x32_bf16 v[152:155], a[16:19], v[192:195], v[160:163]
    ds_read_b64_tr_b16 a[48:49], v16 offset:0
    ds_read_b64_tr_b16 a[50:51], v16 offset:4096
    v_mfma_f32_16x16x32_bf16 v[156:159], a[16:19], v[208:211], v[164:167]
    v_exp_f32 v130, v130
    v_mfma_f32_16x16x32_bf16 v[144:147], a[4:7], v[196:199], v[144:147]
    v_exp_f32 v131, v131
    v_mfma_f32_16x16x32_bf16 v[148:151], a[4:7], v[212:215], v[148:151]
    ds_read_b64_tr_b16 a[52:53], v17 offset:0
    ds_read_b64_tr_b16 a[54:55], v17 offset:4096
    v_cvt_pk_bf16_f32 v176, v128, v129
    v_mfma_f32_16x16x32_bf16 v[152:155], a[20:23], v[196:199], v[152:155]
    buffer_load_dwordx4 v38, s[36:39], s64 offen offset:2048  lds
    v_exp_f32 v136, v136
    v_mfma_f32_16x16x32_bf16 v[156:159], a[20:23], v[212:215], v[156:159]
    v_exp_f32 v137, v137
    v_mfma_f32_16x16x32_bf16 v[144:147], a[8:11], v[200:203], v[144:147]
    ds_read_b64_tr_b16 a[56:57], v18 offset:0
    ds_read_b64_tr_b16 a[58:59], v18 offset:4096
    v_cvt_pk_bf16_f32 v177, v130, v131
    v_mfma_f32_16x16x32_bf16 v[148:151], a[8:11], v[216:219], v[148:151]
    v_exp_f32 v138, v138
    v_mfma_f32_16x16x32_bf16 v[152:155], a[24:27], v[200:203], v[152:155]
    v_exp_f32 v139, v139
    v_mfma_f32_16x16x32_bf16 v[156:159], a[24:27], v[216:219], v[156:159]
    ds_read_b64_tr_b16 a[60:61], v19 offset:0
    ds_read_b64_tr_b16 a[62:63], v19 offset:4096
    v_cvt_pk_bf16_f32 v178, v136, v137
    v_mfma_f32_16x16x32_bf16 v[144:147], a[12:15], v[204:207], v[144:147]
    v_exp_f32 v132, v132
    v_cvt_pk_bf16_f32 v179, v138, v139
    v_mfma_f32_16x16x32_bf16 v[148:151], a[12:15], v[220:223], v[148:151]
    buffer_load_dwordx4 v39, s[36:39], s64 offen offset:3072  lds
    v_exp_f32 v133, v133
    v_mfma_f32_16x16x32_bf16 v[152:155], a[28:31], v[204:207], v[152:155]
    v_exp_f32 v134, v134
    v_mfma_f32_16x16x32_bf16 v[156:159], a[28:31], v[220:223], v[156:159]
    v_and_b32 v1, v184, v185
    v_and_b32 v1, 1, v1
    v_exp_f32 v135, v135
    v_cvt_pk_bf16_f32 v180, v132, v133
    v_cmp_eq_u32 vcc, 0, v1
    s_cbranch_vccnz L_notag_2
L_tag_2:
L_tail_2:
    s_waitcnt lgkmcnt(0)
    v_mfma_f32_16x16x32_bf16 v[168:171], v[56:59], v[176:179], v[168:171]
    v_cvt_pk_bf16_f32 v181, v134, v135
    v_mfma_f32_16x16x32_bf16 v[64:67], a[32:35], v[176:179], v[64:67]
    v_exp_f32 v140, v140
    v_mfma_f32_16x16x32_bf16 v[72:75], a[36:39], v[176:179], v[72:75]
    v_mfma_f32_16x16x32_bf16 v[80:83], a[40:43], v[176:179], v[80:83]
    v_exp_f32 v141, v141
    v_mfma_f32_16x16x32_bf16 v[88:91], a[44:47], v[176:179], v[88:91]
    v_cvt_pk_bf16_f32 v182, v140, v141
    v_mfma_f32_16x16x32_bf16 v[96:99], a[48:51], v[176:179], v[96:99]
    v_exp_f32 v142, v142
    v_mfma_f32_16x16x32_bf16 v[104:107], a[52:55], v[176:179], v[104:107]
    v_exp_f32 v143, v143
    v_mfma_f32_16x16x32_bf16 v[112:115], a[56:59], v[176:179], v[112:115]
    v_cvt_pk_bf16_f32 v183, v142, v143
    v_mfma_f32_16x16x32_bf16 v[120:123], a[60:63], v[176:179], v[120:123]
    v_max3_f32 v48, v144, v145, v146
    v_mfma_f32_16x16x32_bf16 v[172:175], v[56:59], v[180:183], v[172:175]
    v_max3_f32 v49, v148, v149, v150
    v_mfma_f32_16x16x32_bf16 v[68:71], a[32:35], v[180:183], v[68:71]
    v_max3_f32 v48, v48, v147, v152
    v_mfma_f32_16x16x32_bf16 v[76:79], a[36:39], v[180:183], v[76:79]
    ds_read_b64_tr_b16 a[32:33], v12 offset:8192
    v_max3_f32 v49, v49, v151, v156
    v_mfma_f32_16x16x32_bf16 v[84:87], a[40:43], v[180:183], v[84:87]
    ds_read_b64_tr_b16 a[34:35], v12 offset:12288
    v_max3_f32 v48, v48, v153, v154
    v_mfma_f32_16x16x32_bf16 v[92:95], a[44:47], v[180:183], v[92:95]
    ds_read_b64_tr_b16 a[36:37], v13 offset:8192
    v_max3_f32 v49, v49, v157, v158
    v_mfma_f32_16x16x32_bf16 v[100:103], a[48:51], v[180:183], v[100:103]
    ds_read_b64_tr_b16 a[38:39], v13 offset:12288
    v_max_f32 v49, v49, v159
    v_mfma_f32_16x16x32_bf16 v[108:111], a[52:55], v[180:183], v[108:111]
    ds_read_b64_tr_b16 a[40:41], v14 offset:8192
    v_max3_f32 v48, v48, v155, v49
    v_mfma_f32_16x16x32_bf16 v[116:119], a[56:59], v[180:183], v[116:119]
    ds_read_b64_tr_b16 a[42:43], v14 offset:12288
    v_cmp_lt_f32 vcc, 0x41000000, v48
    v_mfma_f32_16x16x32_bf16 v[124:127], a[60:63], v[180:183], v[124:127]
    ds_read_b64_tr_b16 a[44:45], v15 offset:8192
    ds_read_b64_tr_b16 a[46:47], v15 offset:12288
    s_cbranch_vccnz L_rs_12_2
L_rsb_12_2:
    buffer_load_dwordx2 v[186:187], v51, s[40:43], 0 offen sc1
    ds_read_b64_tr_b16 a[48:49], v16 offset:8192
    ds_read_b64_tr_b16 a[50:51], v16 offset:12288
    ds_read_b64_tr_b16 a[52:53], v17 offset:8192
    ds_read_b64_tr_b16 a[54:55], v17 offset:12288
    ds_read_b64_tr_b16 a[56:57], v18 offset:8192
    ds_read_b64_tr_b16 a[58:59], v18 offset:12288
    ds_read_b64_tr_b16 a[60:61], v19 offset:8192
    ds_read_b64_tr_b16 a[62:63], v19 offset:12288
    v_exp_f32 v144, v144
    v_exp_f32 v145, v145
    v_exp_f32 v146, v146
    v_cvt_pk_bf16_f32 v176, v144, v145
    v_exp_f32 v147, v147
    v_exp_f32 v152, v152
    v_cvt_pk_bf16_f32 v177, v146, v147
    v_exp_f32 v153, v153
    v_exp_f32 v154, v154
    v_cvt_pk_bf16_f32 v178, v152, v153
    v_exp_f32 v155, v155
    s_lshl_b32 s60, s55, 15
    v_cvt_pk_bf16_f32 v179, v154, v155
    s_add_u32 s60, s60, s73
    s_add_u32 s61, s60, 4096
    v_mfma_f32_16x16x32_bf16 v[168:171], v[56:59], v[176:179], v[168:171]
    v_exp_f32 v148, v148
    v_exp_f32 v149, v149
    s_waitcnt lgkmcnt(1)
    v_mfma_f32_16x16x32_bf16 v[64:67], a[32:35], v[176:179], v[64:67]
    v_exp_f32 v150, v150
    v_cvt_pk_bf16_f32 v180, v148, v149
    v_mfma_f32_16x16x32_bf16 v[72:75], a[36:39], v[176:179], v[72:75]
    v_exp_f32 v151, v151
    v_mfma_f32_16x16x32_bf16 v[80:83], a[40:43], v[176:179], v[80:83]
    v_exp_f32 v156, v156
    v_cvt_pk_bf16_f32 v181, v150, v151
    v_mfma_f32_16x16x32_bf16 v[88:91], a[44:47], v[176:179], v[88:91]
    v_exp_f32 v157, v157
    v_mfma_f32_16x16x32_bf16 v[96:99], a[48:51], v[176:179], v[96:99]
    v_exp_f32 v158, v158
    v_cvt_pk_bf16_f32 v182, v156, v157
    v_mfma_f32_16x16x32_bf16 v[104:107], a[52:55], v[176:179], v[104:107]
    v_exp_f32 v159, v159
    v_mfma_f32_16x16x32_bf16 v[112:115], a[56:59], v[176:179], v[112:115]
    v_cvt_pk_bf16_f32 v183, v158, v159
    v_rcp_f32 v60, v168
    s_waitcnt lgkmcnt(0)
    v_mfma_f32_16x16x32_bf16 v[120:123], a[60:63], v[176:179], v[120:123]
    v_mov_b32 v61, v60
    v_mfma_f32_16x16x32_bf16 v[172:175], v[56:59], v[180:183], v[172:175]
    v_mfma_f32_16x16x32_bf16 v[68:71], a[32:35], v[180:183], v[68:71]
    v_mul_f32 v64, v64, v60
    v_mul_f32 v65, v65, v60
    v_cvt_pk_bf16_f32 v192, v64, v65
    v_mfma_f32_16x16x32_bf16 v[76:79], a[36:39], v[180:183], v[76:79]
    v_mul_f32 v66, v66, v60
    v_mul_f32 v67, v67, v60
    v_mfma_f32_16x16x32_bf16 v[84:87], a[40:43], v[180:183], v[84:87]
    v_cvt_pk_bf16_f32 v193, v66, v67
    v_mul_f32 v72, v72, v60
    v_mul_f32 v73, v73, v60
    v_mfma_f32_16x16x32_bf16 v[92:95], a[44:47], v[180:183], v[92:95]
    v_cvt_pk_bf16_f32 v194, v72, v73
    v_mul_f32 v74, v74, v60
    v_mfma_f32_16x16x32_bf16 v[100:103], a[48:51], v[180:183], v[100:103]
    v_mul_f32 v75, v75, v60
    v_cvt_pk_bf16_f32 v195, v74, v75
    v_mfma_f32_16x16x32_bf16 v[108:111], a[52:55], v[180:183], v[108:111]
    buffer_store_dwordx4 v[192:195], v53, s[40:43], s60 offen offset:0 sc1
    v_mul_f32 v80, v80, v60
    v_mul_f32 v81, v81, v60
    v_mfma_f32_16x16x32_bf16 v[116:119], a[56:59], v[180:183], v[116:119]
    v_cvt_pk_bf16_f32 v196, v80, v81
    v_mul_f32 v82, v82, v60
    v_mfma_f32_16x16x32_bf16 v[124:127], a[60:63], v[180:183], v[124:127]
    v_mul_f32 v83, v83, v60
    v_cvt_pk_bf16_f32 v197, v82, v83
    v_rcp_f32 v62, v172
    v_add_u32 v44, s9, v40
    v_add_u32 v45, s9, v41
    v_add_u32 v46, s9, v42
    v_add_u32 v47, s9, v43
    v_mov_b32 v63, v62
    v_pk_mul_f32 v[88:89], v[88:89], v[60:61]
    v_cvt_pk_bf16_f32 v198, v88, v89
    v_pk_mul_f32 v[90:91], v[90:91], v[60:61]
    v_cvt_pk_bf16_f32 v199, v90, v91
    buffer_store_dwordx4 v[196:199], v53, s[40:43], s60 offen offset:1024 sc1
    v_pk_mul_f32 v[96:97], v[96:97], v[60:61]
    v_cvt_pk_bf16_f32 v200, v96, v97
    v_pk_mul_f32 v[98:99], v[98:99], v[60:61]
    v_cvt_pk_bf16_f32 v201, v98, v99
    v_pk_mul_f32 v[104:105], v[104:105], v[60:61]
    v_cvt_pk_bf16_f32 v202, v104, v105
    v_pk_mul_f32 v[106:107], v[106:107], v[60:61]
    v_cvt_pk_bf16_f32 v203, v106, v107
    buffer_store_dwordx4 v[200:203], v53, s[40:43], s60 offen offset:2048 sc1
    v_pk_mul_f32 v[112:113], v[112:113], v[60:61]
    v_cvt_pk_bf16_f32 v204, v112, v113
    v_pk_mul_f32 v[114:115], v[114:115], v[60:61]
    v_cvt_pk_bf16_f32 v205, v114, v115
    v_pk_mul_f32 v[120:121], v[120:121], v[60:61]
    v_cvt_pk_bf16_f32 v206, v120, v121
    v_pk_mul_f32 v[122:123], v[122:123], v[60:61]
    v_cvt_pk_bf16_f32 v207, v122, v123
    buffer_store_dwordx4 v[204:207], v53, s[40:43], s60 offen offset:3072 sc1
    v_pk_mul_f32 v[68:69], v[68:69], v[62:63]
    v_cvt_pk_bf16_f32 v208, v68, v69
    v_pk_mul_f32 v[70:71], v[70:71], v[62:63]
    v_cvt_pk_bf16_f32 v209, v70, v71
    v_pk_mul_f32 v[76:77], v[76:77], v[62:63]
    v_cvt_pk_bf16_f32 v210, v76, v77
    v_pk_mul_f32 v[78:79], v[78:79], v[62:63]
    v_cvt_pk_bf16_f32 v211, v78, v79
    buffer_store_dwordx4 v[208:211], v53, s[40:43], s61 offen offset:0 sc1
    v_pk_mul_f32 v[84:85], v[84:85], v[62:63]
    v_cvt_pk_bf16_f32 v212, v84, v85
    v_pk_mul_f32 v[86:87], v[86:87], v[62:63]
    v_cvt_pk_bf16_f32 v213, v86, v87
    v_pk_mul_f32 v[92:93], v[92:93], v[62:63]
    v_cvt_pk_bf16_f32 v214, v92, v93
    v_pk_mul_f32 v[94:95], v[94:95], v[62:63]
    v_cvt_pk_bf16_f32 v215, v94, v95
    buffer_store_dwordx4 v[212:215], v53, s[40:43], s61 offen offset:1024 sc1
    v_pk_mul_f32 v[100:101], v[100:101], v[62:63]
    v_cvt_pk_bf16_f32 v216, v100, v101
    v_pk_mul_f32 v[102:103], v[102:103], v[62:63]
    v_cvt_pk_bf16_f32 v217, v102, v103
    v_pk_mul_f32 v[108:109], v[108:109], v[62:63]
    v_cvt_pk_bf16_f32 v218, v108, v109
    v_pk_mul_f32 v[110:111], v[110:111], v[62:63]
    v_cvt_pk_bf16_f32 v219, v110, v111
    buffer_store_dwordx4 v[216:219], v53, s[40:43], s61 offen offset:2048 sc1
    v_pk_mul_f32 v[116:117], v[116:117], v[62:63]
    v_cvt_pk_bf16_f32 v220, v116, v117
    v_pk_mul_f32 v[118:119], v[118:119], v[62:63]
    v_cvt_pk_bf16_f32 v221, v118, v119
    v_pk_mul_f32 v[124:125], v[124:125], v[62:63]
    v_cvt_pk_bf16_f32 v222, v124, v125
    v_pk_mul_f32 v[126:127], v[126:127], v[62:63]
    v_cvt_pk_bf16_f32 v223, v126, v127
    buffer_store_dwordx4 v[220:223], v53, s[40:43], s61 offen offset:3072 sc1
    s_waitcnt vmcnt(8)
    v_cmp_eq_u64 vcc, v[184:185], v[186:187]
    s_mov_b32 s8, 0xfe
    s_barrier
    s_and_b32 s7, vcc_lo, 0xfe
    ds_read_b64_tr_b16 a[224:225], v44 offset:0
    ds_read_b64_tr_b16 a[226:227], v44 offset:2048
    ds_read_b64_tr_b16 a[228:229], v45 offset:0
    ds_read_b64_tr_b16 a[230:231], v45 offset:2048
    ds_read_b64_tr_b16 a[232:233], v46 offset:0
    ds_read_b64_tr_b16 a[234:235], v46 offset:2048
    ds_read_b64_tr_b16 a[236:237], v47 offset:0
    ds_read_b64_tr_b16 a[238:239], v47 offset:2048
    s_bcnt1_i32_b32 s60, s7
    s_cmp_ge_u32 s60, 2
    s_cbranch_scc0 L_slow_2
L_fast_2:
    s_and_b32 s60, s7, s8
    s_ff1_i32_b32 s60, s60
    s_bitset0_b32 s8, s60
    s_add_u32 s60, s60, s55
    s_and_b32 s60, s60, 7
    s_lshl_b32 s61, s60, 15
    s_add_u32 s12, s61, s73
    s_add_u32 s13, s12, 4096
    s_lshl_b32 s61, s60, 2
    s_lshr_b32 s61, 0x52419876, s61
    s_and_b32 s61, s61, 15
    s_lshl_b32 s10, s61, 14
    s_waitcnt lgkmcnt(4)
    v_mfma_f32_16x16x32_bf16 v[224:227], a[224:227], v[192:195], 0
    ds_read_b64_tr_b16 a[240:241], v44 offset:4096
    ds_read_b64_tr_b16 a[242:243], v44 offset:6144
    v_mfma_f32_16x16x32_bf16 v[228:231], a[224:227], v[208:211], 0
    buffer_load_dwordx4 a[0:3], v53, s[40:43], s12 offen offset:0 sc1
    v_mfma_f32_16x16x32_bf16 v[232:235], a[228:231], v[192:195], 0
    ds_read_b64_tr_b16 a[244:245], v45 offset:4096
    ds_read_b64_tr_b16 a[246:247], v45 offset:6144
    v_mfma_f32_16x16x32_bf16 v[236:239], a[228:231], v[208:211], 0
    buffer_load_dwordx4 a[16:19], v53, s[40:43], s13 offen offset:0 sc1
    s_waitcnt lgkmcnt(4)
    v_mfma_f32_16x16x32_bf16 v[240:243], a[232:235], v[192:195], 0
    ds_read_b64_tr_b16 a[248:249], v46 offset:4096
    ds_read_b64_tr_b16 a[250:251], v46 offset:6144
    v_mfma_f32_16x16x32_bf16 v[244:247], a[232:235], v[208:211], 0
    buffer_load_dwordx4 a[4:7], v53, s[40:43], s12 offen offset:1024 sc1
    v_mfma_f32_16x16x32_bf16 v[248:251], a[236:239], v[192:195], 0
    ds_read_b64_tr_b16 a[252:253], v47 offset:4096
    ds_read_b64_tr_b16 a[254:255], v47 offset:6144
    v_mfma_f32_16x16x32_bf16 v[252:255], a[236:239], v[208:211], 0
    buffer_load_dwordx4 a[20:23], v53, s[40:43], s13 offen offset:1024 sc1
    s_waitcnt lgkmcnt(4)
    v_mfma_f32_16x16x32_bf16 v[224:227], a[240:243], v[196:199], v[224:227]
    ds_read_b64_tr_b16 a[224:225], v44 offset:8192
    ds_read_b64_tr_b16 a[226:227], v44 offset:10240
    v_mfma_f32_16x16x32_bf16 v[228:231], a[240:243], v[212:215], v[228:231]
    buffer_load_dwordx4 a[8:11], v53, s[40:43], s12 offen offset:2048 sc1
    v_mfma_f32_16x16x32_bf16 v[232:235], a[244:247], v[196:199], v[232:235]
    ds_read_b64_tr_b16 a[228:229], v45 offset:8192
    ds_read_b64_tr_b16 a[230:231], v45 offset:10240
    v_mfma_f32_16x16x32_bf16 v[236:239], a[244:247], v[212:215], v[236:239]
    buffer_load_dwordx4 a[24:27], v53, s[40:43], s13 offen offset:2048 sc1
    s_waitcnt lgkmcnt(4)
    v_mfma_f32_16x16x32_bf16 v[240:243], a[248:251], v[196:199], v[240:243]
    ds_read_b64_tr_b16 a[232:233], v46 offset:8192
    ds_read_b64_tr_b16 a[234:235], v46 offset:10240
    v_mfma_f32_16x16x32_bf16 v[244:247], a[248:251], v[212:215], v[244:247]
    buffer_load_dwordx4 a[12:15], v53, s[40:43], s12 offen offset:3072 sc1
    v_mfma_f32_16x16x32_bf16 v[248:251], a[252:255], v[196:199], v[248:251]
    ds_read_b64_tr_b16 a[236:237], v47 offset:8192
    ds_read_b64_tr_b16 a[238:239], v47 offset:10240
    v_mfma_f32_16x16x32_bf16 v[252:255], a[252:255], v[212:215], v[252:255]
    buffer_load_dwordx4 a[28:31], v53, s[40:43], s13 offen offset:3072 sc1
    s_and_b32 s60, s7, s8
    s_ff1_i32_b32 s60, s60
    s_bitset0_b32 s8, s60
    s_add_u32 s60, s60, s55
    s_and_b32 s60, s60, 7
    s_lshl_b32 s61, s60, 15
    s_add_u32 s12, s61, s73
    s_add_u32 s13, s12, 4096
    s_lshl_b32 s61, s60, 2
    s_lshr_b32 s61, 0x52419876, s61
    s_and_b32 s61, s61, 15
    s_lshl_b32 s11, s61, 14
    s_waitcnt lgkmcnt(4)
    v_mfma_f32_16x16x32_bf16 v[224:227], a[224:227], v[200:203], v[224:227]
    ds_read_b64_tr_b16 a[240:241], v44 offset:12288
    ds_read_b64_tr_b16 a[242:243], v44 offset:14336
    v_mfma_f32_16x16x32_bf16 v[228:231], a[224:227], v[216:219], v[228:231]
    buffer_load_dwordx4 a[32:35], v53, s[40:43], s12 offen offset:0 sc1
    v_mfma_f32_16x16x32_bf16 v[232:235], a[228:231], v[200:203], v[232:235]
    ds_read_b64_tr_b16 a[244:245], v45 offset:12288
    ds_read_b64_tr_b16 a[246:247], v45 offset:14336
    v_mfma_f32_16x16x32_bf16 v[236:239], a[228:231], v[216:219], v[236:239]
    buffer_load_dwordx4 a[48:51], v53, s[40:43], s13 offen offset:0 sc1
    v_add_u32 v44, s10, v40
    v_add_u32 v45, s10, v41
    s_waitcnt lgkmcnt(4)
    v_mfma_f32_16x16x32_bf16 v[240:243], a[232:235], v[200:203], v[240:243]
    ds_read_b64_tr_b16 a[248:249], v46 offset:12288
    ds_read_b64_tr_b16 a[250:251], v46 offset:14336
    v_mfma_f32_16x16x32_bf16 v[244:247], a[232:235], v[216:219], v[244:247]
    buffer_load_dwordx4 a[36:39], v53, s[40:43], s12 offen offset:1024 sc1
    v_mfma_f32_16x16x32_bf16 v[248:251], a[236:239], v[200:203], v[248:251]
    ds_read_b64_tr_b16 a[252:253], v47 offset:12288
    ds_read_b64_tr_b16 a[254:255], v47 offset:14336
    v_mfma_f32_16x16x32_bf16 v[252:255], a[236:239], v[216:219], v[252:255]
    buffer_load_dwordx4 a[52:55], v53, s[40:43], s13 offen offset:1024 sc1
    v_add_u32 v46, s10, v42
    v_add_u32 v47, s10, v43
    s_waitcnt lgkmcnt(4)
    v_mfma_f32_16x16x32_bf16 v[224:227], a[240:243], v[204:207], v[224:227]
    ds_read_b64_tr_b16 a[224:225], v44 offset:0
    ds_read_b64_tr_b16 a[226:227], v44 offset:2048
    v_mfma_f32_16x16x32_bf16 v[228:231], a[240:243], v[220:223], v[228:231]
    buffer_load_dwordx4 a[40:43], v53, s[40:43], s12 offen offset:2048 sc1
    v_mfma_f32_16x16x32_bf16 v[232:235], a[244:247], v[204:207], v[232:235]
    ds_read_b64_tr_b16 a[228:229], v45 offset:0
    ds_read_b64_tr_b16 a[230:231], v45 offset:2048
    v_mfma_f32_16x16x32_bf16 v[236:239], a[244:247], v[220:223], v[236:239]
    buffer_load_dwordx4 a[56:59], v53, s[40:43], s13 offen offset:2048 sc1
    s_waitcnt lgkmcnt(4)
    v_mfma_f32_16x16x32_bf16 v[240:243], a[248:251], v[204:207], v[240:243]
    ds_read_b64_tr_b16 a[232:233], v46 offset:0
    ds_read_b64_tr_b16 a[234:235], v46 offset:2048
    v_mfma_f32_16x16x32_bf16 v[244:247], a[248:251], v[220:223], v[244:247]
    buffer_load_dwordx4 a[44:47], v53, s[40:43], s12 offen offset:3072 sc1
    v_mfma_f32_16x16x32_bf16 v[248:251], a[252:255], v[204:207], v[248:251]
    ds_read_b64_tr_b16 a[236:237], v47 offset:0
    ds_read_b64_tr_b16 a[238:239], v47 offset:2048
    v_mfma_f32_16x16x32_bf16 v[252:255], a[252:255], v[220:223], v[252:255]
    buffer_load_dwordx4 a[60:63], v53, s[40:43], s13 offen offset:3072 sc1
    s_waitcnt vmcnt(16)
    s_mov_b64 exec, 1
    buffer_store_dwordx2 v[184:185], v55, s[40:43], 0 offen sc1
    s_mov_b64 exec, -1
L_common_2:
    s_waitcnt vmcnt(14) lgkmcnt(4)
    v_mfma_f32_16x16x32_bf16 v[224:227], a[224:227], a[0:3], v[224:227]
    ds_read_b64_tr_b16 a[240:241], v44 offset:4096
    ds_read_b64_tr_b16 a[242:243], v44 offset:6144
    v_mfma_f32_16x16x32_bf16 v[228:231], a[224:227], a[16:19], v[228:231]
    s_and_b32 s60, s7, s8
    s_cbranch_scc0 L_sel3_2
L_sel3_2_go:
    s_ff1_i32_b32 s60, s60
    s_bitset0_b32 s8, s60
    v_mfma_f32_16x16x32_bf16 v[232:235], a[228:231], a[0:3], v[232:235]
    ds_read_b64_tr_b16 a[244:245], v45 offset:4096
    ds_read_b64_tr_b16 a[246:247], v45 offset:6144
    v_mfma_f32_16x16x32_bf16 v[236:239], a[228:231], a[16:19], v[236:239]
    s_add_u32 s60, s60, s55
    s_and_b32 s60, s60, 7
    s_lshl_b32 s61, s60, 15
    s_waitcnt lgkmcnt(4)
    v_mfma_f32_16x16x32_bf16 v[240:243], a[232:235], a[0:3], v[240:243]
    ds_read_b64_tr_b16 a[248:249], v46 offset:4096
    ds_read_b64_tr_b16 a[250:251], v46 offset:6144
    v_mfma_f32_16x16x32_bf16 v[244:247], a[232:235], a[16:19], v[244:247]
    s_add_u32 s12, s61, s73
    s_add_u32 s13, s12, 4096
    s_lshl_b32 s61, s60, 2
    v_mfma_f32_16x16x32_bf16 v[248:251], a[236:239], a[0:3], v[248:251]
    ds_read_b64_tr_b16 a[252:253], v47 offset:4096
    ds_read_b64_tr_b16 a[254:255], v47 offset:6144
    v_mfma_f32_16x16x32_bf16 v[252:255], a[236:239], a[16:19], v[252:255]
    s_lshr_b32 s61, 0x52419876, s61
    s_and_b32 s61, s61, 15
    s_lshl_b32 s9, s61, 14
    s_waitcnt vmcnt(12) lgkmcnt(4)
    v_mfma_f32_16x16x32_bf16 v[224:227], a[240:243], a[4:7], v[224:227]
    ds_read_b64_tr_b16 a[224:225], v44 offset:8192
    ds_read_b64_tr_b16 a[226:227], v44 offset:10240
    v_mfma_f32_16x16x32_bf16 v[228:231], a[240:243], a[20:23], v[228:231]
    buffer_load_dwordx4 a[64:67], v53, s[40:43], s12 offen offset:0 sc1
    v_mfma_f32_16x16x32_bf16 v[232:235], a[244:247], a[4:7], v[232:235]
    ds_read_b64_tr_b16 a[228:229], v45 offset:8192
    ds_read_b64_tr_b16 a[230:231], v45 offset:10240
    v_mfma_f32_16x16x32_bf16 v[236:239], a[244:247], a[20:23], v[236:239]
    buffer_load_dwordx4 a[80:83], v53, s[40:43], s13 offen offset:0 sc1
    s_waitcnt lgkmcnt(4)
    v_mfma_f32_16x16x32_bf16 v[240:243], a[248:251], a[4:7], v[240:243]
    ds_read_b64_tr_b16 a[232:233], v46 offset:8192
    ds_read_b64_tr_b16 a[234:235], v46 offset:10240
    v_mfma_f32_16x16x32_bf16 v[244:247], a[248:251], a[20:23], v[244:247]
    buffer_load_dwordx4 a[68:71], v53, s[40:43], s12 offen offset:1024 sc1
    v_mfma_f32_16x16x32_bf16 v[248:251], a[252:255], a[4:7], v[248:251]
    ds_read_b64_tr_b16 a[236:237], v47 offset:8192
    ds_read_b64_tr_b16 a[238:239], v47 offset:10240
    v_mfma_f32_16x16x32_bf16 v[252:255], a[252:255], a[20:23], v[252:255]
    s_waitcnt vmcnt(13) lgkmcnt(4)
    v_mfma_f32_16x16x32_bf16 v[224:227], a[224:227], a[8:11], v[224:227]
    ds_read_b64_tr_b16 a[240:241], v44 offset:12288
    ds_read_b64_tr_b16 a[242:243], v44 offset:14336
    v_mfma_f32_16x16x32_bf16 v[228:231], a[224:227], a[24:27], v[228:231]
    buffer_load_dwordx4 a[84:87], v53, s[40:43], s13 offen offset:1024 sc1
    v_mfma_f32_16x16x32_bf16 v[232:235], a[228:231], a[8:11], v[232:235]
    ds_read_b64_tr_b16 a[244:245], v45 offset:12288
    ds_read_b64_tr_b16 a[246:247], v45 offset:14336
    v_mfma_f32_16x16x32_bf16 v[236:239], a[228:231], a[24:27], v[236:239]
    v_add_u32 v44, s11, v40
    v_add_u32 v45, s11, v41
    s_waitcnt lgkmcnt(4)
    v_mfma_f32_16x16x32_bf16 v[240:243], a[232:235], a[8:11], v[240:243]
    ds_read_b64_tr_b16 a[248:249], v46 offset:12288
    ds_read_b64_tr_b16 a[250:251], v46 offset:14336
    v_mfma_f32_16x16x32_bf16 v[244:247], a[232:235], a[24:27], v[244:247]
    buffer_load_dwordx4 a[72:75], v53, s[40:43], s12 offen offset:2048 sc1
    v_mfma_f32_16x16x32_bf16 v[248:251], a[236:239], a[8:11], v[248:251]
    ds_read_b64_tr_b16 a[252:253], v47 offset:12288
    ds_read_b64_tr_b16 a[254:255], v47 offset:14336
    v_mfma_f32_16x16x32_bf16 v[252:255], a[236:239], a[24:27], v[252:255]
    buffer_load_dwordx4 a[88:91], v53, s[40:43], s13 offen offset:2048 sc1
    v_add_u32 v46, s11, v42
    v_add_u32 v47, s11, v43
    s_waitcnt vmcnt(14) lgkmcnt(4)
    v_mfma_f32_16x16x32_bf16 v[224:227], a[240:243], a[12:15], v[224:227]
    ds_read_b64_tr_b16 a[224:225], v44 offset:0
    ds_read_b64_tr_b16 a[226:227], v44 offset:2048
    v_mfma_f32_16x16x32_bf16 v[228:231], a[240:243], a[28:31], v[228:231]
    buffer_load_dwordx4 a[76:79], v53, s[40:43], s12 offen offset:3072 sc1
    v_mfma_f32_16x16x32_bf16 v[232:235], a[244:247], a[12:15], v[232:235]
    ds_read_b64_tr_b16 a[228:229], v45 offset:0
    ds_read_b64_tr_b16 a[230:231], v45 offset:2048
    v_mfma_f32_16x16x32_bf16 v[236:239], a[244:247], a[28:31], v[236:239]
    s_waitcnt lgkmcnt(4)
    v_mfma_f32_16x16x32_bf16 v[240:243], a[248:251], a[12:15], v[240:243]
    ds_read_b64_tr_b16 a[232:233], v46 offset:0
    ds_read_b64_tr_b16 a[234:235], v46 offset:2048
    v_mfma_f32_16x16x32_bf16 v[244:247], a[248:251], a[28:31], v[244:247]
    buffer_load_dwordx4 a[92:95], v53, s[40:43], s13 offen offset:3072 sc1
    v_mfma_f32_16x16x32_bf16 v[248:251], a[252:255], a[12:15], v[248:251]
    ds_read_b64_tr_b16 a[236:237], v47 offset:0
    ds_read_b64_tr_b16 a[238:239], v47 offset:2048
    v_mfma_f32_16x16x32_bf16 v[252:255], a[252:255], a[28:31], v[252:255]
    s_waitcnt vmcnt(14) lgkmcnt(4)
    v_mfma_f32_16x16x32_bf16 v[224:227], a[224:227], a[32:35], v[224:227]
    ds_read_b64_tr_b16 a[240:241], v44 offset:4096
    ds_read_b64_tr_b16 a[242:243], v44 offset:6144
    v_mfma_f32_16x16x32_bf16 v[228:231], a[224:227], a[48:51], v[228:231]
    s_and_b32 s60, s7, s8
    s_cbranch_scc0 L_sel4_2
L_sel4_2_go:
    s_ff1_i32_b32 s60, s60
    s_bitset0_b32 s8, s60
    v_mfma_f32_16x16x32_bf16 v[232:235], a[228:231], a[32:35], v[232:235]
    ds_read_b64_tr_b16 a[244:245], v45 offset:4096
    ds_read_b64_tr_b16 a[246:247], v45 offset:6144
    v_mfma_f32_16x16x32_bf16 v[236:239], a[228:231], a[48:51], v[236:239]
    s_add_u32 s60, s60, s55
    s_and_b32 s60, s60, 7
    s_lshl_b32 s61, s60, 15
    s_waitcnt lgkmcnt(4)
    v_mfma_f32_16x16x32_bf16 v[240:243], a[232:235], a[32:35], v[240:243]
    ds_read_b64_tr_b16 a[248:249], v46 offset:4096
    ds_read_b64_tr_b16 a[250:251], v46 offset:6144
    v_mfma_f32_16x16x32_bf16 v[244:247], a[232:235], a[48:51], v[244:247]
    s_add_u32 s12, s61, s73
    s_add_u32 s13, s12, 4096
    s_lshl_b32 s61, s60, 2
    v_mfma_f32_16x16x32_bf16 v[248:251], a[236:239], a[32:35], v[248:251]
    ds_read_b64_tr_b16 a[252:253], v47 offset:4096
    ds_read_b64_tr_b16 a[254:255], v47 offset:6144
    v_mfma_f32_16x16x32_bf16 v[252:255], a[236:239], a[48:51], v[252:255]
    s_lshr_b32 s61, 0x52419876, s61
    s_and_b32 s61, s61, 15
    s_lshl_b32 s10, s61, 14
    s_waitcnt vmcnt(12) lgkmcnt(4)
    v_mfma_f32_16x16x32_bf16 v[224:227], a[240:243], a[36:39], v[224:227]
    ds_read_b64_tr_b16 a[224:225], v44 offset:8192
    ds_read_b64_tr_b16 a[226:227], v44 offset:10240
    v_mfma_f32_16x16x32_bf16 v[228:231], a[240:243], a[52:55], v[228:231]
    buffer_load_dwordx4 a[96:99], v53, s[40:43], s12 offen offset:0 sc1
    v_mfma_f32_16x16x32_bf16 v[232:235], a[244:247], a[36:39], v[232:235]
    ds_read_b64_tr_b16 a[228:229], v45 offset:8192
    ds_read_b64_tr_b16 a[230:231], v45 offset:10240
    v_mfma_f32_16x16x32_bf16 v[236:239], a[244:247], a[52:55], v[236:239]
    buffer_load_dwordx4 a[112:115], v53, s[40:43], s13 offen offset:0 sc1
    s_waitcnt lgkmcnt(4)
    v_mfma_f32_16x16x32_bf16 v[240:243], a[248:251], a[36:39], v[240:243]
    ds_read_b64_tr_b16 a[232:233], v46 offset:8192
    ds_read_b64_tr_b16 a[234:235], v46 offset:10240
    v_mfma_f32_16x16x32_bf16 v[244:247], a[248:251], a[52:55], v[244:247]
    buffer_load_dwordx4 a[100:103], v53, s[40:43], s12 offen offset:1024 sc1
    v_mfma_f32_16x16x32_bf16 v[248:251], a[252:255], a[36:39], v[248:251]
    ds_read_b64_tr_b16 a[236:237], v47 offset:8192
    ds_read_b64_tr_b16 a[238:239], v47 offset:10240
    v_mfma_f32_16x16x32_bf16 v[252:255], a[252:255], a[52:55], v[252:255]
    s_waitcnt vmcnt(13) lgkmcnt(4)
    v_mfma_f32_16x16x32_bf16 v[224:227], a[224:227], a[40:43], v[224:227]
    ds_read_b64_tr_b16 a[240:241], v44 offset:12288
    ds_read_b64_tr_b16 a[242:243], v44 offset:14336
    v_mfma_f32_16x16x32_bf16 v[228:231], a[224:227], a[56:59], v[228:231]
    buffer_load_dwordx4 a[116:119], v53, s[40:43], s13 offen offset:1024 sc1
    v_mfma_f32_16x16x32_bf16 v[232:235], a[228:231], a[40:43], v[232:235]
    ds_read_b64_tr_b16 a[244:245], v45 offset:12288
    ds_read_b64_tr_b16 a[246:247], v45 offset:14336
    v_mfma_f32_16x16x32_bf16 v[236:239], a[228:231], a[56:59], v[236:239]
    v_add_u32 v44, s9, v40
    v_add_u32 v45, s9, v41
    s_waitcnt lgkmcnt(4)
    v_mfma_f32_16x16x32_bf16 v[240:243], a[232:235], a[40:43], v[240:243]
    ds_read_b64_tr_b16 a[248:249], v46 offset:12288
    ds_read_b64_tr_b16 a[250:251], v46 offset:14336
    v_mfma_f32_16x16x32_bf16 v[244:247], a[232:235], a[56:59], v[244:247]
    buffer_load_dwordx4 a[104:107], v53, s[40:43], s12 offen offset:2048 sc1
    v_mfma_f32_16x16x32_bf16 v[248:251], a[236:239], a[40:43], v[248:251]
    ds_read_b64_tr_b16 a[252:253], v47 offset:12288
    ds_read_b64_tr_b16 a[254:255], v47 offset:14336
    v_mfma_f32_16x16x32_bf16 v[252:255], a[236:239], a[56:59], v[252:255]
    buffer_load_dwordx4 a[120:123], v53, s[40:43], s13 offen offset:2048 sc1
    v_add_u32 v46, s9, v42
    v_add_u32 v47, s9, v43
    s_waitcnt vmcnt(14) lgkmcnt(4)
    v_mfma_f32_16x16x32_bf16 v[224:227], a[240:243], a[44:47], v[224:227]
    ds_read_b64_tr_b16 a[224:225], v44 offset:0
    ds_read_b64_tr_b16 a[226:227], v44 offset:2048
    v_mfma_f32_16x16x32_bf16 v[228:231], a[240:243], a[60:63], v[228:231]
    buffer_load_dwordx4 a[108:111], v53, s[40:43], s12 offen offset:3072 sc1
    v_mfma_f32_16x16x32_bf16 v[232:235], a[244:247], a[44:47], v[232:235]
    ds_read_b64_tr_b16 a[228:229], v45 offset:0
    ds_read_b64_tr_b16 a[230:231], v45 offset:2048
    v_mfma_f32_16x16x32_bf16 v[236:239], a[244:247], a[60:63], v[236:239]
    s_waitcnt lgkmcnt(4)
    v_mfma_f32_16x16x32_bf16 v[240:243], a[248:251], a[44:47], v[240:243]
    ds_read_b64_tr_b16 a[232:233], v46 offset:0
    ds_read_b64_tr_b16 a[234:235], v46 offset:2048
    v_mfma_f32_16x16x32_bf16 v[244:247], a[248:251], a[60:63], v[244:247]
    buffer_load_dwordx4 a[124:127], v53, s[40:43], s13 offen offset:3072 sc1
    v_mfma_f32_16x16x32_bf16 v[248:251], a[252:255], a[44:47], v[248:251]
    ds_read_b64_tr_b16 a[236:237], v47 offset:0
    ds_read_b64_tr_b16 a[238:239], v47 offset:2048
    v_mfma_f32_16x16x32_bf16 v[252:255], a[252:255], a[60:63], v[252:255]
    s_waitcnt vmcnt(14) lgkmcnt(4)
    v_mfma_f32_16x16x32_bf16 v[224:227], a[224:227], a[64:67], v[224:227]
    ds_read_b64_tr_b16 a[240:241], v44 offset:4096
    ds_read_b64_tr_b16 a[242:243], v44 offset:6144
    v_mfma_f32_16x16x32_bf16 v[228:231], a[224:227], a[80:83], v[228:231]
    s_and_b32 s60, s7, s8
    s_cbranch_scc0 L_sel5_2
L_sel5_2_go:
    s_ff1_i32_b32 s60, s60
    s_bitset0_b32 s8, s60
    v_mfma_f32_16x16x32_bf16 v[232:235], a[228:231], a[64:67], v[232:235]
    ds_read_b64_tr_b16 a[244:245], v45 offset:4096
    ds_read_b64_tr_b16 a[246:247], v45 offset:6144
    v_mfma_f32_16x16x32_bf16 v[236:239], a[228:231], a[80:83], v[236:239]
    s_add_u32 s60, s60, s55
    s_and_b32 s60, s60, 7
    s_lshl_b32 s61, s60, 15
    s_waitcnt lgkmcnt(4)
    v_mfma_f32_16x16x32_bf16 v[240:243], a[232:235], a[64:67], v[240:243]
    ds_read_b64_tr_b16 a[248:249], v46 offset:4096
    ds_read_b64_tr_b16 a[250:251], v46 offset:6144
    v_mfma_f32_16x16x32_bf16 v[244:247], a[232:235], a[80:83], v[244:247]
    s_add_u32 s12, s61, s73
    s_add_u32 s13, s12, 4096
    s_lshl_b32 s61, s60, 2
    v_mfma_f32_16x16x32_bf16 v[248:251], a[236:239], a[64:67], v[248:251]
    ds_read_b64_tr_b16 a[252:253], v47 offset:4096
    ds_read_b64_tr_b16 a[254:255], v47 offset:6144
    v_mfma_f32_16x16x32_bf16 v[252:255], a[236:239], a[80:83], v[252:255]
    s_lshr_b32 s61, 0x52419876, s61
    s_and_b32 s61, s61, 15
    s_lshl_b32 s11, s61, 14
    s_waitcnt vmcnt(12) lgkmcnt(4)
    v_mfma_f32_16x16x32_bf16 v[224:227], a[240:243], a[68:71], v[224:227]
    ds_read_b64_tr_b16 a[224:225], v44 offset:8192
    ds_read_b64_tr_b16 a[226:227], v44 offset:10240
    v_mfma_f32_16x16x32_bf16 v[228:231], a[240:243], a[84:87], v[228:231]
    buffer_load_dwordx4 a[128:131], v53, s[40:43], s12 offen offset:0 sc1
    v_mfma_f32_16x16x32_bf16 v[232:235], a[244:247], a[68:71], v[232:235]
    ds_read_b64_tr_b16 a[228:229], v45 offset:8192
    ds_read_b64_tr_b16 a[230:231], v45 offset:10240
    v_mfma_f32_16x16x32_bf16 v[236:239], a[244:247], a[84:87], v[236:239]
    buffer_load_dwordx4 a[144:147], v53, s[40:43], s13 offen offset:0 sc1
    s_waitcnt lgkmcnt(4)
    v_mfma_f32_16x16x32_bf16 v[240:243], a[248:251], a[68:71], v[240:243]
    ds_read_b64_tr_b16 a[232:233], v46 offset:8192
    ds_read_b64_tr_b16 a[234:235], v46 offset:10240
    v_mfma_f32_16x16x32_bf16 v[244:247], a[248:251], a[84:87], v[244:247]
    buffer_load_dwordx4 a[132:135], v53, s[40:43], s12 offen offset:1024 sc1
    v_mfma_f32_16x16x32_bf16 v[248:251], a[252:255], a[68:71], v[248:251]
    ds_read_b64_tr_b16 a[236:237], v47 offset:8192
    ds_read_b64_tr_b16 a[238:239], v47 offset:10240
    v_mfma_f32_16x16x32_bf16 v[252:255], a[252:255], a[84:87], v[252:255]
    s_waitcnt vmcnt(13) lgkmcnt(4)
    v_mfma_f32_16x16x32_bf16 v[224:227], a[224:227], a[72:75], v[224:227]
    ds_read_b64_tr_b16 a[240:241], v44 offset:12288
    ds_read_b64_tr_b16 a[242:243], v44 offset:14336
    v_mfma_f32_16x16x32_bf16 v[228:231], a[224:227], a[88:91], v[228:231]
    buffer_load_dwordx4 a[148:151], v53, s[40:43], s13 offen offset:1024 sc1
    v_mfma_f32_16x16x32_bf16 v[232:235], a[228:231], a[72:75], v[232:235]
    ds_read_b64_tr_b16 a[244:245], v45 offset:12288
    ds_read_b64_tr_b16 a[246:247], v45 offset:14336
    v_mfma_f32_16x16x32_bf16 v[236:239], a[228:231], a[88:91], v[236:239]
    v_add_u32 v44, s10, v40
    v_add_u32 v45, s10, v41
    s_waitcnt lgkmcnt(4)
    v_mfma_f32_16x16x32_bf16 v[240:243], a[232:235], a[72:75], v[240:243]
    ds_read_b64_tr_b16 a[248:249], v46 offset:12288
    ds_read_b64_tr_b16 a[250:251], v46 offset:14336
    v_mfma_f32_16x16x32_bf16 v[244:247], a[232:235], a[88:91], v[244:247]
    buffer_load_dwordx4 a[136:139], v53, s[40:43], s12 offen offset:2048 sc1
    v_mfma_f32_16x16x32_bf16 v[248:251], a[236:239], a[72:75], v[248:251]
    ds_read_b64_tr_b16 a[252:253], v47 offset:12288
    ds_read_b64_tr_b16 a[254:255], v47 offset:14336
    v_mfma_f32_16x16x32_bf16 v[252:255], a[236:239], a[88:91], v[252:255]
    buffer_load_dwordx4 a[152:155], v53, s[40:43], s13 offen offset:2048 sc1
    v_add_u32 v46, s10, v42
    v_add_u32 v47, s10, v43
    s_waitcnt vmcnt(14) lgkmcnt(4)
    v_mfma_f32_16x16x32_bf16 v[224:227], a[240:243], a[76:79], v[224:227]
    ds_read_b64_tr_b16 a[224:225], v44 offset:0
    ds_read_b64_tr_b16 a[226:227], v44 offset:2048
    v_mfma_f32_16x16x32_bf16 v[228:231], a[240:243], a[92:95], v[228:231]
    buffer_load_dwordx4 a[140:143], v53, s[40:43], s12 offen offset:3072 sc1
    v_mfma_f32_16x16x32_bf16 v[232:235], a[244:247], a[76:79], v[232:235]
    ds_read_b64_tr_b16 a[228:229], v45 offset:0
    ds_read_b64_tr_b16 a[230:231], v45 offset:2048
    v_mfma_f32_16x16x32_bf16 v[236:239], a[244:247], a[92:95], v[236:239]
    s_waitcnt lgkmcnt(4)
    v_mfma_f32_16x16x32_bf16 v[240:243], a[248:251], a[76:79], v[240:243]
    ds_read_b64_tr_b16 a[232:233], v46 offset:0
    ds_read_b64_tr_b16 a[234:235], v46 offset:2048
    v_mfma_f32_16x16x32_bf16 v[244:247], a[248:251], a[92:95], v[244:247]
    buffer_load_dwordx4 a[156:159], v53, s[40:43], s13 offen offset:3072 sc1
    v_mfma_f32_16x16x32_bf16 v[248:251], a[252:255], a[76:79], v[248:251]
    ds_read_b64_tr_b16 a[236:237], v47 offset:0
    ds_read_b64_tr_b16 a[238:239], v47 offset:2048
    v_mfma_f32_16x16x32_bf16 v[252:255], a[252:255], a[92:95], v[252:255]
    s_waitcnt vmcnt(14) lgkmcnt(4)
    v_mfma_f32_16x16x32_bf16 v[224:227], a[224:227], a[96:99], v[224:227]
    ds_read_b64_tr_b16 a[240:241], v44 offset:4096
    ds_read_b64_tr_b16 a[242:243], v44 offset:6144
    v_mfma_f32_16x16x32_bf16 v[228:231], a[224:227], a[112:115], v[228:231]
    s_and_b32 s60, s7, s8
    s_cbranch_scc0 L_sel6_2
L_sel6_2_go:
    s_ff1_i32_b32 s60, s60
    s_bitset0_b32 s8, s60
    v_mfma_f32_16x16x32_bf16 v[232:235], a[228:231], a[96:99], v[232:235]
    ds_read_b64_tr_b16 a[244:245], v45 offset:4096
    ds_read_b64_tr_b16 a[246:247], v45 offset:6144
    v_mfma_f32_16x16x32_bf16 v[236:239], a[228:231], a[112:115], v[236:239]
    s_add_u32 s60, s60, s55
    s_and_b32 s60, s60, 7
    s_lshl_b32 s61, s60, 15
    s_waitcnt lgkmcnt(4)
    v_mfma_f32_16x16x32_bf16 v[240:243], a[232:235], a[96:99], v[240:243]
    ds_read_b64_tr_b16 a[248:249], v46 offset:4096
    ds_read_b64_tr_b16 a[250:251], v46 offset:6144
    v_mfma_f32_16x16x32_bf16 v[244:247], a[232:235], a[112:115], v[244:247]
    s_add_u32 s12, s61, s73
    s_add_u32 s13, s12, 4096
    s_lshl_b32 s61, s60, 2
    v_mfma_f32_16x16x32_bf16 v[248:251], a[236:239], a[96:99], v[248:251]
    ds_read_b64_tr_b16 a[252:253], v47 offset:4096
    ds_read_b64_tr_b16 a[254:255], v47 offset:6144
    v_mfma_f32_16x16x32_bf16 v[252:255], a[236:239], a[112:115], v[252:255]
    s_lshr_b32 s61, 0x52419876, s61
    s_and_b32 s61, s61, 15
    s_lshl_b32 s9, s61, 14
    s_waitcnt vmcnt(12) lgkmcnt(4)
    v_mfma_f32_16x16x32_bf16 v[224:227], a[240:243], a[100:103], v[224:227]
    ds_read_b64_tr_b16 a[224:225], v44 offset:8192
    ds_read_b64_tr_b16 a[226:227], v44 offset:10240
    v_mfma_f32_16x16x32_bf16 v[228:231], a[240:243], a[116:119], v[228:231]
    buffer_load_dwordx4 a[160:163], v53, s[40:43], s12 offen offset:0 sc1
    v_mfma_f32_16x16x32_bf16 v[232:235], a[244:247], a[100:103], v[232:235]
    ds_read_b64_tr_b16 a[228:229], v45 offset:8192
    ds_read_b64_tr_b16 a[230:231], v45 offset:10240
    v_mfma_f32_16x16x32_bf16 v[236:239], a[244:247], a[116:119], v[236:239]
    buffer_load_dwordx4 a[176:179], v53, s[40:43], s13 offen offset:0 sc1
    s_waitcnt lgkmcnt(4)
    v_mfma_f32_16x16x32_bf16 v[240:243], a[248:251], a[100:103], v[240:243]
    ds_read_b64_tr_b16 a[232:233], v46 offset:8192
    ds_read_b64_tr_b16 a[234:235], v46 offset:10240
    v_mfma_f32_16x16x32_bf16 v[244:247], a[248:251], a[116:119], v[244:247]
    buffer_load_dwordx4 a[164:167], v53, s[40:43], s12 offen offset:1024 sc1
    v_mfma_f32_16x16x32_bf16 v[248:251], a[252:255], a[100:103], v[248:251]
    ds_read_b64_tr_b16 a[236:237], v47 offset:8192
    ds_read_b64_tr_b16 a[238:239], v47 offset:10240
    v_mfma_f32_16x16x32_bf16 v[252:255], a[252:255], a[116:119], v[252:255]
    s_waitcnt vmcnt(13) lgkmcnt(4)
    v_mfma_f32_16x16x32_bf16 v[224:227], a[224:227], a[104:107], v[224:227]
    ds_read_b64_tr_b16 a[240:241], v44 offset:12288
    ds_read_b64_tr_b16 a[242:243], v44 offset:14336
    v_mfma_f32_16x16x32_bf16 v[228:231], a[224:227], a[120:123], v[228:231]
    buffer_load_dwordx4 a[180:183], v53, s[40:43], s13 offen offset:1024 sc1
    v_mfma_f32_16x16x32_bf16 v[232:235], a[228:231], a[104:107], v[232:235]
    ds_read_b64_tr_b16 a[244:245], v45 offset:12288
    ds_read_b64_tr_b16 a[246:247], v45 offset:14336
    v_mfma_f32_16x16x32_bf16 v[236:239], a[228:231], a[120:123], v[236:239]
    v_add_u32 v44, s11, v40
    v_add_u32 v45, s11, v41
    s_waitcnt lgkmcnt(4)
    v_mfma_f32_16x16x32_bf16 v[240:243], a[232:235], a[104:107], v[240:243]
    ds_read_b64_tr_b16 a[248:249], v46 offset:12288
    ds_read_b64_tr_b16 a[250:251], v46 offset:14336
    v_mfma_f32_16x16x32_bf16 v[244:247], a[232:235], a[120:123], v[244:247]
    buffer_load_dwordx4 a[168:171], v53, s[40:43], s12 offen offset:2048 sc1
    v_mfma_f32_16x16x32_bf16 v[248:251], a[236:239], a[104:107], v[248:251]
    ds_read_b64_tr_b16 a[252:253], v47 offset:12288
    ds_read_b64_tr_b16 a[254:255], v47 offset:14336
    v_mfma_f32_16x16x32_bf16 v[252:255], a[236:239], a[120:123], v[252:255]
    buffer_load_dwordx4 a[184:187], v53, s[40:43], s13 offen offset:2048 sc1
    v_add_u32 v46, s11, v42
    v_add_u32 v47, s11, v43
    s_waitcnt vmcnt(14) lgkmcnt(4)
    v_mfma_f32_16x16x32_bf16 v[224:227], a[240:243], a[108:111], v[224:227]
    ds_read_b64_tr_b16 a[224:225], v44 offset:0
    ds_read_b64_tr_b16 a[226:227], v44 offset:2048
    v_mfma_f32_16x16x32_bf16 v[228:231], a[240:243], a[124:127], v[228:231]
    buffer_load_dwordx4 a[172:175], v53, s[40:43], s12 offen offset:3072 sc1
    v_mfma_f32_16x16x32_bf16 v[232:235], a[244:247], a[108:111], v[232:235]
    ds_read_b64_tr_b16 a[228:229], v45 offset:0
    ds_read_b64_tr_b16 a[230:231], v45 offset:2048
    v_mfma_f32_16x16x32_bf16 v[236:239], a[244:247], a[124:127], v[236:239]
    s_waitcnt lgkmcnt(4)
    v_mfma_f32_16x16x32_bf16 v[240:243], a[248:251], a[108:111], v[240:243]
    ds_read_b64_tr_b16 a[232:233], v46 offset:0
    ds_read_b64_tr_b16 a[234:235], v46 offset:2048
    v_mfma_f32_16x16x32_bf16 v[244:247], a[248:251], a[124:127], v[244:247]
    buffer_load_dwordx4 a[188:191], v53, s[40:43], s13 offen offset:3072 sc1
    v_mfma_f32_16x16x32_bf16 v[248:251], a[252:255], a[108:111], v[248:251]
    ds_read_b64_tr_b16 a[236:237], v47 offset:0
    ds_read_b64_tr_b16 a[238:239], v47 offset:2048
    v_mfma_f32_16x16x32_bf16 v[252:255], a[252:255], a[124:127], v[252:255]
    s_waitcnt vmcnt(14) lgkmcnt(4)
    v_mfma_f32_16x16x32_bf16 v[224:227], a[224:227], a[128:131], v[224:227]
    ds_read_b64_tr_b16 a[240:241], v44 offset:4096
    ds_read_b64_tr_b16 a[242:243], v44 offset:6144
    v_mfma_f32_16x16x32_bf16 v[228:231], a[224:227], a[144:147], v[228:231]
    s_and_b32 s60, s7, s8
    s_cbranch_scc0 L_sel7_2
L_sel7_2_go:
    s_ff1_i32_b32 s60, s60
    s_bitset0_b32 s8, s60
    v_mfma_f32_16x16x32_bf16 v[232:235], a[228:231], a[128:131], v[232:235]
    ds_read_b64_tr_b16 a[244:245], v45 offset:4096
    ds_read_b64_tr_b16 a[246:247], v45 offset:6144
    v_mfma_f32_16x16x32_bf16 v[236:239], a[228:231], a[144:147], v[236:239]
    s_add_u32 s60, s60, s55
    s_and_b32 s60, s60, 7
    s_lshl_b32 s61, s60, 15
    s_waitcnt lgkmcnt(4)
    v_mfma_f32_16x16x32_bf16 v[240:243], a[232:235], a[128:131], v[240:243]
    ds_read_b64_tr_b16 a[248:249], v46 offset:4096
    ds_read_b64_tr_b16 a[250:251], v46 offset:6144
    v_mfma_f32_16x16x32_bf16 v[244:247], a[232:235], a[144:147], v[244:247]
    s_add_u32 s12, s61, s73
    s_add_u32 s13, s12, 4096
    s_lshl_b32 s61, s60, 2
    v_mfma_f32_16x16x32_bf16 v[248:251], a[236:239], a[128:131], v[248:251]
    ds_read_b64_tr_b16 a[252:253], v47 offset:4096
    ds_read_b64_tr_b16 a[254:255], v47 offset:6144
    v_mfma_f32_16x16x32_bf16 v[252:255], a[236:239], a[144:147], v[252:255]
    s_lshr_b32 s61, 0x52419876, s61
    s_and_b32 s61, s61, 15
    s_lshl_b32 s10, s61, 14
    s_waitcnt vmcnt(12) lgkmcnt(4)
    v_mfma_f32_16x16x32_bf16 v[224:227], a[240:243], a[132:135], v[224:227]
    ds_read_b64_tr_b16 a[224:225], v44 offset:8192
    ds_read_b64_tr_b16 a[226:227], v44 offset:10240
    v_mfma_f32_16x16x32_bf16 v[228:231], a[240:243], a[148:151], v[228:231]
    buffer_load_dwordx4 a[192:195], v53, s[40:43], s12 offen offset:0 sc1
    v_mfma_f32_16x16x32_bf16 v[232:235], a[244:247], a[132:135], v[232:235]
    ds_read_b64_tr_b16 a[228:229], v45 offset:8192
    ds_read_b64_tr_b16 a[230:231], v45 offset:10240
    v_mfma_f32_16x16x32_bf16 v[236:239], a[244:247], a[148:151], v[236:239]
    buffer_load_dwordx4 a[208:211], v53, s[40:43], s13 offen offset:0 sc1
    s_waitcnt lgkmcnt(4)
    v_mfma_f32_16x16x32_bf16 v[240:243], a[248:251], a[132:135], v[240:243]
    ds_read_b64_tr_b16 a[232:233], v46 offset:8192
    ds_read_b64_tr_b16 a[234:235], v46 offset:10240
    v_mfma_f32_16x16x32_bf16 v[244:247], a[248:251], a[148:151], v[244:247]
    buffer_load_dwordx4 a[196:199], v53, s[40:43], s12 offen offset:1024 sc1
    v_mfma_f32_16x16x32_bf16 v[248:251], a[252:255], a[132:135], v[248:251]
    ds_read_b64_tr_b16 a[236:237], v47 offset:8192
    ds_read_b64_tr_b16 a[238:239], v47 offset:10240
    v_mfma_f32_16x16x32_bf16 v[252:255], a[252:255], a[148:151], v[252:255]
    s_waitcnt vmcnt(13) lgkmcnt(4)
    v_mfma_f32_16x16x32_bf16 v[224:227], a[224:227], a[136:139], v[224:227]
    ds_read_b64_tr_b16 a[240:241], v44 offset:12288
    ds_read_b64_tr_b16 a[242:243], v44 offset:14336
    v_mfma_f32_16x16x32_bf16 v[228:231], a[224:227], a[152:155], v[228:231]
    buffer_load_dwordx4 a[212:215], v53, s[40:43], s13 offen offset:1024 sc1
    v_mfma_f32_16x16x32_bf16 v[232:235], a[228:231], a[136:139], v[232:235]
    ds_read_b64_tr_b16 a[244:245], v45 offset:12288
    ds_read_b64_tr_b16 a[246:247], v45 offset:14336
    v_mfma_f32_16x16x32_bf16 v[236:239], a[228:231], a[152:155], v[236:239]
    v_add_u32 v44, s9, v40
    v_add_u32 v45, s9, v41
    s_waitcnt lgkmcnt(4)
    v_mfma_f32_16x16x32_bf16 v[240:243], a[232:235], a[136:139], v[240:243]
    ds_read_b64_tr_b16 a[248:249], v46 offset:12288
    ds_read_b64_tr_b16 a[250:251], v46 offset:14336
    v_mfma_f32_16x16x32_bf16 v[244:247], a[232:235], a[152:155], v[244:247]
    buffer_load_dwordx4 a[200:203], v53, s[40:43], s12 offen offset:2048 sc1
    v_mfma_f32_16x16x32_bf16 v[248:251], a[236:239], a[136:139], v[248:251]
    ds_read_b64_tr_b16 a[252:253], v47 offset:12288
    ds_read_b64_tr_b16 a[254:255], v47 offset:14336
    v_mfma_f32_16x16x32_bf16 v[252:255], a[236:239], a[152:155], v[252:255]
    buffer_load_dwordx4 a[216:219], v53, s[40:43], s13 offen offset:2048 sc1
    v_add_u32 v46, s9, v42
    v_add_u32 v47, s9, v43
    s_waitcnt vmcnt(14) lgkmcnt(4)
    v_mfma_f32_16x16x32_bf16 v[224:227], a[240:243], a[140:143], v[224:227]
    ds_read_b64_tr_b16 a[224:225], v44 offset:0
    ds_read_b64_tr_b16 a[226:227], v44 offset:2048
    v_mfma_f32_16x16x32_bf16 v[228:231], a[240:243], a[156:159], v[228:231]
    buffer_load_dwordx4 a[204:207], v53, s[40:43], s12 offen offset:3072 sc1
    v_mfma_f32_16x16x32_bf16 v[232:235], a[244:247], a[140:143], v[232:235]
    ds_read_b64_tr_b16 a[228:229], v45 offset:0
    ds_read_b64_tr_b16 a[230:231], v45 offset:2048
    v_mfma_f32_16x16x32_bf16 v[236:239], a[244:247], a[156:159], v[236:239]
    s_waitcnt lgkmcnt(4)
    v_mfma_f32_16x16x32_bf16 v[240:243], a[248:251], a[140:143], v[240:243]
    ds_read_b64_tr_b16 a[232:233], v46 offset:0
    ds_read_b64_tr_b16 a[234:235], v46 offset:2048
    v_mfma_f32_16x16x32_bf16 v[244:247], a[248:251], a[156:159], v[244:247]
    buffer_load_dwordx4 a[220:223], v53, s[40:43], s13 offen offset:3072 sc1
    v_mfma_f32_16x16x32_bf16 v[248:251], a[252:255], a[140:143], v[248:251]
    ds_read_b64_tr_b16 a[236:237], v47 offset:0
    ds_read_b64_tr_b16 a[238:239], v47 offset:2048
    v_mfma_f32_16x16x32_bf16 v[252:255], a[252:255], a[156:159], v[252:255]
    s_waitcnt vmcnt(14) lgkmcnt(4)
    v_mfma_f32_16x16x32_bf16 v[224:227], a[224:227], a[160:163], v[224:227]
    ds_read_b64_tr_b16 a[240:241], v44 offset:4096
    ds_read_b64_tr_b16 a[242:243], v44 offset:6144
    v_mfma_f32_16x16x32_bf16 v[228:231], a[224:227], a[176:179], v[228:231]
    v_mfma_f32_16x16x32_bf16 v[232:235], a[228:231], a[160:163], v[232:235]
    ds_read_b64_tr_b16 a[244:245], v45 offset:4096
    ds_read_b64_tr_b16 a[246:247], v45 offset:6144
    v_mfma_f32_16x16x32_bf16 v[236:239], a[228:231], a[176:179], v[236:239]
    s_waitcnt lgkmcnt(4)
    v_mfma_f32_16x16x32_bf16 v[240:243], a[232:235], a[160:163], v[240:243]
    ds_read_b64_tr_b16 a[248:249], v46 offset:4096
    ds_read_b64_tr_b16 a[250:251], v46 offset:6144
    v_mfma_f32_16x16x32_bf16 v[244:247], a[232:235], a[176:179], v[244:247]
    v_mfma_f32_16x16x32_bf16 v[248:251], a[236:239], a[160:163], v[248:251]
    ds_read_b64_tr_b16 a[252:253], v47 offset:4096
    ds_read_b64_tr_b16 a[254:255], v47 offset:6144
    v_mfma_f32_16x16x32_bf16 v[252:255], a[236:239], a[176:179], v[252:255]
    s_waitcnt vmcnt(12) lgkmcnt(4)
    v_mfma_f32_16x16x32_bf16 v[224:227], a[240:243], a[164:167], v[224:227]
    ds_read_b64_tr_b16 a[224:225], v44 offset:8192
    ds_read_b64_tr_b16 a[226:227], v44 offset:10240
    v_mfma_f32_16x16x32_bf16 v[228:231], a[240:243], a[180:183], v[228:231]
    v_mfma_f32_16x16x32_bf16 v[232:235], a[244:247], a[164:167], v[232:235]
    ds_read_b64_tr_b16 a[228:229], v45 offset:8192
    ds_read_b64_tr_b16 a[230:231], v45 offset:10240
    v_mfma_f32_16x16x32_bf16 v[236:239], a[244:247], a[180:183], v[236:239]
    s_waitcnt lgkmcnt(4)
    v_mfma_f32_16x16x32_bf16 v[240:243], a[248:251], a[164:167], v[240:243]
    ds_read_b64_tr_b16 a[232:233], v46 offset:8192
    ds_read_b64_tr_b16 a[234:235], v46 offset:10240
    v_mfma_f32_16x16x32_bf16 v[244:247], a[248:251], a[180:183], v[244:247]
    v_mfma_f32_16x16x32_bf16 v[248:251], a[252:255], a[164:167], v[248:251]
    ds_read_b64_tr_b16 a[236:237], v47 offset:8192
    ds_read_b64_tr_b16 a[238:239], v47 offset:10240
    v_mfma_f32_16x16x32_bf16 v[252:255], a[252:255], a[180:183], v[252:255]
    s_waitcnt vmcnt(10) lgkmcnt(4)
    v_mfma_f32_16x16x32_bf16 v[224:227], a[224:227], a[168:171], v[224:227]
    ds_read_b64_tr_b16 a[240:241], v44 offset:12288
    ds_read_b64_tr_b16 a[242:243], v44 offset:14336
    v_mfma_f32_16x16x32_bf16 v[228:231], a[224:227], a[184:187], v[228:231]
    v_mfma_f32_16x16x32_bf16 v[232:235], a[228:231], a[168:171], v[232:235]
    ds_read_b64_tr_b16 a[244:245], v45 offset:12288
    ds_read_b64_tr_b16 a[246:247], v45 offset:14336
    v_mfma_f32_16x16x32_bf16 v[236:239], a[228:231], a[184:187], v[236:239]
    v_add_u32 v44, s10, v40
    v_add_u32 v45, s10, v41
    s_waitcnt lgkmcnt(4)
    v_mfma_f32_16x16x32_bf16 v[240:243], a[232:235], a[168:171], v[240:243]
    ds_read_b64_tr_b16 a[248:249], v46 offset:12288
    ds_read_b64_tr_b16 a[250:251], v46 offset:14336
    v_mfma_f32_16x16x32_bf16 v[244:247], a[232:235], a[184:187], v[244:247]
    v_mfma_f32_16x16x32_bf16 v[248:251], a[236:239], a[168:171], v[248:251]
    ds_read_b64_tr_b16 a[252:253], v47 offset:12288
    ds_read_b64_tr_b16 a[254:255], v47 offset:14336
    v_mfma_f32_16x16x32_bf16 v[252:255], a[236:239], a[184:187], v[252:255]
    v_add_u32 v46, s10, v42
    v_add_u32 v47, s10, v43
    s_waitcnt vmcnt(8) lgkmcnt(4)
    v_mfma_f32_16x16x32_bf16 v[224:227], a[240:243], a[172:175], v[224:227]
    ds_read_b64_tr_b16 a[224:225], v44 offset:0
    ds_read_b64_tr_b16 a[226:227], v44 offset:2048
    v_mfma_f32_16x16x32_bf16 v[228:231], a[240:243], a[188:191], v[228:231]
    v_mfma_f32_16x16x32_bf16 v[232:235], a[244:247], a[172:175], v[232:235]
    ds_read_b64_tr_b16 a[228:229], v45 offset:0
    ds_read_b64_tr_b16 a[230:231], v45 offset:2048
    v_mfma_f32_16x16x32_bf16 v[236:239], a[244:247], a[188:191], v[236:239]
    s_waitcnt lgkmcnt(4)
    v_mfma_f32_16x16x32_bf16 v[240:243], a[248:251], a[172:175], v[240:243]
    ds_read_b64_tr_b16 a[232:233], v46 offset:0
    ds_read_b64_tr_b16 a[234:235], v46 offset:2048
    v_mfma_f32_16x16x32_bf16 v[244:247], a[248:251], a[188:191], v[244:247]
    v_mfma_f32_16x16x32_bf16 v[248:251], a[252:255], a[172:175], v[248:251]
    ds_read_b64_tr_b16 a[236:237], v47 offset:0
    ds_read_b64_tr_b16 a[238:239], v47 offset:2048
    v_mfma_f32_16x16x32_bf16 v[252:255], a[252:255], a[188:191], v[252:255]
    s_waitcnt vmcnt(6) lgkmcnt(4)
    v_mfma_f32_16x16x32_bf16 v[224:227], a[224:227], a[192:195], v[224:227]
    ds_read_b64_tr_b16 a[240:241], v44 offset:4096
    ds_read_b64_tr_b16 a[242:243], v44 offset:6144
    v_mfma_f32_16x16x32_bf16 v[228:231], a[224:227], a[208:211], v[228:231]
    v_mfma_f32_16x16x32_bf16 v[232:235], a[228:231], a[192:195], v[232:235]
    ds_read_b64_tr_b16 a[244:245], v45 offset:4096
    ds_read_b64_tr_b16 a[246:247], v45 offset:6144
    v_mfma_f32_16x16x32_bf16 v[236:239], a[228:231], a[208:211], v[236:239]
    s_waitcnt lgkmcnt(4)
    v_mfma_f32_16x16x32_bf16 v[240:243], a[232:235], a[192:195], v[240:243]
    ds_read_b64_tr_b16 a[248:249], v46 offset:4096
    ds_read_b64_tr_b16 a[250:251], v46 offset:6144
    v_mfma_f32_16x16x32_bf16 v[244:247], a[232:235], a[208:211], v[244:247]
    v_mfma_f32_16x16x32_bf16 v[248:251], a[236:239], a[192:195], v[248:251]
    ds_read_b64_tr_b16 a[252:253], v47 offset:4096
    ds_read_b64_tr_b16 a[254:255], v47 offset:6144
    v_mfma_f32_16x16x32_bf16 v[252:255], a[236:239], a[208:211], v[252:255]
    s_waitcnt vmcnt(4) lgkmcnt(4)
    v_mfma_f32_16x16x32_bf16 v[224:227], a[240:243], a[196:199], v[224:227]
    ds_read_b64_tr_b16 a[224:225], v44 offset:8192
    ds_read_b64_tr_b16 a[226:227], v44 offset:10240
    v_mfma_f32_16x16x32_bf16 v[228:231], a[240:243], a[212:215], v[228:231]
    v_mfma_f32_16x16x32_bf16 v[232:235], a[244:247], a[196:199], v[232:235]
    ds_read_b64_tr_b16 a[228:229], v45 offset:8192
    ds_read_b64_tr_b16 a[230:231], v45 offset:10240
    v_mfma_f32_16x16x32_bf16 v[236:239], a[244:247], a[212:215], v[236:239]
    s_waitcnt lgkmcnt(4)
    v_mfma_f32_16x16x32_bf16 v[240:243], a[248:251], a[196:199], v[240:243]
    ds_read_b64_tr_b16 a[232:233], v46 offset:8192
    ds_read_b64_tr_b16 a[234:235], v46 offset:10240
    v_mfma_f32_16x16x32_bf16 v[244:247], a[248:251], a[212:215], v[244:247]
    v_mfma_f32_16x16x32_bf16 v[248:251], a[252:255], a[196:199], v[248:251]
    ds_read_b64_tr_b16 a[236:237], v47 offset:8192
    ds_read_b64_tr_b16 a[238:239], v47 offset:10240
    v_mfma_f32_16x16x32_bf16 v[252:255], a[252:255], a[212:215], v[252:255]
    s_waitcnt vmcnt(2) lgkmcnt(4)
    v_mfma_f32_16x16x32_bf16 v[224:227], a[224:227], a[200:203], v[224:227]
    ds_read_b64_tr_b16 a[240:241], v46 offset:12288
    ds_read_b64_tr_b16 a[242:243], v46 offset:14336
    v_mfma_f32_16x16x32_bf16 v[228:231], a[224:227], a[216:219], v[228:231]
    v_mfma_f32_16x16x32_bf16 v[232:235], a[228:231], a[200:203], v[232:235]
    ds_read_b64_tr_b16 a[244:245], v47 offset:12288
    ds_read_b64_tr_b16 a[246:247], v47 offset:14336
    v_mfma_f32_16x16x32_bf16 v[236:239], a[228:231], a[216:219], v[236:239]
    s_waitcnt lgkmcnt(4)
    v_mfma_f32_16x16x32_bf16 v[240:243], a[232:235], a[200:203], v[240:243]
    ds_read_b64_tr_b16 a[248:249], v44 offset:12288
    ds_read_b64_tr_b16 a[250:251], v44 offset:14336
    v_mfma_f32_16x16x32_bf16 v[244:247], a[232:235], a[216:219], v[244:247]
    v_mfma_f32_16x16x32_bf16 v[248:251], a[236:239], a[200:203], v[248:251]
    ds_read_b64_tr_b16 a[252:253], v45 offset:12288
    ds_read_b64_tr_b16 a[254:255], v45 offset:14336
    v_mfma_f32_16x16x32_bf16 v[252:255], a[236:239], a[216:219], v[252:255]
    s_waitcnt vmcnt(0) lgkmcnt(4)
    v_mfma_f32_16x16x32_bf16 v[240:243], a[240:243], a[204:207], v[240:243]
    v_mfma_f32_16x16x32_bf16 v[244:247], a[240:243], a[220:223], v[244:247]
    v_mfma_f32_16x16x32_bf16 v[248:251], a[244:247], a[204:207], v[248:251]
    v_mfma_f32_16x16x32_bf16 v[252:255], a[244:247], a[220:223], v[252:255]
    s_waitcnt lgkmcnt(0)
    v_mfma_f32_16x16x32_bf16 v[232:235], a[252:255], a[204:207], v[232:235]
    v_mfma_f32_16x16x32_bf16 v[236:239], a[252:255], a[220:223], v[236:239]
    v_mfma_f32_16x16x32_bf16 v[224:227], a[248:251], a[204:207], v[224:227]
    v_mfma_f32_16x16x32_bf16 v[228:231], a[248:251], a[220:223], v[228:231]
    s_lshl_b32 s69, s56, 11
    s_add_u32 s69, s69, s74
    s_xor_b32 s60, s56, 1
    s_lshl_b32 s60, s60, 13
    s_add_u32 s66, s60, s69
    s_xor_b32 s60, s56, 2
    s_lshl_b32 s60, s60, 13
    s_add_u32 s67, s60, s69
    s_xor_b32 s60, s56, 3
    s_lshl_b32 s60, s60, 13
    s_add_u32 s68, s60, s69
    buffer_store_dwordx4 v[232:235], v53, s[40:43], s66 offen offset:0 sc1
    buffer_store_dwordx4 v[236:239], v53, s[40:43], s66 offen offset:1024 sc1
    buffer_store_dwordx4 v[240:243], v53, s[40:43], s67 offen offset:0 sc1
    buffer_store_dwordx4 v[244:247], v53, s[40:43], s67 offen offset:1024 sc1
    buffer_store_dwordx4 v[248:251], v53, s[40:43], s68 offen offset:0 sc1
    buffer_store_dwordx4 v[252:255], v53, s[40:43], s68 offen offset:1024 sc1
    s_lshl_b32 s69, s56, 13
    s_add_u32 s69, s69, s74
    s_xor_b32 s60, s56, 1
    s_lshl_b32 s60, s60, 11
    s_add_u32 s66, s60, s69
    s_xor_b32 s60, s56, 2
    s_lshl_b32 s60, s60, 11
    s_add_u32 s67, s60, s69
    s_xor_b32 s60, s56, 3
    s_lshl_b32 s60, s60, 11
    s_add_u32 s68, s60, s69
    s_waitcnt vmcnt(0)
    s_mov_b64 exec, 14
    buffer_store_dwordx2 v[184:185], v188, s[40:43], 0 offen sc1
    s_mov_b64 exec, -1
    s_mov_b32 s75, 0
L_p2_2:
    buffer_load_dwordx2 v[186:187], v52, s[40:43], 0 offen sc1
    s_add_u32 s75, s75, 1
    s_cmp_gt_u32 s75, 4000000
    s_cbranch_scc1 L_p2_2_out
    s_waitcnt vmcnt(0)
    v_cmp_ne_u64 vcc, v[184:185], v[186:187]
    s_cbranch_vccz L_p2_2_out
    s_branch L_p2_2
L_p2_2_out:
    buffer_load_dwordx4 v[232:235], v53, s[40:43], s66 offen offset:0 sc1
    buffer_load_dwordx4 v[236:239], v53, s[40:43], s66 offen offset:1024 sc1
    buffer_load_dwordx4 v[240:243], v53, s[40:43], s67 offen offset:0 sc1
    buffer_load_dwordx4 v[244:247], v53, s[40:43], s67 offen offset:1024 sc1
    buffer_load_dwordx4 v[248:251], v53, s[40:43], s68 offen offset:0 sc1
    buffer_load_dwordx4 v[252:255], v53, s[40:43], s68 offen offset:1024 sc1
    s_waitcnt vmcnt(4)
    v_add_f32 v224, v224, v232
    v_add_f32 v225, v225, v233
    v_add_f32 v226, v226, v234
    v_add_f32 v227, v227, v235
    v_add_f32 v228, v228, v236
    v_add_f32 v229, v229, v237
    v_add_f32 v230, v230, v238
    v_add_f32 v231, v231, v239
    s_waitcnt vmcnt(2)
    v_add_f32 v224, v224, v240
    v_add_f32 v225, v225, v241
    v_add_f32 v226, v226, v242
    v_add_f32 v227, v227, v243
    v_add_f32 v228, v228, v244
    v_add_f32 v229, v229, v245
    v_add_f32 v230, v230, v246
    v_add_f32 v231, v231, v247
    s_waitcnt vmcnt(0)
    v_add_f32 v224, v224, v248
    v_add_f32 v225, v225, v249
    v_add_f32 v226, v226, v250
    v_add_f32 v227, v227, v251
    v_add_f32 v228, v228, v252
    v_add_f32 v229, v229, v253
    v_add_f32 v230, v230, v254
    v_add_f32 v231, v231, v255
    v_cvt_pk_bf16_f32 v176, v224, v225
    v_cvt_pk_bf16_f32 v177, v226, v227
    v_cvt_pk_bf16_f32 v178, v228, v229
    v_cvt_pk_bf16_f32 v179, v230, v231
    s_nop 1
    v_permlane16_swap_b32 v176, v178
    v_permlane16_swap_b32 v177, v179
    buffer_store_dwordx4 v[176:179], v54, s[44:47], 0 offen
L_end:
    s_endpgm
L_slow_2:
    s_waitcnt lgkmcnt(0)
    s_waitcnt lgkmcnt(4)
    v_mfma_f32_16x16x32_bf16 v[224:227], a[224:227], v[192:195], 0
    ds_read_b64_tr_b16 a[240:241], v44 offset:4096
    ds_read_b64_tr_b16 a[242:243], v44 offset:6144
    v_mfma_f32_16x16x32_bf16 v[228:231], a[224:227], v[208:211], 0
    v_mfma_f32_16x16x32_bf16 v[232:235], a[228:231], v[192:195], 0
    ds_read_b64_tr_b16 a[244:245], v45 offset:4096
    ds_read_b64_tr_b16 a[246:247], v45 offset:6144
    v_mfma_f32_16x16x32_bf16 v[236:239], a[228:231], v[208:211], 0
    s_waitcnt lgkmcnt(4)
    v_mfma_f32_16x16x32_bf16 v[240:243], a[232:235], v[192:195], 0
    ds_read_b64_tr_b16 a[248:249], v46 offset:4096
    ds_read_b64_tr_b16 a[250:251], v46 offset:6144
    v_mfma_f32_16x16x32_bf16 v[244:247], a[232:235], v[208:211], 0
    v_mfma_f32_16x16x32_bf16 v[248:251], a[236:239], v[192:195], 0
    ds_read_b64_tr_b16 a[252:253], v47 offset:4096
    ds_read_b64_tr_b16 a[254:255], v47 offset:6144
    v_mfma_f32_16x16x32_bf16 v[252:255], a[236:239], v[208:211], 0
    s_waitcnt lgkmcnt(4)
    v_mfma_f32_16x16x32_bf16 v[224:227], a[240:243], v[196:199], v[224:227]
    ds_read_b64_tr_b16 a[224:225], v44 offset:8192
    ds_read_b64_tr_b16 a[226:227], v44 offset:10240
    v_mfma_f32_16x16x32_bf16 v[228:231], a[240:243], v[212:215], v[228:231]
    v_mfma_f32_16x16x32_bf16 v[232:235], a[244:247], v[196:199], v[232:235]
    ds_read_b64_tr_b16 a[228:229], v45 offset:8192
    ds_read_b64_tr_b16 a[230:231], v45 offset:10240
    v_mfma_f32_16x16x32_bf16 v[236:239], a[244:247], v[212:215], v[236:239]
    s_waitcnt lgkmcnt(4)
    v_mfma_f32_16x16x32_bf16 v[240:243], a[248:251], v[196:199], v[240:243]
    ds_read_b64_tr_b16 a[232:233], v46 offset:8192
    ds_read_b64_tr_b16 a[234:235], v46 offset:10240
    v_mfma_f32_16x16x32_bf16 v[244:247], a[248:251], v[212:215], v[244:247]
    v_mfma_f32_16x16x32_bf16 v[248:251], a[252:255], v[196:199], v[248:251]
    ds_read_b64_tr_b16 a[236:237], v47 offset:8192
    ds_read_b64_tr_b16 a[238:239], v47 offset:10240
    v_mfma_f32_16x16x32_bf16 v[252:255], a[252:255], v[212:215], v[252:255]
    s_waitcnt lgkmcnt(4)
    v_mfma_f32_16x16x32_bf16 v[224:227], a[224:227], v[200:203], v[224:227]
    ds_read_b64_tr_b16 a[240:241], v44 offset:12288
    ds_read_b64_tr_b16 a[242:243], v44 offset:14336
    v_mfma_f32_16x16x32_bf16 v[228:231], a[224:227], v[216:219], v[228:231]
    v_mfma_f32_16x16x32_bf16 v[232:235], a[228:231], v[200:203], v[232:235]
    ds_read_b64_tr_b16 a[244:245], v45 offset:12288
    ds_read_b64_tr_b16 a[246:247], v45 offset:14336
    v_mfma_f32_16x16x32_bf16 v[236:239], a[228:231], v[216:219], v[236:239]
    s_waitcnt lgkmcnt(4)
    v_mfma_f32_16x16x32_bf16 v[240:243], a[232:235], v[200:203], v[240:243]
    ds_read_b64_tr_b16 a[248:249], v46 offset:12288
    ds_read_b64_tr_b16 a[250:251], v46 offset:14336
    v_mfma_f32_16x16x32_bf16 v[244:247], a[232:235], v[216:219], v[244:247]
    v_mfma_f32_16x16x32_bf16 v[248:251], a[236:239], v[200:203], v[248:251]
    ds_read_b64_tr_b16 a[252:253], v47 offset:12288
    ds_read_b64_tr_b16 a[254:255], v47 offset:14336
    v_mfma_f32_16x16x32_bf16 v[252:255], a[236:239], v[216:219], v[252:255]
    s_waitcnt lgkmcnt(4)
    v_mfma_f32_16x16x32_bf16 v[224:227], a[240:243], v[204:207], v[224:227]
    v_mfma_f32_16x16x32_bf16 v[228:231], a[240:243], v[220:223], v[228:231]
    v_mfma_f32_16x16x32_bf16 v[232:235], a[244:247], v[204:207], v[232:235]
    v_mfma_f32_16x16x32_bf16 v[236:239], a[244:247], v[220:223], v[236:239]
    s_waitcnt lgkmcnt(0)
    v_mfma_f32_16x16x32_bf16 v[240:243], a[248:251], v[204:207], v[240:243]
    v_mfma_f32_16x16x32_bf16 v[244:247], a[248:251], v[220:223], v[244:247]
    v_mfma_f32_16x16x32_bf16 v[248:251], a[252:255], v[204:207], v[248:251]
    v_mfma_f32_16x16x32_bf16 v[252:255], a[252:255], v[220:223], v[252:255]
    buffer_load_dwordx2 v[186:187], v51, s[40:43], 0 offen sc1
    s_waitcnt vmcnt(1)
    s_mov_b64 exec, 1
    buffer_store_dwordx2 v[184:185], v55, s[40:43], 0 offen sc1
    s_mov_b64 exec, -1
    s_waitcnt vmcnt(1)
    v_cmp_eq_u64 vcc, v[184:185], v[186:187]
    s_nop 0
    s_mov_b32 s7, vcc_lo
    s_and_b32 s60, s7, s8
    s_cbranch_scc0 L_sel1_2
L_sel1_2_go:
    s_ff1_i32_b32 s60, s60
    s_bitset0_b32 s8, s60
    s_add_u32 s60, s60, s55
    s_and_b32 s60, s60, 7
    s_lshl_b32 s61, s60, 15
    s_add_u32 s12, s61, s73
    s_add_u32 s13, s12, 4096
    s_lshl_b32 s61, s60, 2
    s_lshr_b32 s61, 0x52419876, s61
    s_and_b32 s61, s61, 15
    s_lshl_b32 s10, s61, 14
    buffer_load_dwordx4 a[0:3], v53, s[40:43], s12 offen offset:0 sc1
    buffer_load_dwordx4 a[16:19], v53, s[40:43], s13 offen offset:0 sc1
    buffer_load_dwordx4 a[4:7], v53, s[40:43], s12 offen offset:1024 sc1
    buffer_load_dwordx4 a[20:23], v53, s[40:43], s13 offen offset:1024 sc1
    buffer_load_dwordx4 a[8:11], v53, s[40:43], s12 offen offset:2048 sc1
    buffer_load_dwordx4 a[24:27], v53, s[40:43], s13 offen offset:2048 sc1
    buffer_load_dwordx4 a[12:15], v53, s[40:43], s12 offen offset:3072 sc1
    buffer_load_dwordx4 a[28:31], v53, s[40:43], s13 offen offset:3072 sc1
    v_add_u32 v44, s10, v40
    v_add_u32 v45, s10, v41
    v_add_u32 v46, s10, v42
    v_add_u32 v47, s10, v43
    ds_read_b64_tr_b16 a[224:225], v44 offset:0
    ds_read_b64_tr_b16 a[226:227], v44 offset:2048
    ds_read_b64_tr_b16 a[228:229], v45 offset:0
    ds_read_b64_tr_b16 a[230:231], v45 offset:2048
    ds_read_b64_tr_b16 a[232:233], v46 offset:0
    ds_read_b64_tr_b16 a[234:235], v46 offset:2048
    ds_read_b64_tr_b16 a[236:237], v47 offset:0
    ds_read_b64_tr_b16 a[238:239], v47 offset:2048
    s_and_b32 s60, s7, s8
    s_cbranch_scc0 L_sel2_2
L_sel2_2_go:
    s_ff1_i32_b32 s60, s60
    s_bitset0_b32 s8, s60
    s_add_u32 s60, s60, s55
    s_and_b32 s60, s60, 7
    s_lshl_b32 s61, s60, 15
    s_add_u32 s12, s61, s73
    s_add_u32 s13, s12, 4096
    s_lshl_b32 s61, s60, 2
    s_lshr_b32 s61, 0x52419876, s61
    s_and_b32 s61, s61, 15
    s_lshl_b32 s11, s61, 14
    buffer_load_dwordx4 a[32:35], v53, s[40:43], s12 offen offset:0 sc1
    buffer_load_dwordx4 a[48:51], v53, s[40:43], s13 offen offset:0 sc1
    buffer_load_dwordx4 a[36:39], v53, s[40:43], s12 offen offset:1024 sc1
    buffer_load_dwordx4 a[52:55], v53, s[40:43], s13 offen offset:1024 sc1
    buffer_load_dwordx4 a[40:43], v53, s[40:43], s12 offen offset:2048 sc1
    buffer_load_dwordx4 a[56:59], v53, s[40:43], s13 offen offset:2048 sc1
    buffer_load_dwordx4 a[44:47], v53, s[40:43], s12 offen offset:3072 sc1
    buffer_load_dwordx4 a[60:63], v53, s[40:43], s13 offen offset:3072 sc1
    s_branch L_common_2
L_last_1:
    s_waitcnt lgkmcnt(0)
    v_mfma_f32_16x16x32_bf16 v[168:171], v[56:59], v[176:179], v[168:171]
    s_waitcnt vmcnt(12)
    s_barrier
    ds_read_b128 a[0:3], v8 offset:16384
    v_mfma_f32_16x16x32_bf16 v[64:67], a[32:35], v[176:179], v[64:67]
    ds_read_b128 a[16:19], v8 offset:20480
    s_add_u32 m0, s57, 0
    ds_read_b64_tr_b16 a[32:33], v12 offset:8192
    ds_read_b64_tr_b16 a[34:35], v12 offset:12288
    v_mfma_f32_16x16x32_bf16 v[72:75], a[36:39], v[176:179], v[72:75]
    ds_read_b128 a[4:7], v9 offset:16384
    ds_read_b64_tr_b16 a[36:37], v13 offset:8192
    ds_read_b64_tr_b16 a[38:39], v13 offset:12288
    v_mfma_f32_16x16x32_bf16 v[80:83], a[40:43], v[176:179], v[80:83]
    ds_read_b128 a[20:23], v9 offset:20480
    buffer_load_dwordx4 v20, s[28:31], s64 offen offset:0 nt lds
    ds_read_b64_tr_b16 a[40:41], v14 offset:8192
    ds_read_b64_tr_b16 a[42:43], v14 offset:12288
    v_mfma_f32_16x16x32_bf16 v[88:91], a[44:47], v[176:179], v[88:91]
    ds_read_b128 a[8:11], v10 offset:16384
    ds_read_b64_tr_b16 a[44:45], v15 offset:8192
    ds_read_b64_tr_b16 a[46:47], v15 offset:12288
    v_max3_f32 v48, v144, v145, v146
    v_mfma_f32_16x16x32_bf16 v[96:99], a[48:51], v[176:179], v[96:99]
    ds_read_b128 a[24:27], v10 offset:20480
    v_max3_f32 v48, v48, v147, v152
    v_mfma_f32_16x16x32_bf16 v[104:107], a[52:55], v[176:179], v[104:107]
    ds_read_b128 a[12:15], v11 offset:16384
    v_max3_f32 v48, v48, v153, v154
    v_mfma_f32_16x16x32_bf16 v[112:115], a[56:59], v[176:179], v[112:115]
    ds_read_b128 a[28:31], v11 offset:20480
    v_max_f32 v48, v48, v155
    v_mfma_f32_16x16x32_bf16 v[120:123], a[60:63], v[176:179], v[120:123]
    v_cmp_lt_f32 vcc, 0x41000000, v48
    s_cbranch_vccnz L_rs_6_1
L_rsb_6_1:
    s_waitcnt lgkmcnt(8)
    v_mfma_f32_16x16x32_bf16 v[128:131], a[0:3], v[192:195], v[160:163]
    ds_read_b64_tr_b16 a[48:49], v16 offset:8192
    ds_read_b64_tr_b16 a[50:51], v16 offset:12288
    v_exp_f32 v144, v144
    v_exp_f32 v145, v145
    v_mfma_f32_16x16x32_bf16 v[136:139], a[16:19], v[192:195], v[160:163]
    ds_read_b64_tr_b16 a[52:53], v17 offset:8192
    ds_read_b64_tr_b16 a[54:55], v17 offset:12288
    v_exp_f32 v146, v146
    v_cvt_pk_bf16_f32 v176, v144, v145
    v_mfma_f32_16x16x32_bf16 v[128:131], a[4:7], v[196:199], v[128:131]
    ds_read_b64_tr_b16 a[56:57], v18 offset:8192
    ds_read_b64_tr_b16 a[58:59], v18 offset:12288
    v_exp_f32 v147, v147
    v_exp_f32 v152, v152
    v_mfma_f32_16x16x32_bf16 v[136:139], a[20:23], v[196:199], v[136:139]
    ds_read_b64_tr_b16 a[60:61], v19 offset:8192
    ds_read_b64_tr_b16 a[62:63], v19 offset:12288
    v_cvt_pk_bf16_f32 v177, v146, v147
    v_exp_f32 v153, v153
    s_waitcnt lgkmcnt(8)
    v_mfma_f32_16x16x32_bf16 v[128:131], a[8:11], v[200:203], v[128:131]
    buffer_load_dwordx4 v21, s[28:31], s64 offen offset:1024 nt lds
    v_exp_f32 v154, v154
    v_cvt_pk_bf16_f32 v178, v152, v153
    v_mfma_f32_16x16x32_bf16 v[136:139], a[24:27], v[200:203], v[136:139]
    buffer_load_dwordx4 v22, s[28:31], s64 offen offset:2048 nt lds
    v_exp_f32 v155, v155
    v_mfma_f32_16x16x32_bf16 v[128:131], a[12:15], v[204:207], v[128:131]
    buffer_load_dwordx4 v23, s[28:31], s64 offen offset:3072 nt lds
    v_cvt_pk_bf16_f32 v179, v154, v155
    v_mfma_f32_16x16x32_bf16 v[136:139], a[28:31], v[204:207], v[136:139]
    v_mov_b32 v2, 0
    s_nop 0
    s_waitcnt lgkmcnt(0)
    v_mfma_f32_16x16x32_bf16 v[168:171], v[56:59], v[176:179], v[168:171]
    s_waitcnt vmcnt(12)
    s_barrier
    ds_read_b128 a[0:3], v8 offset:24576
    v_mfma_f32_16x16x32_bf16 v[64:67], a[32:35], v[176:179], v[64:67]
    ds_read_b128 a[16:19], v8 offset:28672
    s_add_u32 m0, s57, 49152
    ds_read_b64_tr_b16 a[32:33], v12 offset:16384
    ds_read_b64_tr_b16 a[34:35], v12 offset:20480
    v_mfma_f32_16x16x32_bf16 v[72:75], a[36:39], v[176:179], v[72:75]
    ds_read_b128 a[4:7], v9 offset:24576
    ds_read_b64_tr_b16 a[36:37], v13 offset:16384
    ds_read_b64_tr_b16 a[38:39], v13 offset:20480
    v_mfma_f32_16x16x32_bf16 v[80:83], a[40:43], v[176:179], v[80:83]
    ds_read_b128 a[20:23], v9 offset:28672
    buffer_load_dwordx4 v24, s[32:35], s65 offen offset:0 nt lds
    ds_read_b64_tr_b16 a[40:41], v14 offset:16384
    ds_read_b64_tr_b16 a[42:43], v14 offset:20480
    v_mfma_f32_16x16x32_bf16 v[88:91], a[44:47], v[176:179], v[88:91]
    ds_read_b128 a[8:11], v10 offset:24576
    ds_read_b64_tr_b16 a[44:45], v15 offset:16384
    ds_read_b64_tr_b16 a[46:47], v15 offset:20480
    v_max3_f32 v48, v128, v129, v130
    v_mfma_f32_16x16x32_bf16 v[96:99], a[48:51], v[176:179], v[96:99]
    ds_read_b128 a[24:27], v10 offset:28672
    v_max3_f32 v48, v48, v131, v136
    v_mfma_f32_16x16x32_bf16 v[104:107], a[52:55], v[176:179], v[104:107]
    ds_read_b128 a[12:15], v11 offset:24576
    v_max3_f32 v48, v48, v137, v138
    v_mfma_f32_16x16x32_bf16 v[112:115], a[56:59], v[176:179], v[112:115]
    ds_read_b128 a[28:31], v11 offset:28672
    v_max_f32 v48, v48, v139
    v_mfma_f32_16x16x32_bf16 v[120:123], a[60:63], v[176:179], v[120:123]
    v_cmp_lt_f32 vcc, 0x41000000, v48
    s_cbranch_vccnz L_rs_7_1
L_rsb_7_1:
    s_waitcnt lgkmcnt(8)
    v_mfma_f32_16x16x32_bf16 v[144:147], a[0:3], v[192:195], v[160:163]
    ds_read_b64_tr_b16 a[48:49], v16 offset:16384
    ds_read_b64_tr_b16 a[50:51], v16 offset:20480
    v_exp_f32 v128, v128
    v_exp_f32 v129, v129
    v_mfma_f32_16x16x32_bf16 v[152:155], a[16:19], v[192:195], v[160:163]
    ds_read_b64_tr_b16 a[52:53], v17 offset:16384
    ds_read_b64_tr_b16 a[54:55], v17 offset:20480
    v_exp_f32 v130, v130
    v_cvt_pk_bf16_f32 v176, v128, v129
    v_mfma_f32_16x16x32_bf16 v[144:147], a[4:7], v[196:199], v[144:147]
    ds_read_b64_tr_b16 a[56:57], v18 offset:16384
    ds_read_b64_tr_b16 a[58:59], v18 offset:20480
    v_exp_f32 v131, v131
    v_exp_f32 v136, v136
    v_mfma_f32_16x16x32_bf16 v[152:155], a[20:23], v[196:199], v[152:155]
    ds_read_b64_tr_b16 a[60:61], v19 offset:16384
    ds_read_b64_tr_b16 a[62:63], v19 offset:20480
    v_cvt_pk_bf16_f32 v177, v130, v131
    v_exp_f32 v137, v137
    s_waitcnt lgkmcnt(8)
    v_mfma_f32_16x16x32_bf16 v[144:147], a[8:11], v[200:203], v[144:147]
    buffer_load_dwordx4 v25, s[32:35], s65 offen offset:1024 nt lds
    v_exp_f32 v138, v138
    v_cvt_pk_bf16_f32 v178, v136, v137
    v_mfma_f32_16x16x32_bf16 v[152:155], a[24:27], v[200:203], v[152:155]
    buffer_load_dwordx4 v26, s[32:35], s65 offen offset:2048 nt lds
    v_exp_f32 v139, v139
    v_mfma_f32_16x16x32_bf16 v[144:147], a[12:15], v[204:207], v[144:147]
    buffer_load_dwordx4 v27, s[32:35], s65 offen offset:3072 nt lds
    v_cvt_pk_bf16_f32 v179, v138, v139
    v_mfma_f32_16x16x32_bf16 v[152:155], a[28:31], v[204:207], v[152:155]
    buffer_load_dwordx2 v[184:185], v2, s[48:51], 0 offen sc1
    s_mov_b32 s64, 524288
    s_nop 0
    s_waitcnt lgkmcnt(0)
    v_mfma_f32_16x16x32_bf16 v[168:171], v[56:59], v[176:179], v[168:171]
    s_waitcnt vmcnt(12)
    s_barrier
    ds_read_b128 a[0:3], v8 offset:32768
    v_mfma_f32_16x16x32_bf16 v[64:67], a[32:35], v[176:179], v[64:67]
    ds_read_b128 a[16:19], v8 offset:36864
    s_add_u32 m0, s57, 16384
    ds_read_b64_tr_b16 a[32:33], v12 offset:24576
    ds_read_b64_tr_b16 a[34:35], v12 offset:28672
    v_mfma_f32_16x16x32_bf16 v[72:75], a[36:39], v[176:179], v[72:75]
    ds_read_b128 a[4:7], v9 offset:32768
    ds_read_b64_tr_b16 a[36:37], v13 offset:24576
    ds_read_b64_tr_b16 a[38:39], v13 offset:28672
    v_mfma_f32_16x16x32_bf16 v[80:83], a[40:43], v[176:179], v[80:83]
    ds_read_b128 a[20:23], v9 offset:36864
    buffer_load_dwordx4 v36, s[36:39], s64 offen offset:0  lds
    ds_read_b64_tr_b16 a[40:41], v14 offset:24576
    ds_read_b64_tr_b16 a[42:43], v14 offset:28672
    v_mfma_f32_16x16x32_bf16 v[88:91], a[44:47], v[176:179], v[88:91]
    ds_read_b128 a[8:11], v10 offset:32768
    ds_read_b64_tr_b16 a[44:45], v15 offset:24576
    ds_read_b64_tr_b16 a[46:47], v15 offset:28672
    v_max3_f32 v48, v144, v145, v146
    v_mfma_f32_16x16x32_bf16 v[96:99], a[48:51], v[176:179], v[96:99]
    ds_read_b128 a[24:27], v10 offset:36864
    v_max3_f32 v48, v48, v147, v152
    v_mfma_f32_16x16x32_bf16 v[104:107], a[52:55], v[176:179], v[104:107]
    ds_read_b128 a[12:15], v11 offset:32768
    v_max3_f32 v48, v48, v153, v154
    v_mfma_f32_16x16x32_bf16 v[112:115], a[56:59], v[176:179], v[112:115]
    ds_read_b128 a[28:31], v11 offset:36864
    v_max_f32 v48, v48, v155
    v_mfma_f32_16x16x32_bf16 v[120:123], a[60:63], v[176:179], v[120:123]
    v_cmp_lt_f32 vcc, 0x41000000, v48
    s_cbranch_vccnz L_rs_8_1
L_rsb_8_1:
    s_waitcnt lgkmcnt(8)
    v_mfma_f32_16x16x32_bf16 v[128:131], a[0:3], v[192:195], v[160:163]
    ds_read_b64_tr_b16 a[48:49], v16 offset:24576
    ds_read_b64_tr_b16 a[50:51], v16 offset:28672
    v_exp_f32 v144, v144
    v_exp_f32 v145, v145
    v_mfma_f32_16x16x32_bf16 v[136:139], a[16:19], v[192:195], v[160:163]
    ds_read_b64_tr_b16 a[52:53], v17 offset:24576
    ds_read_b64_tr_b16 a[54:55], v17 offset:28672
    v_exp_f32 v146, v146
    v_cvt_pk_bf16_f32 v176, v144, v145
    v_mfma_f32_16x16x32_bf16 v[128:131], a[4:7], v[196:199], v[128:131]
    ds_read_b64_tr_b16 a[56:57], v18 offset:24576
    ds_read_b64_tr_b16 a[58:59], v18 offset:28672
    v_exp_f32 v147, v147
    v_exp_f32 v152, v152
    v_mfma_f32_16x16x32_bf16 v[136:139], a[20:23], v[196:199], v[136:139]
    ds_read_b64_tr_b16 a[60:61], v19 offset:24576
    ds_read_b64_tr_b16 a[62:63], v19 offset:28672
    v_cvt_pk_bf16_f32 v177, v146, v147
    v_exp_f32 v153, v153
    s_waitcnt lgkmcnt(8)
    v_mfma_f32_16x16x32_bf16 v[128:131], a[8:11], v[200:203], v[128:131]
    buffer_load_dwordx4 v37, s[36:39], s64 offen offset:1024  lds
    v_exp_f32 v154, v154
    v_cvt_pk_bf16_f32 v178, v152, v153
    v_mfma_f32_16x16x32_bf16 v[136:139], a[24:27], v[200:203], v[136:139]
    buffer_load_dwordx4 v38, s[36:39], s64 offen offset:2048  lds
    v_exp_f32 v155, v155
    v_mfma_f32_16x16x32_bf16 v[128:131], a[12:15], v[204:207], v[128:131]
    buffer_load_dwordx4 v39, s[36:39], s64 offen offset:3072  lds
    v_cvt_pk_bf16_f32 v179, v154, v155
    v_mfma_f32_16x16x32_bf16 v[136:139], a[28:31], v[204:207], v[136:139]
    s_mov_b32 s64, 655360
    s_nop 0
    s_waitcnt lgkmcnt(0)
    v_mfma_f32_16x16x32_bf16 v[168:171], v[56:59], v[176:179], v[168:171]
    s_waitcnt vmcnt(12)
    s_barrier
    ds_read_b128 a[0:3], v8 offset:40960
    v_mfma_f32_16x16x32_bf16 v[64:67], a[32:35], v[176:179], v[64:67]
    ds_read_b128 a[16:19], v8 offset:45056
    s_add_u32 m0, s57, 65536
    ds_read_b64_tr_b16 a[32:33], v12 offset:32768
    ds_read_b64_tr_b16 a[34:35], v12 offset:36864
    v_mfma_f32_16x16x32_bf16 v[72:75], a[36:39], v[176:179], v[72:75]
    ds_read_b128 a[4:7], v9 offset:40960
    ds_read_b64_tr_b16 a[36:37], v13 offset:32768
    ds_read_b64_tr_b16 a[38:39], v13 offset:36864
    v_mfma_f32_16x16x32_bf16 v[80:83], a[40:43], v[176:179], v[80:83]
    ds_read_b128 a[20:23], v9 offset:45056
    buffer_load_dwordx4 v36, s[36:39], s64 offen offset:0  lds
    ds_read_b64_tr_b16 a[40:41], v14 offset:32768
    ds_read_b64_tr_b16 a[42:43], v14 offset:36864
    v_mfma_f32_16x16x32_bf16 v[88:91], a[44:47], v[176:179], v[88:91]
    ds_read_b128 a[8:11], v10 offset:40960
    ds_read_b64_tr_b16 a[44:45], v15 offset:32768
    ds_read_b64_tr_b16 a[46:47], v15 offset:36864
    v_max3_f32 v48, v128, v129, v130
    v_mfma_f32_16x16x32_bf16 v[96:99], a[48:51], v[176:179], v[96:99]
    ds_read_b128 a[24:27], v10 offset:45056
    v_max3_f32 v48, v48, v131, v136
    v_mfma_f32_16x16x32_bf16 v[104:107], a[52:55], v[176:179], v[104:107]
    ds_read_b128 a[12:15], v11 offset:40960
    v_max3_f32 v48, v48, v137, v138
    v_mfma_f32_16x16x32_bf16 v[112:115], a[56:59], v[176:179], v[112:115]
    ds_read_b128 a[28:31], v11 offset:45056
    v_max_f32 v48, v48, v139
    v_mfma_f32_16x16x32_bf16 v[120:123], a[60:63], v[176:179], v[120:123]
    v_cmp_lt_f32 vcc, 0x41000000, v48
    s_cbranch_vccnz L_rs_9_1
L_rsb_9_1:
    s_waitcnt lgkmcnt(8)
    v_mfma_f32_16x16x32_bf16 v[144:147], a[0:3], v[192:195], v[160:163]
    ds_read_b64_tr_b16 a[48:49], v16 offset:32768
    ds_read_b64_tr_b16 a[50:51], v16 offset:36864
    v_exp_f32 v128, v128
    v_exp_f32 v129, v129
    v_mfma_f32_16x16x32_bf16 v[152:155], a[16:19], v[192:195], v[160:163]
    ds_read_b64_tr_b16 a[52:53], v17 offset:32768
    ds_read_b64_tr_b16 a[54:55], v17 offset:36864
    v_exp_f32 v130, v130
    v_cvt_pk_bf16_f32 v176, v128, v129
    v_mfma_f32_16x16x32_bf16 v[144:147], a[4:7], v[196:199], v[144:147]
    ds_read_b64_tr_b16 a[56:57], v18 offset:32768
    ds_read_b64_tr_b16 a[58:59], v18 offset:36864
    v_exp_f32 v131, v131
    v_exp_f32 v136, v136
    v_mfma_f32_16x16x32_bf16 v[152:155], a[20:23], v[196:199], v[152:155]
    ds_read_b64_tr_b16 a[60:61], v19 offset:32768
    ds_read_b64_tr_b16 a[62:63], v19 offset:36864
    v_cvt_pk_bf16_f32 v177, v130, v131
    v_exp_f32 v137, v137
    s_waitcnt lgkmcnt(8)
    v_mfma_f32_16x16x32_bf16 v[144:147], a[8:11], v[200:203], v[144:147]
    buffer_load_dwordx4 v37, s[36:39], s64 offen offset:1024  lds
    v_exp_f32 v138, v138
    v_cvt_pk_bf16_f32 v178, v136, v137
    v_mfma_f32_16x16x32_bf16 v[152:155], a[24:27], v[200:203], v[152:155]
    buffer_load_dwordx4 v38, s[36:39], s64 offen offset:2048  lds
    v_exp_f32 v139, v139
    v_mfma_f32_16x16x32_bf16 v[144:147], a[12:15], v[204:207], v[144:147]
    buffer_load_dwordx4 v39, s[36:39], s64 offen offset:3072  lds
    v_cvt_pk_bf16_f32 v179, v138, v139
    v_mfma_f32_16x16x32_bf16 v[152:155], a[28:31], v[204:207], v[152:155]
    s_mov_b32 s64, 786432
    s_nop 0
    s_waitcnt lgkmcnt(0)
    v_mfma_f32_16x16x32_bf16 v[168:171], v[56:59], v[176:179], v[168:171]
    s_waitcnt vmcnt(12)
    s_barrier
    ds_read_b128 a[0:3], v8 offset:0
    v_mfma_f32_16x16x32_bf16 v[64:67], a[32:35], v[176:179], v[64:67]
    ds_read_b128 a[16:19], v8 offset:4096
    s_add_u32 m0, s57, 32768
    ds_read_b64_tr_b16 a[32:33], v12 offset:40960
    ds_read_b64_tr_b16 a[34:35], v12 offset:45056
    v_mfma_f32_16x16x32_bf16 v[72:75], a[36:39], v[176:179], v[72:75]
    ds_read_b128 a[4:7], v9 offset:0
    ds_read_b64_tr_b16 a[36:37], v13 offset:40960
    ds_read_b64_tr_b16 a[38:39], v13 offset:45056
    v_mfma_f32_16x16x32_bf16 v[80:83], a[40:43], v[176:179], v[80:83]
    ds_read_b128 a[20:23], v9 offset:4096
    buffer_load_dwordx4 v36, s[36:39], s64 offen offset:0  lds
    ds_read_b64_tr_b16 a[40:41], v14 offset:40960
    ds_read_b64_tr_b16 a[42:43], v14 offset:45056
    v_mfma_f32_16x16x32_bf16 v[88:91], a[44:47], v[176:179], v[88:91]
    ds_read_b128 a[8:11], v10 offset:0
    ds_read_b64_tr_b16 a[44:45], v15 offset:40960
    ds_read_b64_tr_b16 a[46:47], v15 offset:45056
    v_max3_f32 v48, v144, v145, v146
    v_mfma_f32_16x16x32_bf16 v[96:99], a[48:51], v[176:179], v[96:99]
    ds_read_b128 a[24:27], v10 offset:4096
    v_max3_f32 v48, v48, v147, v152
    v_mfma_f32_16x16x32_bf16 v[104:107], a[52:55], v[176:179], v[104:107]
    ds_read_b128 a[12:15], v11 offset:0
    v_max3_f32 v48, v48, v153, v154
    v_mfma_f32_16x16x32_bf16 v[112:115], a[56:59], v[176:179], v[112:115]
    ds_read_b128 a[28:31], v11 offset:4096
    v_max_f32 v48, v48, v155
    v_mfma_f32_16x16x32_bf16 v[120:123], a[60:63], v[176:179], v[120:123]
    v_cmp_lt_f32 vcc, 0x41000000, v48
    s_cbranch_vccnz L_rs_10_1
L_rsb_10_1:
    s_waitcnt lgkmcnt(8)
    v_mfma_f32_16x16x32_bf16 v[128:131], a[0:3], v[192:195], v[160:163]
    ds_read_b64_tr_b16 a[48:49], v16 offset:40960
    ds_read_b64_tr_b16 a[50:51], v16 offset:45056
    v_exp_f32 v144, v144
    v_exp_f32 v145, v145
    v_mfma_f32_16x16x32_bf16 v[136:139], a[16:19], v[192:195], v[160:163]
    ds_read_b64_tr_b16 a[52:53], v17 offset:40960
    ds_read_b64_tr_b16 a[54:55], v17 offset:45056
    v_exp_f32 v146, v146
    v_cvt_pk_bf16_f32 v176, v144, v145
    v_mfma_f32_16x16x32_bf16 v[128:131], a[4:7], v[196:199], v[128:131]
    ds_read_b64_tr_b16 a[56:57], v18 offset:40960
    ds_read_b64_tr_b16 a[58:59], v18 offset:45056
    v_exp_f32 v147, v147
    v_exp_f32 v152, v152
    v_mfma_f32_16x16x32_bf16 v[136:139], a[20:23], v[196:199], v[136:139]
    ds_read_b64_tr_b16 a[60:61], v19 offset:40960
    ds_read_b64_tr_b16 a[62:63], v19 offset:45056
    v_cvt_pk_bf16_f32 v177, v146, v147
    v_exp_f32 v153, v153
    s_waitcnt lgkmcnt(8)
    v_mfma_f32_16x16x32_bf16 v[128:131], a[8:11], v[200:203], v[128:131]
    buffer_load_dwordx4 v37, s[36:39], s64 offen offset:1024  lds
    v_exp_f32 v154, v154
    v_cvt_pk_bf16_f32 v178, v152, v153
    v_mfma_f32_16x16x32_bf16 v[136:139], a[24:27], v[200:203], v[136:139]
    buffer_load_dwordx4 v38, s[36:39], s64 offen offset:2048  lds
    v_exp_f32 v155, v155
    v_mfma_f32_16x16x32_bf16 v[128:131], a[12:15], v[204:207], v[128:131]
    buffer_load_dwordx4 v39, s[36:39], s64 offen offset:3072  lds
    v_cvt_pk_bf16_f32 v179, v154, v155
    v_mfma_f32_16x16x32_bf16 v[136:139], a[28:31], v[204:207], v[136:139]
    s_mov_b32 s64, 917504
    s_nop 0
    s_waitcnt lgkmcnt(0)
    v_mfma_f32_16x16x32_bf16 v[168:171], v[56:59], v[176:179], v[168:171]
    s_waitcnt vmcnt(12)
    s_barrier
    ds_read_b128 a[0:3], v8 offset:8192
    v_mfma_f32_16x16x32_bf16 v[64:67], a[32:35], v[176:179], v[64:67]
    ds_read_b128 a[16:19], v8 offset:12288
    s_add_u32 m0, s57, 81920
    ds_read_b64_tr_b16 a[32:33], v12 offset:0
    ds_read_b64_tr_b16 a[34:35], v12 offset:4096
    v_mfma_f32_16x16x32_bf16 v[72:75], a[36:39], v[176:179], v[72:75]
    ds_read_b128 a[4:7], v9 offset:8192
    ds_read_b64_tr_b16 a[36:37], v13 offset:0
    ds_read_b64_tr_b16 a[38:39], v13 offset:4096
    v_mfma_f32_16x16x32_bf16 v[80:83], a[40:43], v[176:179], v[80:83]
    ds_read_b128 a[20:23], v9 offset:12288
    buffer_load_dwordx4 v36, s[36:39], s64 offen offset:0  lds
    ds_read_b64_tr_b16 a[40:41], v14 offset:0
    ds_read_b64_tr_b16 a[42:43], v14 offset:4096
    v_mfma_f32_16x16x32_bf16 v[88:91], a[44:47], v[176:179], v[88:91]
    ds_read_b128 a[8:11], v10 offset:8192
    ds_read_b64_tr_b16 a[44:45], v15 offset:0
    ds_read_b64_tr_b16 a[46:47], v15 offset:4096
    v_max3_f32 v48, v128, v129, v130
    v_mfma_f32_16x16x32_bf16 v[96:99], a[48:51], v[176:179], v[96:99]
    ds_read_b128 a[24:27], v10 offset:12288
    v_max3_f32 v48, v48, v131, v136
    v_mfma_f32_16x16x32_bf16 v[104:107], a[52:55], v[176:179], v[104:107]
    ds_read_b128 a[12:15], v11 offset:8192
    v_max3_f32 v48, v48, v137, v138
    v_mfma_f32_16x16x32_bf16 v[112:115], a[56:59], v[176:179], v[112:115]
    ds_read_b128 a[28:31], v11 offset:12288
    v_max_f32 v48, v48, v139
    v_mfma_f32_16x16x32_bf16 v[120:123], a[60:63], v[176:179], v[120:123]
    v_cmp_lt_f32 vcc, 0x41000000, v48
    s_cbranch_vccnz L_rs_11_1
L_rsb_11_1:
    s_waitcnt lgkmcnt(8)
    v_mfma_f32_16x16x32_bf16 v[144:147], a[0:3], v[192:195], v[160:163]
    ds_read_b64_tr_b16 a[48:49], v16 offset:0
    ds_read_b64_tr_b16 a[50:51], v16 offset:4096
    v_exp_f32 v128, v128
    v_exp_f32 v129, v129
    v_mfma_f32_16x16x32_bf16 v[152:155], a[16:19], v[192:195], v[160:163]
    ds_read_b64_tr_b16 a[52:53], v17 offset:0
    ds_read_b64_tr_b16 a[54:55], v17 offset:4096
    v_exp_f32 v130, v130
    v_cvt_pk_bf16_f32 v176, v128, v129
    v_mfma_f32_16x16x32_bf16 v[144:147], a[4:7], v[196:199], v[144:147]
    ds_read_b64_tr_b16 a[56:57], v18 offset:0
    ds_read_b64_tr_b16 a[58:59], v18 offset:4096
    v_exp_f32 v131, v131
    v_exp_f32 v136, v136
    v_mfma_f32_16x16x32_bf16 v[152:155], a[20:23], v[196:199], v[152:155]
    ds_read_b64_tr_b16 a[60:61], v19 offset:0
    ds_read_b64_tr_b16 a[62:63], v19 offset:4096
    v_cvt_pk_bf16_f32 v177, v130, v131
    v_exp_f32 v137, v137
    s_waitcnt lgkmcnt(8)
    v_mfma_f32_16x16x32_bf16 v[144:147], a[8:11], v[200:203], v[144:147]
    buffer_load_dwordx4 v37, s[36:39], s64 offen offset:1024  lds
    v_exp_f32 v138, v138
    v_cvt_pk_bf16_f32 v178, v136, v137
    v_mfma_f32_16x16x32_bf16 v[152:155], a[24:27], v[200:203], v[152:155]
    buffer_load_dwordx4 v38, s[36:39], s64 offen offset:2048  lds
    v_exp_f32 v139, v139
    v_mfma_f32_16x16x32_bf16 v[144:147], a[12:15], v[204:207], v[144:147]
    buffer_load_dwordx4 v39, s[36:39], s64 offen offset:3072  lds
    v_cvt_pk_bf16_f32 v179, v138, v139
    v_mfma_f32_16x16x32_bf16 v[152:155], a[28:31], v[204:207], v[152:155]
    v_and_b32 v1, v184, v185
    v_and_b32 v1, 1, v1
    s_nop 0
    v_cmp_eq_u32 vcc, 0, v1
    s_cbranch_vccnz L_notag_1
L_tag_1:
L_tail_1:
    s_waitcnt lgkmcnt(0)
    v_mfma_f32_16x16x32_bf16 v[168:171], v[56:59], v[176:179], v[168:171]
    v_mfma_f32_16x16x32_bf16 v[64:67], a[32:35], v[176:179], v[64:67]
    ds_read_b64_tr_b16 a[32:33], v12 offset:8192
    ds_read_b64_tr_b16 a[34:35], v12 offset:12288
    v_mfma_f32_16x16x32_bf16 v[72:75], a[36:39], v[176:179], v[72:75]
    ds_read_b64_tr_b16 a[36:37], v13 offset:8192
    ds_read_b64_tr_b16 a[38:39], v13 offset:12288
    v_mfma_f32_16x16x32_bf16 v[80:83], a[40:43], v[176:179], v[80:83]
    ds_read_b64_tr_b16 a[40:41], v14 offset:8192
    ds_read_b64_tr_b16 a[42:43], v14 offset:12288
    v_mfma_f32_16x16x32_bf16 v[88:91], a[44:47], v[176:179], v[88:91]
    ds_read_b64_tr_b16 a[44:45], v15 offset:8192
    ds_read_b64_tr_b16 a[46:47], v15 offset:12288
    v_max3_f32 v48, v144, v145, v146
    v_mfma_f32_16x16x32_bf16 v[96:99], a[48:51], v[176:179], v[96:99]
    v_max3_f32 v48, v48, v147, v152
    v_mfma_f32_16x16x32_bf16 v[104:107], a[52:55], v[176:179], v[104:107]
    v_max3_f32 v48, v48, v153, v154
    v_mfma_f32_16x16x32_bf16 v[112:115], a[56:59], v[176:179], v[112:115]
    v_max_f32 v48, v48, v155
    v_mfma_f32_16x16x32_bf16 v[120:123], a[60:63], v[176:179], v[120:123]
    v_cmp_lt_f32 vcc, 0x41000000, v48
    s_cbranch_vccnz L_rs_12_1
L_rsb_12_1:
    buffer_load_dwordx2 v[186:187], v51, s[40:43], 0 offen sc1
    ds_read_b64_tr_b16 a[48:49], v16 offset:8192
    ds_read_b64_tr_b16 a[50:51], v16 offset:12288
    ds_read_b64_tr_b16 a[52:53], v17 offset:8192
    ds_read_b64_tr_b16 a[54:55], v17 offset:12288
    ds_read_b64_tr_b16 a[56:57], v18 offset:8192
    ds_read_b64_tr_b16 a[58:59], v18 offset:12288
    ds_read_b64_tr_b16 a[60:61], v19 offset:8192
    ds_read_b64_tr_b16 a[62:63], v19 offset:12288
    v_exp_f32 v144, v144
    v_exp_f32 v145, v145
    v_exp_f32 v146, v146
    v_cvt_pk_bf16_f32 v176, v144, v145
    v_exp_f32 v147, v147
    v_exp_f32 v152, v152
    v_cvt_pk_bf16_f32 v177, v146, v147
    v_exp_f32 v153, v153
    v_exp_f32 v154, v154
    v_cvt_pk_bf16_f32 v178, v152, v153
    v_exp_f32 v155, v155
    s_lshl_b32 s60, s55, 15
    v_cvt_pk_bf16_f32 v179, v154, v155
    s_add_u32 s60, s60, s73
    s_add_u32 s61, s60, 4096
    v_mfma_f32_16x16x32_bf16 v[168:171], v[56:59], v[176:179], v[168:171]
    s_waitcnt lgkmcnt(3)
    v_mfma_f32_16x16x32_bf16 v[64:67], a[32:35], v[176:179], v[64:67]
    v_mfma_f32_16x16x32_bf16 v[72:75], a[36:39], v[176:179], v[72:75]
    v_mfma_f32_16x16x32_bf16 v[80:83], a[40:43], v[176:179], v[80:83]
    v_mfma_f32_16x16x32_bf16 v[88:91], a[44:47], v[176:179], v[88:91]
    v_mfma_f32_16x16x32_bf16 v[96:99], a[48:51], v[176:179], v[96:99]
    v_add_u32 v44, s9, v40
    v_add_u32 v45, s9, v41
    v_mfma_f32_16x16x32_bf16 v[104:107], a[52:55], v[176:179], v[104:107]
    v_add_u32 v46, s9, v42
    v_add_u32 v47, s9, v43
    s_waitcnt lgkmcnt(0)
    v_mfma_f32_16x16x32_bf16 v[112:115], a[56:59], v[176:179], v[112:115]
    s_nop 0
    v_mfma_f32_16x16x32_bf16 v[120:123], a[60:63], v[176:179], v[120:123]
    v_rcp_f32 v60, v168
    s_nop 3
    v_mov_b32 v61, v60
    v_pk_mul_f32 v[64:65], v[64:65], v[60:61]
    v_cvt_pk_bf16_f32 v192, v64, v65
    v_pk_mul_f32 v[66:67], v[66:67], v[60:61]
    v_cvt_pk_bf16_f32 v193, v66, v67
    v_pk_mul_f32 v[72:73], v[72:73], v[60:61]
    v_cvt_pk_bf16_f32 v194, v72, v73
    v_pk_mul_f32 v[74:75], v[74:75], v[60:61]
    v_cvt_pk_bf16_f32 v195, v74, v75
    buffer_store_dwordx4 v[192:195], v53, s[40:43], s60 offen offset:0 sc1
    v_pk_mul_f32 v[80:81], v[80:81], v[60:61]
    v_cvt_pk_bf16_f32 v196, v80, v81
    v_pk_mul_f32 v[82:83], v[82:83], v[60:61]
    v_cvt_pk_bf16_f32 v197, v82, v83
    v_pk_mul_f32 v[88:89], v[88:89], v[60:61]
    v_cvt_pk_bf16_f32 v198, v88, v89
    v_pk_mul_f32 v[90:91], v[90:91], v[60:61]
    v_cvt_pk_bf16_f32 v199, v90, v91
    buffer_store_dwordx4 v[196:199], v53, s[40:43], s60 offen offset:1024 sc1
    v_pk_mul_f32 v[96:97], v[96:97], v[60:61]
    v_cvt_pk_bf16_f32 v200, v96, v97
    v_pk_mul_f32 v[98:99], v[98:99], v[60:61]
    v_cvt_pk_bf16_f32 v201, v98, v99
    v_pk_mul_f32 v[104:105], v[104:105], v[60:61]
    v_cvt_pk_bf16_f32 v202, v104, v105
    v_pk_mul_f32 v[106:107], v[106:107], v[60:61]
    v_cvt_pk_bf16_f32 v203, v106, v107
    buffer_store_dwordx4 v[200:203], v53, s[40:43], s60 offen offset:2048 sc1
    v_pk_mul_f32 v[112:113], v[112:113], v[60:61]
    v_cvt_pk_bf16_f32 v204, v112, v113
    v_pk_mul_f32 v[114:115], v[114:115], v[60:61]
    v_cvt_pk_bf16_f32 v205, v114, v115
    v_pk_mul_f32 v[120:121], v[120:121], v[60:61]
    v_cvt_pk_bf16_f32 v206, v120, v121
    v_pk_mul_f32 v[122:123], v[122:123], v[60:61]
    v_cvt_pk_bf16_f32 v207, v122, v123
    buffer_store_dwordx4 v[204:207], v53, s[40:43], s60 offen offset:3072 sc1
    s_waitcnt vmcnt(4)
    v_cmp_eq_u64 vcc, v[184:185], v[186:187]
    s_mov_b32 s8, 0xfe
    s_barrier
    s_and_b32 s7, vcc_lo, 0xfe
    ds_read_b64_tr_b16 a[224:225], v44 offset:0
    ds_read_b64_tr_b16 a[226:227], v44 offset:2048
    ds_read_b64_tr_b16 a[228:229], v45 offset:0
    ds_read_b64_tr_b16 a[230:231], v45 offset:2048
    ds_read_b64_tr_b16 a[232:233], v46 offset:0
    ds_read_b64_tr_b16 a[234:235], v46 offset:2048
    ds_read_b64_tr_b16 a[236:237], v47 offset:0
    ds_read_b64_tr_b16 a[238:239], v47 offset:2048
    s_bcnt1_i32_b32 s60, s7
    s_cmp_ge_u32 s60, 2
    s_cbranch_scc0 L_slow_1
L_fast_1:
    s_and_b32 s60, s7, s8
    s_ff1_i32_b32 s60, s60
    s_bitset0_b32 s8, s60
    s_add_u32 s60, s60, s55
    s_and_b32 s60, s60, 7
    s_lshl_b32 s61, s60, 15
    s_add_u32 s12, s61, s73
    s_add_u32 s13, s12, 4096
    s_lshl_b32 s61, s60, 2
    s_lshr_b32 s61, 0x52419876, s61
    s_and_b32 s61, s61, 15
    s_lshl_b32 s10, s61, 14
    s_waitcnt lgkmcnt(4)
    v_mfma_f32_16x16x32_bf16 v[224:227], a[224:227], v[192:195], 0
    ds_read_b64_tr_b16 a[240:241], v44 offset:4096
    ds_read_b64_tr_b16 a[242:243], v44 offset:6144
    buffer_load_dwordx4 a[0:3], v53, s[40:43], s12 offen offset:0 sc1
    v_mfma_f32_16x16x32_bf16 v[232:235], a[228:231], v[192:195], 0
    ds_read_b64_tr_b16 a[244:245], v45 offset:4096
    ds_read_b64_tr_b16 a[246:247], v45 offset:6144
    s_waitcnt lgkmcnt(4)
    v_mfma_f32_16x16x32_bf16 v[240:243], a[232:235], v[192:195], 0
    ds_read_b64_tr_b16 a[248:249], v46 offset:4096
    ds_read_b64_tr_b16 a[250:251], v46 offset:6144
    buffer_load_dwordx4 a[4:7], v53, s[40:43], s12 offen offset:1024 sc1
    v_mfma_f32_16x16x32_bf16 v[248:251], a[236:239], v[192:195], 0
    ds_read_b64_tr_b16 a[252:253], v47 offset:4096
    ds_read_b64_tr_b16 a[254:255], v47 offset:6144
    s_waitcnt lgkmcnt(4)
    v_mfma_f32_16x16x32_bf16 v[224:227], a[240:243], v[196:199], v[224:227]
    ds_read_b64_tr_b16 a[224:225], v44 offset:8192
    ds_read_b64_tr_b16 a[226:227], v44 offset:10240
    buffer_load_dwordx4 a[8:11], v53, s[40:43], s12 offen offset:2048 sc1
    v_mfma_f32_16x16x32_bf16 v[232:235], a[244:247], v[196:199], v[232:235]
    ds_read_b64_tr_b16 a[228:229], v45 offset:8192
    ds_read_b64_tr_b16 a[230:231], v45 offset:10240
    s_waitcnt lgkmcnt(4)
    v_mfma_f32_16x16x32_bf16 v[240:243], a[248:251], v[196:199], v[240:243]
    ds_read_b64_tr_b16 a[232:233], v46 offset:8192
    ds_read_b64_tr_b16 a[234:235], v46 offset:10240
    buffer_load_dwordx4 a[12:15], v53, s[40:43], s12 offen offset:3072 sc1
    v_mfma_f32_16x16x32_bf16 v[248:251], a[252:255], v[196:199], v[248:251]
    ds_read_b64_tr_b16 a[236:237], v47 offset:8192
    ds_read_b64_tr_b16 a[238:239], v47 offset:10240
    s_and_b32 s60, s7, s8
    s_ff1_i32_b32 s60, s60
    s_bitset0_b32 s8, s60
    s_add_u32 s60, s60, s55
    s_and_b32 s60, s60, 7
    s_lshl_b32 s61, s60, 15
    s_add_u32 s12, s61, s73
    s_add_u32 s13, s12, 4096
    s_lshl_b32 s61, s60, 2
    s_lshr_b32 s61, 0x52419876, s61
    s_and_b32 s61, s61, 15
    s_lshl_b32 s11, s61, 14
    s_waitcnt lgkmcnt(4)
    v_mfma_f32_16x16x32_bf16 v[224:227], a[224:227], v[200:203], v[224:227]
    ds_read_b64_tr_b16 a[240:241], v44 offset:12288
    ds_read_b64_tr_b16 a[242:243], v44 offset:14336
    buffer_load_dwordx4 a[32:35], v53, s[40:43], s12 offen offset:0 sc1
    v_mfma_f32_16x16x32_bf16 v[232:235], a[228:231], v[200:203], v[232:235]
    ds_read_b64_tr_b16 a[244:245], v45 offset:12288
    ds_read_b64_tr_b16 a[246:247], v45 offset:14336
    v_add_u32 v44, s10, v40
    v_add_u32 v45, s10, v41
    s_waitcnt lgkmcnt(4)
    v_mfma_f32_16x16x32_bf16 v[240:243], a[232:235], v[200:203], v[240:243]
    ds_read_b64_tr_b16 a[248:249], v46 offset:12288
    ds_read_b64_tr_b16 a[250:251], v46 offset:14336
    buffer_load_dwordx4 a[36:39], v53, s[40:43], s12 offen offset:1024 sc1
    v_mfma_f32_16x16x32_bf16 v[248:251], a[236:239], v[200:203], v[248:251]
    ds_read_b64_tr_b16 a[252:253], v47 offset:12288
    ds_read_b64_tr_b16 a[254:255], v47 offset:14336
    v_add_u32 v46, s10, v42
    v_add_u32 v47, s10, v43
    s_waitcnt lgkmcnt(4)
    v_mfma_f32_16x16x32_bf16 v[224:227], a[240:243], v[204:207], v[224:227]
    ds_read_b64_tr_b16 a[224:225], v44 offset:0
    ds_read_b64_tr_b16 a[226:227], v44 offset:2048
    buffer_load_dwordx4 a[40:43], v53, s[40:43], s12 offen offset:2048 sc1
    v_mfma_f32_16x16x32_bf16 v[232:235], a[244:247], v[204:207], v[232:235]
    ds_read_b64_tr_b16 a[228:229], v45 offset:0
    ds_read_b64_tr_b16 a[230:231], v45 offset:2048
    s_waitcnt lgkmcnt(4)
    v_mfma_f32_16x16x32_bf16 v[240:243], a[248:251], v[204:207], v[240:243]
    ds_read_b64_tr_b16 a[232:233], v46 offset:0
    ds_read_b64_tr_b16 a[234:235], v46 offset:2048
    buffer_load_dwordx4 a[44:47], v53, s[40:43], s12 offen offset:3072 sc1
    v_mfma_f32_16x16x32_bf16 v[248:251], a[252:255], v[204:207], v[248:251]
    ds_read_b64_tr_b16 a[236:237], v47 offset:0
    ds_read_b64_tr_b16 a[238:239], v47 offset:2048
    s_waitcnt vmcnt(8)
    s_mov_b64 exec, 1
    buffer_store_dwordx2 v[184:185], v55, s[40:43], 0 offen sc1
    s_mov_b64 exec, -1
L_common_1:
    s_waitcnt vmcnt(7) lgkmcnt(4)
    v_mfma_f32_16x16x32_bf16 v[224:227], a[224:227], a[0:3], v[224:227]
    ds_read_b64_tr_b16 a[240:241], v44 offset:4096
    ds_read_b64_tr_b16 a[242:243], v44 offset:6144
    s_and_b32 s60, s7, s8
    s_cbranch_scc0 L_sel3_1
L_sel3_1_go:
    s_ff1_i32_b32 s60, s60
    s_bitset0_b32 s8, s60
    v_mfma_f32_16x16x32_bf16 v[232:235], a[228:231], a[0:3], v[232:235]
    ds_read_b64_tr_b16 a[244:245], v45 offset:4096
    ds_read_b64_tr_b16 a[246:247], v45 offset:6144
    s_add_u32 s60, s60, s55
    s_and_b32 s60, s60, 7
    s_lshl_b32 s61, s60, 15
    s_waitcnt lgkmcnt(4)
    v_mfma_f32_16x16x32_bf16 v[240:243], a[232:235], a[0:3], v[240:243]
    ds_read_b64_tr_b16 a[248:249], v46 offset:4096
    ds_read_b64_tr_b16 a[250:251], v46 offset:6144
    s_add_u32 s12, s61, s73
    s_add_u32 s13, s12, 4096
    s_lshl_b32 s61, s60, 2
    v_mfma_f32_16x16x32_bf16 v[248:251], a[236:239], a[0:3], v[248:251]
    ds_read_b64_tr_b16 a[252:253], v47 offset:4096
    ds_read_b64_tr_b16 a[254:255], v47 offset:6144
    s_lshr_b32 s61, 0x52419876, s61
    s_and_b32 s61, s61, 15
    s_lshl_b32 s9, s61, 14
    s_waitcnt vmcnt(6) lgkmcnt(4)
    v_mfma_f32_16x16x32_bf16 v[224:227], a[240:243], a[4:7], v[224:227]
    ds_read_b64_tr_b16 a[224:225], v44 offset:8192
    ds_read_b64_tr_b16 a[226:227], v44 offset:10240
    buffer_load_dwordx4 a[64:67], v53, s[40:43], s12 offen offset:0 sc1
    v_mfma_f32_16x16x32_bf16 v[232:235], a[244:247], a[4:7], v[232:235]
    ds_read_b64_tr_b16 a[228:229], v45 offset:8192
    ds_read_b64_tr_b16 a[230:231], v45 offset:10240
    s_waitcnt lgkmcnt(4)
    v_mfma_f32_16x16x32_bf16 v[240:243], a[248:251], a[4:7], v[240:243]
    ds_read_b64_tr_b16 a[232:233], v46 offset:8192
    ds_read_b64_tr_b16 a[234:235], v46 offset:10240
    buffer_load_dwordx4 a[68:71], v53, s[40:43], s12 offen offset:1024 sc1
    v_mfma_f32_16x16x32_bf16 v[248:251], a[252:255], a[4:7], v[248:251]
    ds_read_b64_tr_b16 a[236:237], v47 offset:8192
    ds_read_b64_tr_b16 a[238:239], v47 offset:10240
    s_waitcnt vmcnt(7) lgkmcnt(4)
    v_mfma_f32_16x16x32_bf16 v[224:227], a[224:227], a[8:11], v[224:227]
    ds_read_b64_tr_b16 a[240:241], v44 offset:12288
    ds_read_b64_tr_b16 a[242:243], v44 offset:14336
    v_mfma_f32_16x16x32_bf16 v[232:235], a[228:231], a[8:11], v[232:235]
    ds_read_b64_tr_b16 a[244:245], v45 offset:12288
    ds_read_b64_tr_b16 a[246:247], v45 offset:14336
    v_add_u32 v44, s11, v40
    v_add_u32 v45, s11, v41
    s_waitcnt lgkmcnt(4)
    v_mfma_f32_16x16x32_bf16 v[240:243], a[232:235], a[8:11], v[240:243]
    ds_read_b64_tr_b16 a[248:249], v46 offset:12288
    ds_read_b64_tr_b16 a[250:251], v46 offset:14336
    buffer_load_dwordx4 a[72:75], v53, s[40:43], s12 offen offset:2048 sc1
    v_mfma_f32_16x16x32_bf16 v[248:251], a[236:239], a[8:11], v[248:251]
    ds_read_b64_tr_b16 a[252:253], v47 offset:12288
    ds_read_b64_tr_b16 a[254:255], v47 offset:14336
    v_add_u32 v46, s11, v42
    v_add_u32 v47, s11, v43
    s_waitcnt vmcnt(7) lgkmcnt(4)
    v_mfma_f32_16x16x32_bf16 v[224:227], a[240:243], a[12:15], v[224:227]
    ds_read_b64_tr_b16 a[224:225], v44 offset:0
    ds_read_b64_tr_b16 a[226:227], v44 offset:2048
    buffer_load_dwordx4 a[76:79], v53, s[40:43], s12 offen offset:3072 sc1
    v_mfma_f32_16x16x32_bf16 v[232:235], a[244:247], a[12:15], v[232:235]
    ds_read_b64_tr_b16 a[228:229], v45 offset:0
    ds_read_b64_tr_b16 a[230:231], v45 offset:2048
    s_waitcnt lgkmcnt(4)
    v_mfma_f32_16x16x32_bf16 v[240:243], a[248:251], a[12:15], v[240:243]
    ds_read_b64_tr_b16 a[232:233], v46 offset:0
    ds_read_b64_tr_b16 a[234:235], v46 offset:2048
    v_mfma_f32_16x16x32_bf16 v[248:251], a[252:255], a[12:15], v[248:251]
    ds_read_b64_tr_b16 a[236:237], v47 offset:0
    ds_read_b64_tr_b16 a[238:239], v47 offset:2048
    s_waitcnt vmcnt(7) lgkmcnt(4)
    v_mfma_f32_16x16x32_bf16 v[224:227], a[224:227], a[32:35], v[224:227]
    ds_read_b64_tr_b16 a[240:241], v44 offset:4096
    ds_read_b64_tr_b16 a[242:243], v44 offset:6144
    s_and_b32 s60, s7, s8
    s_cbranch_scc0 L_sel4_1
L_sel4_1_go:
    s_ff1_i32_b32 s60, s60
    s_bitset0_b32 s8, s60
    v_mfma_f32_16x16x32_bf16 v[232:235], a[228:231], a[32:35], v[232:235]
    ds_read_b64_tr_b16 a[244:245], v45 offset:4096
    ds_read_b64_tr_b16 a[246:247], v45 offset:6144
    s_add_u32 s60, s60, s55
    s_and_b32 s60, s60, 7
    s_lshl_b32 s61, s60, 15
    s_waitcnt lgkmcnt(4)
    v_mfma_f32_16x16x32_bf16 v[240:243], a[232:235], a[32:35], v[240:243]
    ds_read_b64_tr_b16 a[248:249], v46 offset:4096
    ds_read_b64_tr_b16 a[250:251], v46 offset:6144
    s_add_u32 s12, s61, s73
    s_add_u32 s13, s12, 4096
    s_lshl_b32 s61, s60, 2
    v_mfma_f32_16x16x32_bf16 v[248:251], a[236:239], a[32:35], v[248:251]
    ds_read_b64_tr_b16 a[252:253], v47 offset:4096
    ds_read_b64_tr_b16 a[254:255], v47 offset:6144
    s_lshr_b32 s61, 0x52419876, s61
    s_and_b32 s61, s61, 15
    s_lshl_b32 s10, s61, 14
    s_waitcnt vmcnt(6) lgkmcnt(4)
    v_mfma_f32_16x16x32_bf16 v[224:227], a[240:243], a[36:39], v[224:227]
    ds_read_b64_tr_b16 a[224:225], v44 offset:8192
    ds_read_b64_tr_b16 a[226:227], v44 offset:10240
    buffer_load_dwordx4 a[96:99], v53, s[40:43], s12 offen offset:0 sc1
    v_mfma_f32_16x16x32_bf16 v[232:235], a[244:247], a[36:39], v[232:235]
    ds_read_b64_tr_b16 a[228:229], v45 offset:8192
    ds_read_b64_tr_b16 a[230:231], v45 offset:10240
    s_waitcnt lgkmcnt(4)
    v_mfma_f32_16x16x32_bf16 v[240:243], a[248:251], a[36:39], v[240:243]
    ds_read_b64_tr_b16 a[232:233], v46 offset:8192
    ds_read_b64_tr_b16 a[234:235], v46 offset:10240
    buffer_load_dwordx4 a[100:103], v53, s[40:43], s12 offen offset:1024 sc1
    v_mfma_f32_16x16x32_bf16 v[248:251], a[252:255], a[36:39], v[248:251]
    ds_read_b64_tr_b16 a[236:237], v47 offset:8192
    ds_read_b64_tr_b16 a[238:239], v47 offset:10240
    s_waitcnt vmcnt(7) lgkmcnt(4)
    v_mfma_f32_16x16x32_bf16 v[224:227], a[224:227], a[40:43], v[224:227]
    ds_read_b64_tr_b16 a[240:241], v44 offset:12288
    ds_read_b64_tr_b16 a[242:243], v44 offset:14336
    v_mfma_f32_16x16x32_bf16 v[232:235], a[228:231], a[40:43], v[232:235]
    ds_read_b64_tr_b16 a[244:245], v45 offset:12288
    ds_read_b64_tr_b16 a[246:247], v45 offset:14336
    v_add_u32 v44, s9, v40
    v_add_u32 v45, s9, v41
    s_waitcnt lgkmcnt(4)
    v_mfma_f32_16x16x32_bf16 v[240:243], a[232:235], a[40:43], v[240:243]
    ds_read_b64_tr_b16 a[248:249], v46 offset:12288
    ds_read_b64_tr_b16 a[250:251], v46 offset:14336
    buffer_load_dwordx4 a[104:107], v53, s[40:43], s12 offen offset:2048 sc1
    v_mfma_f32_16x16x32_bf16 v[248:251], a[236:239], a[40:43], v[248:251]
    ds_read_b64_tr_b16 a[252:253], v47 offset:12288
    ds_read_b64_tr_b16 a[254:255], v47 offset:14336
    v_add_u32 v46, s9, v42
    v_add_u32 v47, s9, v43
    s_waitcnt vmcnt(7) lgkmcnt(4)
    v_mfma_f32_16x16x32_bf16 v[224:227], a[240:243], a[44:47], v[224:227]
    ds_read_b64_tr_b16 a[224:225], v44 offset:0
    ds_read_b64_tr_b16 a[226:227], v44 offset:2048
    buffer_load_dwordx4 a[108:111], v53, s[40:43], s12 offen offset:3072 sc1
    v_mfma_f32_16x16x32_bf16 v[232:235], a[244:247], a[44:47], v[232:235]
    ds_read_b64_tr_b16 a[228:229], v45 offset:0
    ds_read_b64_tr_b16 a[230:231], v45 offset:2048
    s_waitcnt lgkmcnt(4)
    v_mfma_f32_16x16x32_bf16 v[240:243], a[248:251], a[44:47], v[240:243]
    ds_read_b64_tr_b16 a[232:233], v46 offset:0
    ds_read_b64_tr_b16 a[234:235], v46 offset:2048
    v_mfma_f32_16x16x32_bf16 v[248:251], a[252:255], a[44:47], v[248:251]
    ds_read_b64_tr_b16 a[236:237], v47 offset:0
    ds_read_b64_tr_b16 a[238:239], v47 offset:2048
    s_waitcnt vmcnt(7) lgkmcnt(4)
    v_mfma_f32_16x16x32_bf16 v[224:227], a[224:227], a[64:67], v[224:227]
    ds_read_b64_tr_b16 a[240:241], v44 offset:4096
    ds_read_b64_tr_b16 a[242:243], v44 offset:6144
    s_and_b32 s60, s7, s8
    s_cbranch_scc0 L_sel5_1
L_sel5_1_go:
    s_ff1_i32_b32 s60, s60
    s_bitset0_b32 s8, s60
    v_mfma_f32_16x16x32_bf16 v[232:235], a[228:231], a[64:67], v[232:235]
    ds_read_b64_tr_b16 a[244:245], v45 offset:4096
    ds_read_b64_tr_b16 a[246:247], v45 offset:6144
    s_add_u32 s60, s60, s55
    s_and_b32 s60, s60, 7
    s_lshl_b32 s61, s60, 15
    s_waitcnt lgkmcnt(4)
    v_mfma_f32_16x16x32_bf16 v[240:243], a[232:235], a[64:67], v[240:243]
    ds_read_b64_tr_b16 a[248:249], v46 offset:4096
    ds_read_b64_tr_b16 a[250:251], v46 offset:6144
    s_add_u32 s12, s61, s73
    s_add_u32 s13, s12, 4096
    s_lshl_b32 s61, s60, 2
    v_mfma_f32_16x16x32_bf16 v[248:251], a[236:239], a[64:67], v[248:251]
    ds_read_b64_tr_b16 a[252:253], v47 offset:4096
    ds_read_b64_tr_b16 a[254:255], v47 offset:6144
    s_lshr_b32 s61, 0x52419876, s61
    s_and_b32 s61, s61, 15
    s_lshl_b32 s11, s61, 14
    s_waitcnt vmcnt(6) lgkmcnt(4)
    v_mfma_f32_16x16x32_bf16 v[224:227], a[240:243], a[68:71], v[224:227]
    ds_read_b64_tr_b16 a[224:225], v44 offset:8192
    ds_read_b64_tr_b16 a[226:227], v44 offset:10240
    buffer_load_dwordx4 a[128:131], v53, s[40:43], s12 offen offset:0 sc1
    v_mfma_f32_16x16x32_bf16 v[232:235], a[244:247], a[68:71], v[232:235]
    ds_read_b64_tr_b16 a[228:229], v45 offset:8192
    ds_read_b64_tr_b16 a[230:231], v45 offset:10240
    s_waitcnt lgkmcnt(4)
    v_mfma_f32_16x16x32_bf16 v[240:243], a[248:251], a[68:71], v[240:243]
    ds_read_b64_tr_b16 a[232:233], v46 offset:8192
    ds_read_b64_tr_b16 a[234:235], v46 offset:10240
    buffer_load_dwordx4 a[132:135], v53, s[40:43], s12 offen offset:1024 sc1
    v_mfma_f32_16x16x32_bf16 v[248:251], a[252:255], a[68:71], v[248:251]
    ds_read_b64_tr_b16 a[236:237], v47 offset:8192
    ds_read_b64_tr_b16 a[238:239], v47 offset:10240
    s_waitcnt vmcnt(7) lgkmcnt(4)
    v_mfma_f32_16x16x32_bf16 v[224:227], a[224:227], a[72:75], v[224:227]
    ds_read_b64_tr_b16 a[240:241], v44 offset:12288
    ds_read_b64_tr_b16 a[242:243], v44 offset:14336
    v_mfma_f32_16x16x32_bf16 v[232:235], a[228:231], a[72:75], v[232:235]
    ds_read_b64_tr_b16 a[244:245], v45 offset:12288
    ds_read_b64_tr_b16 a[246:247], v45 offset:14336
    v_add_u32 v44, s10, v40
    v_add_u32 v45, s10, v41
    s_waitcnt lgkmcnt(4)
    v_mfma_f32_16x16x32_bf16 v[240:243], a[232:235], a[72:75], v[240:243]
    ds_read_b64_tr_b16 a[248:249], v46 offset:12288
    ds_read_b64_tr_b16 a[250:251], v46 offset:14336
    buffer_load_dwordx4 a[136:139], v53, s[40:43], s12 offen offset:2048 sc1
    v_mfma_f32_16x16x32_bf16 v[248:251], a[236:239], a[72:75], v[248:251]
    ds_read_b64_tr_b16 a[252:253], v47 offset:12288
    ds_read_b64_tr_b16 a[254:255], v47 offset:14336
    v_add_u32 v46, s10, v42
    v_add_u32 v47, s10, v43
    s_waitcnt vmcnt(7) lgkmcnt(4)
    v_mfma_f32_16x16x32_bf16 v[224:227], a[240:243], a[76:79], v[224:227]
    ds_read_b64_tr_b16 a[224:225], v44 offset:0
    ds_read_b64_tr_b16 a[226:227], v44 offset:2048
    buffer_load_dwordx4 a[140:143], v53, s[40:43], s12 offen offset:3072 sc1
    v_mfma_f32_16x16x32_bf16 v[232:235], a[244:247], a[76:79], v[232:235]
    ds_read_b64_tr_b16 a[228:229], v45 offset:0
    ds_read_b64_tr_b16 a[230:231], v45 offset:2048
    s_waitcnt lgkmcnt(4)
    v_mfma_f32_16x16x32_bf16 v[240:243], a[248:251], a[76:79], v[240:243]
    ds_read_b64_tr_b16 a[232:233], v46 offset:0
    ds_read_b64_tr_b16 a[234:235], v46 offset:2048
    v_mfma_f32_16x16x32_bf16 v[248:251], a[252:255], a[76:79], v[248:251]
    ds_read_b64_tr_b16 a[236:237], v47 offset:0
    ds_read_b64_tr_b16 a[238:239], v47 offset:2048
    s_waitcnt vmcnt(7) lgkmcnt(4)
    v_mfma_f32_16x16x32_bf16 v[224:227], a[224:227], a[96:99], v[224:227]
    ds_read_b64_tr_b16 a[240:241], v44 offset:4096
    ds_read_b64_tr_b16 a[242:243], v44 offset:6144
    s_and_b32 s60, s7, s8
    s_cbranch_scc0 L_sel6_1
L_sel6_1_go:
    s_ff1_i32_b32 s60, s60
    s_bitset0_b32 s8, s60
    v_mfma_f32_16x16x32_bf16 v[232:235], a[228:231], a[96:99], v[232:235]
    ds_read_b64_tr_b16 a[244:245], v45 offset:4096
    ds_read_b64_tr_b16 a[246:247], v45 offset:6144
    s_add_u32 s60, s60, s55
    s_and_b32 s60, s60, 7
    s_lshl_b32 s61, s60, 15
    s_waitcnt lgkmcnt(4)
    v_mfma_f32_16x16x32_bf16 v[240:243], a[232:235], a[96:99], v[240:243]
    ds_read_b64_tr_b16 a[248:249], v46 offset:4096
    ds_read_b64_tr_b16 a[250:251], v46 offset:6144
    s_add_u32 s12, s61, s73
    s_add_u32 s13, s12, 4096
    s_lshl_b32 s61, s60, 2
    v_mfma_f32_16x16x32_bf16 v[248:251], a[236:239], a[96:99], v[248:251]
    ds_read_b64_tr_b16 a[252:253], v47 offset:4096
    ds_read_b64_tr_b16 a[254:255], v47 offset:6144
    s_lshr_b32 s61, 0x52419876, s61
    s_and_b32 s61, s61, 15
    s_lshl_b32 s9, s61, 14
    s_waitcnt vmcnt(6) lgkmcnt(4)
    v_mfma_f32_16x16x32_bf16 v[224:227], a[240:243], a[100:103], v[224:227]
    ds_read_b64_tr_b16 a[224:225], v44 offset:8192
    ds_read_b64_tr_b16 a[226:227], v44 offset:10240
    buffer_load_dwordx4 a[160:163], v53, s[40:43], s12 offen offset:0 sc1
    v_mfma_f32_16x16x32_bf16 v[232:235], a[244:247], a[100:103], v[232:235]
    ds_read_b64_tr_b16 a[228:229], v45 offset:8192
    ds_read_b64_tr_b16 a[230:231], v45 offset:10240
    s_waitcnt lgkmcnt(4)
    v_mfma_f32_16x16x32_bf16 v[240:243], a[248:251], a[100:103], v[240:243]
    ds_read_b64_tr_b16 a[232:233], v46 offset:8192
    ds_read_b64_tr_b16 a[234:235], v46 offset:10240
    buffer_load_dwordx4 a[164:167], v53, s[40:43], s12 offen offset:1024 sc1
    v_mfma_f32_16x16x32_bf16 v[248:251], a[252:255], a[100:103], v[248:251]
    ds_read_b64_tr_b16 a[236:237], v47 offset:8192
    ds_read_b64_tr_b16 a[238:239], v47 offset:10240
    s_waitcnt vmcnt(7) lgkmcnt(4)
    v_mfma_f32_16x16x32_bf16 v[224:227], a[224:227], a[104:107], v[224:227]
    ds_read_b64_tr_b16 a[240:241], v44 offset:12288
    ds_read_b64_tr_b16 a[242:243], v44 offset:14336
    v_mfma_f32_16x16x32_bf16 v[232:235], a[228:231], a[104:107], v[232:235]
    ds_read_b64_tr_b16 a[244:245], v45 offset:12288
    ds_read_b64_tr_b16 a[246:247], v45 offset:14336
    v_add_u32 v44, s11, v40
    v_add_u32 v45, s11, v41
    s_waitcnt lgkmcnt(4)
    v_mfma_f32_16x16x32_bf16 v[240:243], a[232:235], a[104:107], v[240:243]
    ds_read_b64_tr_b16 a[248:249], v46 offset:12288
    ds_read_b64_tr_b16 a[250:251], v46 offset:14336
    buffer_load_dwordx4 a[168:171], v53, s[40:43], s12 offen offset:2048 sc1
    v_mfma_f32_16x16x32_bf16 v[248:251], a[236:239], a[104:107], v[248:251]
    ds_read_b64_tr_b16 a[252:253], v47 offset:12288
    ds_read_b64_tr_b16 a[254:255], v47 offset:14336
    v_add_u32 v46, s11, v42
    v_add_u32 v47, s11, v43
    s_waitcnt vmcnt(7) lgkmcnt(4)
    v_mfma_f32_16x16x32_bf16 v[224:227], a[240:243], a[108:111], v[224:227]
    ds_read_b64_tr_b16 a[224:225], v44 offset:0
    ds_read_b64_tr_b16 a[226:227], v44 offset:2048
    buffer_load_dwordx4 a[172:175], v53, s[40:43], s12 offen offset:3072 sc1
    v_mfma_f32_16x16x32_bf16 v[232:235], a[244:247], a[108:111], v[232:235]
    ds_read_b64_tr_b16 a[228:229], v45 offset:0
    ds_read_b64_tr_b16 a[230:231], v45 offset:2048
    s_waitcnt lgkmcnt(4)
    v_mfma_f32_16x16x32_bf16 v[240:243], a[248:251], a[108:111], v[240:243]
    ds_read_b64_tr_b16 a[232:233], v46 offset:0
    ds_read_b64_tr_b16 a[234:235], v46 offset:2048
    v_mfma_f32_16x16x32_bf16 v[248:251], a[252:255], a[108:111], v[248:251]
    ds_read_b64_tr_b16 a[236:237], v47 offset:0
    ds_read_b64_tr_b16 a[238:239], v47 offset:2048
    s_waitcnt vmcnt(7) lgkmcnt(4)
    v_mfma_f32_16x16x32_bf16 v[224:227], a[224:227], a[128:131], v[224:227]
    ds_read_b64_tr_b16 a[240:241], v44 offset:4096
    ds_read_b64_tr_b16 a[242:243], v44 offset:6144
    s_and_b32 s60, s7, s8
    s_cbranch_scc0 L_sel7_1
L_sel7_1_go:
    s_ff1_i32_b32 s60, s60
    s_bitset0_b32 s8, s60
    v_mfma_f32_16x16x32_bf16 v[232:235], a[228:231], a[128:131], v[232:235]
    ds_read_b64_tr_b16 a[244:245], v45 offset:4096
    ds_read_b64_tr_b16 a[246:247], v45 offset:6144
    s_add_u32 s60, s60, s55
    s_and_b32 s60, s60, 7
    s_lshl_b32 s61, s60, 15
    s_waitcnt lgkmcnt(4)
    v_mfma_f32_16x16x32_bf16 v[240:243], a[232:235], a[128:131], v[240:243]
    ds_read_b64_tr_b16 a[248:249], v46 offset:4096
    ds_read_b64_tr_b16 a[250:251], v46 offset:6144
    s_add_u32 s12, s61, s73
    s_add_u32 s13, s12, 4096
    s_lshl_b32 s61, s60, 2
    v_mfma_f32_16x16x32_bf16 v[248:251], a[236:239], a[128:131], v[248:251]
    ds_read_b64_tr_b16 a[252:253], v47 offset:4096
    ds_read_b64_tr_b16 a[254:255], v47 offset:6144
    s_lshr_b32 s61, 0x52419876, s61
    s_and_b32 s61, s61, 15
    s_lshl_b32 s10, s61, 14
    s_waitcnt vmcnt(6) lgkmcnt(4)
    v_mfma_f32_16x16x32_bf16 v[224:227], a[240:243], a[132:135], v[224:227]
    ds_read_b64_tr_b16 a[224:225], v44 offset:8192
    ds_read_b64_tr_b16 a[226:227], v44 offset:10240
    buffer_load_dwordx4 a[192:195], v53, s[40:43], s12 offen offset:0 sc1
    v_mfma_f32_16x16x32_bf16 v[232:235], a[244:247], a[132:135], v[232:235]
    ds_read_b64_tr_b16 a[228:229], v45 offset:8192
    ds_read_b64_tr_b16 a[230:231], v45 offset:10240
    s_waitcnt lgkmcnt(4)
    v_mfma_f32_16x16x32_bf16 v[240:243], a[248:251], a[132:135], v[240:243]
    ds_read_b64_tr_b16 a[232:233], v46 offset:8192
    ds_read_b64_tr_b16 a[234:235], v46 offset:10240
    buffer_load_dwordx4 a[196:199], v53, s[40:43], s12 offen offset:1024 sc1
    v_mfma_f32_16x16x32_bf16 v[248:251], a[252:255], a[132:135], v[248:251]
    ds_read_b64_tr_b16 a[236:237], v47 offset:8192
    ds_read_b64_tr_b16 a[238:239], v47 offset:10240
    s_waitcnt vmcnt(7) lgkmcnt(4)
    v_mfma_f32_16x16x32_bf16 v[224:227], a[224:227], a[136:139], v[224:227]
    ds_read_b64_tr_b16 a[240:241], v44 offset:12288
    ds_read_b64_tr_b16 a[242:243], v44 offset:14336
    v_mfma_f32_16x16x32_bf16 v[232:235], a[228:231], a[136:139], v[232:235]
    ds_read_b64_tr_b16 a[244:245], v45 offset:12288
    ds_read_b64_tr_b16 a[246:247], v45 offset:14336
    v_add_u32 v44, s9, v40
    v_add_u32 v45, s9, v41
    s_waitcnt lgkmcnt(4)
    v_mfma_f32_16x16x32_bf16 v[240:243], a[232:235], a[136:139], v[240:243]
    ds_read_b64_tr_b16 a[248:249], v46 offset:12288
    ds_read_b64_tr_b16 a[250:251], v46 offset:14336
    buffer_load_dwordx4 a[200:203], v53, s[40:43], s12 offen offset:2048 sc1
    v_mfma_f32_16x16x32_bf16 v[248:251], a[236:239], a[136:139], v[248:251]
    ds_read_b64_tr_b16 a[252:253], v47 offset:12288
    ds_read_b64_tr_b16 a[254:255], v47 offset:14336
    v_add_u32 v46, s9, v42
    v_add_u32 v47, s9, v43
    s_waitcnt vmcnt(7) lgkmcnt(4)
    v_mfma_f32_16x16x32_bf16 v[224:227], a[240:243], a[140:143], v[224:227]
    ds_read_b64_tr_b16 a[224:225], v44 offset:0
    ds_read_b64_tr_b16 a[226:227], v44 offset:2048
    buffer_load_dwordx4 a[204:207], v53, s[40:43], s12 offen offset:3072 sc1
    v_mfma_f32_16x16x32_bf16 v[232:235], a[244:247], a[140:143], v[232:235]
    ds_read_b64_tr_b16 a[228:229], v45 offset:0
    ds_read_b64_tr_b16 a[230:231], v45 offset:2048
    s_waitcnt lgkmcnt(4)
    v_mfma_f32_16x16x32_bf16 v[240:243], a[248:251], a[140:143], v[240:243]
    ds_read_b64_tr_b16 a[232:233], v46 offset:0
    ds_read_b64_tr_b16 a[234:235], v46 offset:2048
    v_mfma_f32_16x16x32_bf16 v[248:251], a[252:255], a[140:143], v[248:251]
    ds_read_b64_tr_b16 a[236:237], v47 offset:0
    ds_read_b64_tr_b16 a[238:239], v47 offset:2048
    s_waitcnt vmcnt(7) lgkmcnt(4)
    v_mfma_f32_16x16x32_bf16 v[224:227], a[224:227], a[160:163], v[224:227]
    ds_read_b64_tr_b16 a[240:241], v44 offset:4096
    ds_read_b64_tr_b16 a[242:243], v44 offset:6144
    v_mfma_f32_16x16x32_bf16 v[232:235], a[228:231], a[160:163], v[232:235]
    ds_read_b64_tr_b16 a[244:245], v45 offset:4096
    ds_read_b64_tr_b16 a[246:247], v45 offset:6144
    s_waitcnt lgkmcnt(4)
    v_mfma_f32_16x16x32_bf16 v[240:243], a[232:235], a[160:163], v[240:243]
    ds_read_b64_tr_b16 a[248:249], v46 offset:4096
    ds_read_b64_tr_b16 a[250:251], v46 offset:6144
    v_mfma_f32_16x16x32_bf16 v[248:251], a[236:239], a[160:163], v[248:251]
    ds_read_b64_tr_b16 a[252:253], v47 offset:4096
    ds_read_b64_tr_b16 a[254:255], v47 offset:6144
    s_waitcnt vmcnt(6) lgkmcnt(4)
    v_mfma_f32_16x16x32_bf16 v[224:227], a[240:243], a[164:167], v[224:227]
    ds_read_b64_tr_b16 a[224:225], v44 offset:8192
    ds_read_b64_tr_b16 a[226:227], v44 offset:10240
    v_mfma_f32_16x16x32_bf16 v[232:235], a[244:247], a[164:167], v[232:235]
    ds_read_b64_tr_b16 a[228:229], v45 offset:8192
    ds_read_b64_tr_b16 a[230:231], v45 offset:10240
    s_waitcnt lgkmcnt(4)
    v_mfma_f32_16x16x32_bf16 v[240:243], a[248:251], a[164:167], v[240:243]
    ds_read_b64_tr_b16 a[232:233], v46 offset:8192
    ds_read_b64_tr_b16 a[234:235], v46 offset:10240
    v_mfma_f32_16x16x32_bf16 v[248:251], a[252:255], a[164:167], v[248:251]
    ds_read_b64_tr_b16 a[236:237], v47 offset:8192
    ds_read_b64_tr_b16 a[238:239], v47 offset:10240
    s_waitcnt vmcnt(5) lgkmcnt(4)
    v_mfma_f32_16x16x32_bf16 v[224:227], a[224:227], a[168:171], v[224:227]
    ds_read_b64_tr_b16 a[240:241], v44 offset:12288
    ds_read_b64_tr_b16 a[242:243], v44 offset:14336
    v_mfma_f32_16x16x32_bf16 v[232:235], a[228:231], a[168:171], v[232:235]
    ds_read_b64_tr_b16 a[244:245], v45 offset:12288
    ds_read_b64_tr_b16 a[246:247], v45 offset:14336
    v_add_u32 v44, s10, v40
    v_add_u32 v45, s10, v41
    s_waitcnt lgkmcnt(4)
    v_mfma_f32_16x16x32_bf16 v[240:243], a[232:235], a[168:171], v[240:243]
    ds_read_b64_tr_b16 a[248:249], v46 offset:12288
    ds_read_b64_tr_b16 a[250:251], v46 offset:14336
    v_mfma_f32_16x16x32_bf16 v[248:251], a[236:239], a[168:171], v[248:251]
    ds_read_b64_tr_b16 a[252:253], v47 offset:12288
    ds_read_b64_tr_b16 a[254:255], v47 offset:14336
    v_add_u32 v46, s10, v42
    v_add_u32 v47, s10, v43
    s_waitcnt vmcnt(4) lgkmcnt(4)
    v_mfma_f32_16x16x32_bf16 v[224:227], a[240:243], a[172:175], v[224:227]
    ds_read_b64_tr_b16 a[224:225], v44 offset:0
    ds_read_b64_tr_b16 a[226:227], v44 offset:2048
    v_mfma_f32_16x16x32_bf16 v[232:235], a[244:247], a[172:175], v[232:235]
    ds_read_b64_tr_b16 a[228:229], v45 offset:0
    ds_read_b64_tr_b16 a[230:231], v45 offset:2048
    s_waitcnt lgkmcnt(4)
    v_mfma_f32_16x16x32_bf16 v[240:243], a[248:251], a[172:175], v[240:243]
    ds_read_b64_tr_b16 a[232:233], v46 offset:0
    ds_read_b64_tr_b16 a[234:235], v46 offset:2048
    v_mfma_f32_16x16x32_bf16 v[248:251], a[252:255], a[172:175], v[248:251]
    ds_read_b64_tr_b16 a[236:237], v47 offset:0
    ds_read_b64_tr_b16 a[238:239], v47 offset:2048
    s_waitcnt vmcnt(3) lgkmcnt(4)
    v_mfma_f32_16x16x32_bf16 v[224:227], a[224:227], a[192:195], v[224:227]
    ds_read_b64_tr_b16 a[240:241], v44 offset:4096
    ds_read_b64_tr_b16 a[242:243], v44 offset:6144
    v_mfma_f32_16x16x32_bf16 v[232:235], a[228:231], a[192:195], v[232:235]
    ds_read_b64_tr_b16 a[244:245], v45 offset:4096
    ds_read_b64_tr_b16 a[246:247], v45 offset:6144
    s_waitcnt lgkmcnt(4)
    v_mfma_f32_16x16x32_bf16 v[240:243], a[232:235], a[192:195], v[240:243]
    ds_read_b64_tr_b16 a[248:249], v46 offset:4096
    ds_read_b64_tr_b16 a[250:251], v46 offset:6144
    v_mfma_f32_16x16x32_bf16 v[248:251], a[236:239], a[192:195], v[248:251]
    ds_read_b64_tr_b16 a[252:253], v47 offset:4096
    ds_read_b64_tr_b16 a[254:255], v47 offset:6144
    s_waitcnt vmcnt(2) lgkmcnt(4)
    v_mfma_f32_16x16x32_bf16 v[224:227], a[240:243], a[196:199], v[224:227]
    ds_read_b64_tr_b16 a[224:225], v44 offset:8192
    ds_read_b64_tr_b16 a[226:227], v44 offset:10240
    v_mfma_f32_16x16x32_bf16 v[232:235], a[244:247], a[196:199], v[232:235]
    ds_read_b64_tr_b16 a[228:229], v45 offset:8192
    ds_read_b64_tr_b16 a[230:231], v45 offset:10240
    s_waitcnt lgkmcnt(4)
    v_mfma_f32_16x16x32_bf16 v[240:243], a[248:251], a[196:199], v[240:243]
    ds_read_b64_tr_b16 a[232:233], v46 offset:8192
    ds_read_b64_tr_b16 a[234:235], v46 offset:10240
    v_mfma_f32_16x16x32_bf16 v[248:251], a[252:255], a[196:199], v[248:251]
    ds_read_b64_tr_b16 a[236:237], v47 offset:8192
    ds_read_b64_tr_b16 a[238:239], v47 offset:10240
    s_waitcnt vmcnt(1) lgkmcnt(4)
    v_mfma_f32_16x16x32_bf16 v[224:227], a[224:227], a[200:203], v[224:227]
    ds_read_b64_tr_b16 a[240:241], v46 offset:12288
    ds_read_b64_tr_b16 a[242:243], v46 offset:14336
    v_mfma_f32_16x16x32_bf16 v[232:235], a[228:231], a[200:203], v[232:235]
    ds_read_b64_tr_b16 a[244:245], v47 offset:12288
    ds_read_b64_tr_b16 a[246:247], v47 offset:14336
    s_waitcnt lgkmcnt(4)
    v_mfma_f32_16x16x32_bf16 v[240:243], a[232:235], a[200:203], v[240:243]
    ds_read_b64_tr_b16 a[248:249], v44 offset:12288
    ds_read_b64_tr_b16 a[250:251], v44 offset:14336
    v_mfma_f32_16x16x32_bf16 v[248:251], a[236:239], a[200:203], v[248:251]
    ds_read_b64_tr_b16 a[252:253], v45 offset:12288
    ds_read_b64_tr_b16 a[254:255], v45 offset:14336
    s_waitcnt vmcnt(0) lgkmcnt(4)
    v_mfma_f32_16x16x32_bf16 v[240:243], a[240:243], a[204:207], v[240:243]
    v_mfma_f32_16x16x32_bf16 v[248:251], a[244:247], a[204:207], v[248:251]
    s_waitcnt lgkmcnt(0)
    v_mfma_f32_16x16x32_bf16 v[232:235], a[252:255], a[204:207], v[232:235]
    v_mfma_f32_16x16x32_bf16 v[224:227], a[248:251], a[204:207], v[224:227]
    s_lshl_b32 s69, s56, 11
    s_add_u32 s69, s69, s74
    s_xor_b32 s60, s56, 1
    s_lshl_b32 s60, s60, 13
    s_add_u32 s66, s60, s69
    s_xor_b32 s60, s56, 2
    s_lshl_b32 s60, s60, 13
    s_add_u32 s67, s60, s69
    s_xor_b32 s60, s56, 3
    s_lshl_b32 s60, s60, 13
    s_add_u32 s68, s60, s69
    buffer_store_dwordx4 v[232:235], v53, s[40:43], s66 offen offset:0 sc1
    buffer_store_dwordx4 v[240:243], v53, s[40:43], s67 offen offset:0 sc1
    buffer_store_dwordx4 v[248:251], v53, s[40:43], s68 offen offset:0 sc1
    s_lshl_b32 s69, s56, 13
    s_add_u32 s69, s69, s74
    s_xor_b32 s60, s56, 1
    s_lshl_b32 s60, s60, 11
    s_add_u32 s66, s60, s69
    s_xor_b32 s60, s56, 2
    s_lshl_b32 s60, s60, 11
    s_add_u32 s67, s60, s69
    s_xor_b32 s60, s56, 3
    s_lshl_b32 s60, s60, 11
    s_add_u32 s68, s60, s69
    s_waitcnt vmcnt(0)
    s_mov_b64 exec, 14
    buffer_store_dwordx2 v[184:185], v188, s[40:43], 0 offen sc1
    s_mov_b64 exec, -1
    s_mov_b32 s75, 0
L_p2_1:
    buffer_load_dwordx2 v[186:187], v52, s[40:43], 0 offen sc1
    s_add_u32 s75, s75, 1
    s_cmp_gt_u32 s75, 4000000
    s_cbranch_scc1 L_p2_1_out
    s_waitcnt vmcnt(0)
    v_cmp_ne_u64 vcc, v[184:185], v[186:187]
    s_cbranch_vccz L_p2_1_out
    s_branch L_p2_1
L_p2_1_out:
    buffer_load_dwordx4 v[232:235], v53, s[40:43], s66 offen offset:0 sc1
    buffer_load_dwordx4 v[240:243], v53, s[40:43], s67 offen offset:0 sc1
    buffer_load_dwordx4 v[248:251], v53, s[40:43], s68 offen offset:0 sc1
    s_waitcnt vmcnt(2)
    v_add_f32 v224, v224, v232
    v_add_f32 v225, v225, v233
    v_add_f32 v226, v226, v234
    v_add_f32 v227, v227, v235
    s_waitcnt vmcnt(1)
    v_add_f32 v224, v224, v240
    v_add_f32 v225, v225, v241
    v_add_f32 v226, v226, v242
    v_add_f32 v227, v227, v243
    s_waitcnt vmcnt(0)
    v_add_f32 v224, v224, v248
    v_add_f32 v225, v225, v249
    v_add_f32 v226, v226, v250
    v_add_f32 v227, v227, v251
    v_cvt_pk_bf16_f32 v176, v224, v225
    v_cvt_pk_bf16_f32 v177, v226, v227
    s_nop 1
    v_permlane16_swap_b32 v176, v178
    v_permlane16_swap_b32 v177, v179
    buffer_store_dwordx4 v[176:179], v54, s[44:47], 0 offen
    s_endpgm
L_slow_1:
    s_waitcnt lgkmcnt(0)
    s_waitcnt lgkmcnt(4)
    v_mfma_f32_16x16x32_bf16 v[224:227], a[224:227], v[192:195], 0
    ds_read_b64_tr_b16 a[240:241], v44 offset:4096
    ds_read_b64_tr_b16 a[242:243], v44 offset:6144
    v_mfma_f32_16x16x32_bf16 v[232:235], a[228:231], v[192:195], 0
    ds_read_b64_tr_b16 a[244:245], v45 offset:4096
    ds_read_b64_tr_b16 a[246:247], v45 offset:6144
    s_waitcnt lgkmcnt(4)
    v_mfma_f32_16x16x32_bf16 v[240:243], a[232:235], v[192:195], 0
    ds_read_b64_tr_b16 a[248:249], v46 offset:4096
    ds_read_b64_tr_b16 a[250:251], v46 offset:6144
    v_mfma_f32_16x16x32_bf16 v[248:251], a[236:239], v[192:195], 0
    ds_read_b64_tr_b16 a[252:253], v47 offset:4096
    ds_read_b64_tr_b16 a[254:255], v47 offset:6144
    s_waitcnt lgkmcnt(4)
    v_mfma_f32_16x16x32_bf16 v[224:227], a[240:243], v[196:199], v[224:227]
    ds_read_b64_tr_b16 a[224:225], v44 offset:8192
    ds_read_b64_tr_b16 a[226:227], v44 offset:10240
    v_mfma_f32_16x16x32_bf16 v[232:235], a[244:247], v[196:199], v[232:235]
    ds_read_b64_tr_b16 a[228:229], v45 offset:8192
    ds_read_b64_tr_b16 a[230:231], v45 offset:10240
    s_waitcnt lgkmcnt(4)
    v_mfma_f32_16x16x32_bf16 v[240:243], a[248:251], v[196:199], v[240:243]
    ds_read_b64_tr_b16 a[232:233], v46 offset:8192
    ds_read_b64_tr_b16 a[234:235], v46 offset:10240
    v_mfma_f32_16x16x32_bf16 v[248:251], a[252:255], v[196:199], v[248:251]
    ds_read_b64_tr_b16 a[236:237], v47 offset:8192
    ds_read_b64_tr_b16 a[238:239], v47 offset:10240
    s_waitcnt lgkmcnt(4)
    v_mfma_f32_16x16x32_bf16 v[224:227], a[224:227], v[200:203], v[224:227]
    ds_read_b64_tr_b16 a[240:241], v44 offset:12288
    ds_read_b64_tr_b16 a[242:243], v44 offset:14336
    v_mfma_f32_16x16x32_bf16 v[232:235], a[228:231], v[200:203], v[232:235]
    ds_read_b64_tr_b16 a[244:245], v45 offset:12288
    ds_read_b64_tr_b16 a[246:247], v45 offset:14336
    s_waitcnt lgkmcnt(4)
    v_mfma_f32_16x16x32_bf16 v[240:243], a[232:235], v[200:203], v[240:243]
    ds_read_b64_tr_b16 a[248:249], v46 offset:12288
    ds_read_b64_tr_b16 a[250:251], v46 offset:14336
    v_mfma_f32_16x16x32_bf16 v[248:251], a[236:239], v[200:203], v[248:251]
    ds_read_b64_tr_b16 a[252:253], v47 offset:12288
    ds_read_b64_tr_b16 a[254:255], v47 offset:14336
    s_waitcnt lgkmcnt(4)
    v_mfma_f32_16x16x32_bf16 v[224:227], a[240:243], v[204:207], v[224:227]
    v_mfma_f32_16x16x32_bf16 v[232:235], a[244:247], v[204:207], v[232:235]
    s_waitcnt lgkmcnt(0)
    v_mfma_f32_16x16x32_bf16 v[240:243], a[248:251], v[204:207], v[240:243]
    v_mfma_f32_16x16x32_bf16 v[248:251], a[252:255], v[204:207], v[248:251]
    buffer_load_dwordx2 v[186:187], v51, s[40:43], 0 offen sc1
    s_waitcnt vmcnt(1)
    s_mov_b64 exec, 1
    buffer_store_dwordx2 v[184:185], v55, s[40:43], 0 offen sc1
    s_mov_b64 exec, -1
    s_waitcnt vmcnt(1)
    v_cmp_eq_u64 vcc, v[184:185], v[186:187]
    s_nop 0
    s_mov_b32 s7, vcc_lo
    s_and_b32 s60, s7, s8
    s_cbranch_scc0 L_sel1_1
L_sel1_1_go:
    s_ff1_i32_b32 s60, s60
    s_bitset0_b32 s8, s60
    s_add_u32 s60, s60, s55
    s_and_b32 s60, s60, 7
    s_lshl_b32 s61, s60, 15
    s_add_u32 s12, s61, s73
    s_add_u32 s13, s12, 4096
    s_lshl_b32 s61, s60, 2
    s_lshr_b32 s61, 0x52419876, s61
    s_and_b32 s61, s61, 15
    s_lshl_b32 s10, s61, 14
    buffer_load_dwordx4 a[0:3], v53, s[40:43], s12 offen offset:0 sc1
    buffer_load_dwordx4 a[4:7], v53, s[40:43], s12 offen offset:1024 sc1
    buffer_load_dwordx4 a[8:11], v53, s[40:43], s12 offen offset:2048 sc1
    buffer_load_dwordx4 a[12:15], v53, s[40:43], s12 offen offset:3072 sc1
    v_add_u32 v44, s10, v40
    v_add_u32 v45, s10, v41
    v_add_u32 v46, s10, v42
    v_add_u32 v47, s10, v43
    ds_read_b64_tr_b16 a[224:225], v44 offset:0
    ds_read_b64_tr_b16 a[226:227], v44 offset:2048
    ds_read_b64_tr_b16 a[228:229], v45 offset:0
    ds_read_b64_tr_b16 a[230:231], v45 offset:2048
    ds_read_b64_tr_b16 a[232:233], v46 offset:0
    ds_read_b64_tr_b16 a[234:235], v46 offset:2048
    ds_read_b64_tr_b16 a[236:237], v47 offset:0
    ds_read_b64_tr_b16 a[238:239], v47 offset:2048
    s_and_b32 s60, s7, s8
    s_cbranch_scc0 L_sel2_1
L_sel2_1_go:
    s_ff1_i32_b32 s60, s60
    s_bitset0_b32 s8, s60
    s_add_u32 s60, s60, s55
    s_and_b32 s60, s60, 7
    s_lshl_b32 s61, s60, 15
    s_add_u32 s12, s61, s73
    s_add_u32 s13, s12, 4096
    s_lshl_b32 s61, s60, 2
    s_lshr_b32 s61, 0x52419876, s61
    s_and_b32 s61, s61, 15
    s_lshl_b32 s11, s61, 14
    buffer_load_dwordx4 a[32:35], v53, s[40:43], s12 offen offset:0 sc1
    buffer_load_dwordx4 a[36:39], v53, s[40:43], s12 offen offset:1024 sc1
    buffer_load_dwordx4 a[40:43], v53, s[40:43], s12 offen offset:2048 sc1
    buffer_load_dwordx4 a[44:47], v53, s[40:43], s12 offen offset:3072 sc1
    s_branch L_common_1
L_sel3_2:
    s_mov_b32 s75, 0
L_sel3_2_l:
    buffer_load_dwordx2 v[186:187], v51, s[40:43], 0 offen sc1
    s_add_u32 s75, s75, 1
    s_waitcnt vmcnt(0)
    v_cmp_eq_u64 vcc, v[184:185], v[186:187]
    s_cmp_gt_u32 s75, 4000000
    s_cselect_b32 s7, -1, vcc_lo
    s_and_b32 s60, s7, s8
    s_cbranch_scc1 L_sel3_2_go
    s_branch L_sel3_2_l
L_sel4_2:
    s_mov_b32 s75, 0
L_sel4_2_l:
    buffer_load_dwordx2 v[186:187], v51, s[40:43], 0 offen sc1
    s_add_u32 s75, s75, 1
    s_waitcnt vmcnt(0)
    v_cmp_eq_u64 vcc, v[184:185], v[186:187]
    s_cmp_gt_u32 s75, 4000000
    s_cselect_b32 s7, -1, vcc_lo
    s_and_b32 s60, s7, s8
    s_cbranch_scc1 L_sel4_2_go
    s_branch L_sel4_2_l
L_sel5_2:
    s_mov_b32 s75, 0
L_sel5_2_l:
    buffer_load_dwordx2 v[186:187], v51, s[40:43], 0 offen sc1
    s_add_u32 s75, s75, 1
    s_waitcnt vmcnt(0)
    v_cmp_eq_u64 vcc, v[184:185], v[186:187]
    s_cmp_gt_u32 s75, 4000000
    s_cselect_b32 s7, -1, vcc_lo
    s_and_b32 s60, s7, s8
    s_cbranch_scc1 L_sel5_2_go
    s_branch L_sel5_2_l
L_sel6_2:
    s_mov_b32 s75, 0
L_sel6_2_l:
    buffer_load_dwordx2 v[186:187], v51, s[40:43], 0 offen sc1
    s_add_u32 s75, s75, 1
    s_waitcnt vmcnt(0)
    v_cmp_eq_u64 vcc, v[184:185], v[186:187]
    s_cmp_gt_u32 s75, 4000000
    s_cselect_b32 s7, -1, vcc_lo
    s_and_b32 s60, s7, s8
    s_cbranch_scc1 L_sel6_2_go
    s_branch L_sel6_2_l
L_sel7_2:
    s_mov_b32 s75, 0
L_sel7_2_l:
    buffer_load_dwordx2 v[186:187], v51, s[40:43], 0 offen sc1
    s_add_u32 s75, s75, 1
    s_waitcnt vmcnt(0)
    v_cmp_eq_u64 vcc, v[184:185], v[186:187]
    s_cmp_gt_u32 s75, 4000000
    s_cselect_b32 s7, -1, vcc_lo
    s_and_b32 s60, s7, s8
    s_cbranch_scc1 L_sel7_2_go
    s_branch L_sel7_2_l
L_sel1_2:
    s_mov_b32 s75, 0
L_sel1_2_l:
    buffer_load_dwordx2 v[186:187], v51, s[40:43], 0 offen sc1
    s_add_u32 s75, s75, 1
    s_waitcnt vmcnt(0)
    v_cmp_eq_u64 vcc, v[184:185], v[186:187]
    s_cmp_gt_u32 s75, 4000000
    s_cselect_b32 s7, -1, vcc_lo
    s_and_b32 s60, s7, s8
    s_cbranch_scc1 L_sel1_2_go
    s_branch L_sel1_2_l
L_sel2_2:
    s_mov_b32 s75, 0
L_sel2_2_l:
    buffer_load_dwordx2 v[186:187], v51, s[40:43], 0 offen sc1
    s_add_u32 s75, s75, 1
    s_waitcnt vmcnt(0)
    v_cmp_eq_u64 vcc, v[184:185], v[186:187]
    s_cmp_gt_u32 s75, 4000000
    s_cselect_b32 s7, -1, vcc_lo
    s_and_b32 s60, s7, s8
    s_cbranch_scc1 L_sel2_2_go
    s_branch L_sel2_2_l
L_sel3_1:
    s_mov_b32 s75, 0
L_sel3_1_l:
    buffer_load_dwordx2 v[186:187], v51, s[40:43], 0 offen sc1
    s_add_u32 s75, s75, 1
    s_waitcnt vmcnt(0)
    v_cmp_eq_u64 vcc, v[184:185], v[186:187]
    s_cmp_gt_u32 s75, 4000000
    s_cselect_b32 s7, -1, vcc_lo
    s_and_b32 s60, s7, s8
    s_cbranch_scc1 L_sel3_1_go
    s_branch L_sel3_1_l
L_sel4_1:
    s_mov_b32 s75, 0
L_sel4_1_l:
    buffer_load_dwordx2 v[186:187], v51, s[40:43], 0 offen sc1
    s_add_u32 s75, s75, 1
    s_waitcnt vmcnt(0)
    v_cmp_eq_u64 vcc, v[184:185], v[186:187]
    s_cmp_gt_u32 s75, 4000000
    s_cselect_b32 s7, -1, vcc_lo
    s_and_b32 s60, s7, s8
    s_cbranch_scc1 L_sel4_1_go
    s_branch L_sel4_1_l
L_sel5_1:
    s_mov_b32 s75, 0
L_sel5_1_l:
    buffer_load_dwordx2 v[186:187], v51, s[40:43], 0 offen sc1
    s_add_u32 s75, s75, 1
    s_waitcnt vmcnt(0)
    v_cmp_eq_u64 vcc, v[184:185], v[186:187]
    s_cmp_gt_u32 s75, 4000000
    s_cselect_b32 s7, -1, vcc_lo
    s_and_b32 s60, s7, s8
    s_cbranch_scc1 L_sel5_1_go
    s_branch L_sel5_1_l
L_sel6_1:
    s_mov_b32 s75, 0
L_sel6_1_l:
    buffer_load_dwordx2 v[186:187], v51, s[40:43], 0 offen sc1
    s_add_u32 s75, s75, 1
    s_waitcnt vmcnt(0)
    v_cmp_eq_u64 vcc, v[184:185], v[186:187]
    s_cmp_gt_u32 s75, 4000000
    s_cselect_b32 s7, -1, vcc_lo
    s_and_b32 s60, s7, s8
    s_cbranch_scc1 L_sel6_1_go
    s_branch L_sel6_1_l
L_sel7_1:
    s_mov_b32 s75, 0
L_sel7_1_l:
    buffer_load_dwordx2 v[186:187], v51, s[40:43], 0 offen sc1
    s_add_u32 s75, s75, 1
    s_waitcnt vmcnt(0)
    v_cmp_eq_u64 vcc, v[184:185], v[186:187]
    s_cmp_gt_u32 s75, 4000000
    s_cselect_b32 s7, -1, vcc_lo
    s_and_b32 s60, s7, s8
    s_cbranch_scc1 L_sel7_1_go
    s_branch L_sel7_1_l
L_sel1_1:
    s_mov_b32 s75, 0
L_sel1_1_l:
    buffer_load_dwordx2 v[186:187], v51, s[40:43], 0 offen sc1
    s_add_u32 s75, s75, 1
    s_waitcnt vmcnt(0)
    v_cmp_eq_u64 vcc, v[184:185], v[186:187]
    s_cmp_gt_u32 s75, 4000000
    s_cselect_b32 s7, -1, vcc_lo
    s_and_b32 s60, s7, s8
    s_cbranch_scc1 L_sel1_1_go
    s_branch L_sel1_1_l
L_sel2_1:
    s_mov_b32 s75, 0
L_sel2_1_l:
    buffer_load_dwordx2 v[186:187], v51, s[40:43], 0 offen sc1
    s_add_u32 s75, s75, 1
    s_waitcnt vmcnt(0)
    v_cmp_eq_u64 vcc, v[184:185], v[186:187]
    s_cmp_gt_u32 s75, 4000000
    s_cselect_b32 s7, -1, vcc_lo
    s_and_b32 s60, s7, s8
    s_cbranch_scc1 L_sel2_1_go
    s_branch L_sel2_1_l
L_tail_end:
L_rs_0_2:
    s_mov_b32 s60, 0
    s_branch L_rsB_2
L_rs_1_2:
    s_mov_b32 s60, 1
    s_branch L_rsA_2
L_rs_2_2:
    s_mov_b32 s60, 2
    s_branch L_rsB_2
L_rs_3_2:
    s_mov_b32 s60, 3
    s_branch L_rsA_2
L_rs_4_2:
    s_mov_b32 s60, 4
    s_branch L_rsB_2
L_rs_5_2:
    s_mov_b32 s60, 5
    s_branch L_rsA_2
L_rs_6_2:
    s_mov_b32 s60, 6
    s_branch L_rsB_2
L_rs_7_2:
    s_mov_b32 s60, 7
    s_branch L_rsA_2
L_rs_8_2:
    s_mov_b32 s60, 8
    s_branch L_rsB_2
L_rs_9_2:
    s_mov_b32 s60, 9
    s_branch L_rsA_2
L_rs_10_2:
    s_mov_b32 s60, 10
    s_branch L_rsB_2
L_rs_11_2:
    s_mov_b32 s60, 11
    s_branch L_rsA_2
L_rs_12_2:
    s_mov_b32 s60, 12
    s_branch L_rsB_2
L_rsA_2:
    v_max3_f32 v48, v128, v129, v130
    v_max3_f32 v48, v48, v131, v136
    v_max3_f32 v48, v48, v137, v138
    v_max_f32 v48, v48, v139
    v_max3_f32 v49, v132, v133, v134
    v_max3_f32 v49, v49, v135, v140
    v_max3_f32 v49, v49, v141, v142
    v_max_f32 v49, v49, v143
    v_mov_b32 v60, v48
    v_mov_b32 v61, v49
    s_nop 1
    v_permlane32_swap_b32 v48, v60
    v_permlane32_swap_b32 v49, v61
    v_max_f32 v48, v48, v60
    v_max_f32 v49, v49, v61
    v_mov_b32 v60, v48
    v_mov_b32 v61, v49
    s_nop 1
    v_permlane16_swap_b32 v48, v60
    v_permlane16_swap_b32 v49, v61
    v_max_f32 v48, v48, v60
    v_max_f32 v49, v49, v61
    v_max_f32 v48, 0, v48
    v_sub_f32 v60, 0, v48
    v_exp_f32 v60, v60
    v_max_f32 v49, 0, v49
    v_sub_f32 v61, 0, v49
    v_exp_f32 v61, v61
    v_sub_f32 v128, v128, v48
    v_sub_f32 v129, v129, v48
    v_sub_f32 v130, v130, v48
    v_sub_f32 v131, v131, v48
    v_sub_f32 v136, v136, v48
    v_sub_f32 v137, v137, v48
    v_sub_f32 v138, v138, v48
    v_sub_f32 v139, v139, v48
    v_sub_f32 v160, v160, v48
    v_sub_f32 v161, v161, v48
    v_sub_f32 v162, v162, v48
    v_sub_f32 v163, v163, v48
    v_sub_f32 v132, v132, v49
    v_sub_f32 v133, v133, v49
    v_sub_f32 v134, v134, v49
    v_sub_f32 v135, v135, v49
    v_sub_f32 v140, v140, v49
    v_sub_f32 v141, v141, v49
    v_sub_f32 v142, v142, v49
    v_sub_f32 v143, v143, v49
    v_sub_f32 v164, v164, v49
    v_sub_f32 v165, v165, v49
    v_sub_f32 v166, v166, v49
    v_sub_f32 v167, v167, v49
    v_mul_f32 v168, v168, v60
    v_mul_f32 v169, v169, v60
    v_mul_f32 v170, v170, v60
    v_mul_f32 v171, v171, v60
    v_mul_f32 v64, v64, v60
    v_mul_f32 v65, v65, v60
    v_mul_f32 v66, v66, v60
    v_mul_f32 v67, v67, v60
    v_mul_f32 v72, v72, v60
    v_mul_f32 v73, v73, v60
    v_mul_f32 v74, v74, v60
    v_mul_f32 v75, v75, v60
    v_mul_f32 v80, v80, v60
    v_mul_f32 v81, v81, v60
    v_mul_f32 v82, v82, v60
    v_mul_f32 v83, v83, v60
    v_mul_f32 v88, v88, v60
    v_mul_f32 v89, v89, v60
    v_mul_f32 v90, v90, v60
    v_mul_f32 v91, v91, v60
    v_mul_f32 v96, v96, v60
    v_mul_f32 v97, v97, v60
    v_mul_f32 v98, v98, v60
    v_mul_f32 v99, v99, v60
    v_mul_f32 v104, v104, v60
    v_mul_f32 v105, v105, v60
    v_mul_f32 v106, v106, v60
    v_mul_f32 v107, v107, v60
    v_mul_f32 v112, v112, v60
    v_mul_f32 v113, v113, v60
    v_mul_f32 v114, v114, v60
    v_mul_f32 v115, v115, v60
    v_mul_f32 v120, v120, v60
    v_mul_f32 v121, v121, v60
    v_mul_f32 v122, v122, v60
    v_mul_f32 v123, v123, v60
    v_mul_f32 v172, v172, v61
    v_mul_f32 v173, v173, v61
    v_mul_f32 v174, v174, v61
    v_mul_f32 v175, v175, v61
    v_mul_f32 v68, v68, v61
    v_mul_f32 v69, v69, v61
    v_mul_f32 v70, v70, v61
    v_mul_f32 v71, v71, v61
    v_mul_f32 v76, v76, v61
    v_mul_f32 v77, v77, v61
    v_mul_f32 v78, v78, v61
    v_mul_f32 v79, v79, v61
    v_mul_f32 v84, v84, v61
    v_mul_f32 v85, v85, v61
    v_mul_f32 v86, v86, v61
    v_mul_f32 v87, v87, v61
    v_mul_f32 v92, v92, v61
    v_mul_f32 v93, v93, v61
    v_mul_f32 v94, v94, v61
    v_mul_f32 v95, v95, v61
    v_mul_f32 v100, v100, v61
    v_mul_f32 v101, v101, v61
    v_mul_f32 v102, v102, v61
    v_mul_f32 v103, v103, v61
    v_mul_f32 v108, v108, v61
    v_mul_f32 v109, v109, v61
    v_mul_f32 v110, v110, v61
    v_mul_f32 v111, v111, v61
    v_mul_f32 v116, v116, v61
    v_mul_f32 v117, v117, v61
    v_mul_f32 v118, v118, v61
    v_mul_f32 v119, v119, v61
    v_mul_f32 v124, v124, v61
    v_mul_f32 v125, v125, v61
    v_mul_f32 v126, v126, v61
    v_mul_f32 v127, v127, v61
    s_cmp_eq_u32 s60, 1
    s_cbranch_scc1 L_rsb_1_2
    s_cmp_eq_u32 s60, 3
    s_cbranch_scc1 L_rsb_3_2
    s_cmp_eq_u32 s60, 5
    s_cbranch_scc1 L_rsb_5_2
    s_cmp_eq_u32 s60, 7
    s_cbranch_scc1 L_rsb_7_2
    s_cmp_eq_u32 s60, 9
    s_cbranch_scc1 L_rsb_9_2
    s_nop 0
    s_branch L_rsb_11_2
L_rsB_2:
    v_max3_f32 v48, v144, v145, v146
    v_max3_f32 v48, v48, v147, v152
    v_max3_f32 v48, v48, v153, v154
    v_max_f32 v48, v48, v155
    v_max3_f32 v49, v148, v149, v150
    v_max3_f32 v49, v49, v151, v156
    v_max3_f32 v49, v49, v157, v158
    v_max_f32 v49, v49, v159
    v_mov_b32 v60, v48
    v_mov_b32 v61, v49
    s_nop 1
    v_permlane32_swap_b32 v48, v60
    v_permlane32_swap_b32 v49, v61
    v_max_f32 v48, v48, v60
    v_max_f32 v49, v49, v61
    v_mov_b32 v60, v48
    v_mov_b32 v61, v49
    s_nop 1
    v_permlane16_swap_b32 v48, v60
    v_permlane16_swap_b32 v49, v61
    v_max_f32 v48, v48, v60
    v_max_f32 v49, v49, v61
    v_max_f32 v48, 0, v48
    v_sub_f32 v60, 0, v48
    v_exp_f32 v60, v60
    v_max_f32 v49, 0, v49
    v_sub_f32 v61, 0, v49
    v_exp_f32 v61, v61
    v_sub_f32 v144, v144, v48
    v_sub_f32 v145, v145, v48
    v_sub_f32 v146, v146, v48
    v_sub_f32 v147, v147, v48
    v_sub_f32 v152, v152, v48
    v_sub_f32 v153, v153, v48
    v_sub_f32 v154, v154, v48
    v_sub_f32 v155, v155, v48
    v_sub_f32 v160, v160, v48
    v_sub_f32 v161, v161, v48
    v_sub_f32 v162, v162, v48
    v_sub_f32 v163, v163, v48
    v_sub_f32 v148, v148, v49
    v_sub_f32 v149, v149, v49
    v_sub_f32 v150, v150, v49
    v_sub_f32 v151, v151, v49
    v_sub_f32 v156, v156, v49
    v_sub_f32 v157, v157, v49
    v_sub_f32 v158, v158, v49
    v_sub_f32 v159, v159, v49
    v_sub_f32 v164, v164, v49
    v_sub_f32 v165, v165, v49
    v_sub_f32 v166, v166, v49
    v_sub_f32 v167, v167, v49
    v_mul_f32 v168, v168, v60
    v_mul_f32 v169, v169, v60
    v_mul_f32 v170, v170, v60
    v_mul_f32 v171, v171, v60
    v_mul_f32 v64, v64, v60
    v_mul_f32 v65, v65, v60
    v_mul_f32 v66, v66, v60
    v_mul_f32 v67, v67, v60
    v_mul_f32 v72, v72, v60
    v_mul_f32 v73, v73, v60
    v_mul_f32 v74, v74, v60
    v_mul_f32 v75, v75, v60
    v_mul_f32 v80, v80, v60
    v_mul_f32 v81, v81, v60
    v_mul_f32 v82, v82, v60
    v_mul_f32 v83, v83, v60
    v_mul_f32 v88, v88, v60
    v_mul_f32 v89, v89, v60
    v_mul_f32 v90, v90, v60
    v_mul_f32 v91, v91, v60
    v_mul_f32 v96, v96, v60
    v_mul_f32 v97, v97, v60
    v_mul_f32 v98, v98, v60
    v_mul_f32 v99, v99, v60
    v_mul_f32 v104, v104, v60
    v_mul_f32 v105, v105, v60
    v_mul_f32 v106, v106, v60
    v_mul_f32 v107, v107, v60
    v_mul_f32 v112, v112, v60
    v_mul_f32 v113, v113, v60
    v_mul_f32 v114, v114, v60
    v_mul_f32 v115, v115, v60
    v_mul_f32 v120, v120, v60
    v_mul_f32 v121, v121, v60
    v_mul_f32 v122, v122, v60
    v_mul_f32 v123, v123, v60
    v_mul_f32 v172, v172, v61
    v_mul_f32 v173, v173, v61
    v_mul_f32 v174, v174, v61
    v_mul_f32 v175, v175, v61
    v_mul_f32 v68, v68, v61
    v_mul_f32 v69, v69, v61
    v_mul_f32 v70, v70, v61
    v_mul_f32 v71, v71, v61
    v_mul_f32 v76, v76, v61
    v_mul_f32 v77, v77, v61
    v_mul_f32 v78, v78, v61
    v_mul_f32 v79, v79, v61
    v_mul_f32 v84, v84, v61
    v_mul_f32 v85, v85, v61
    v_mul_f32 v86, v86, v61
    v_mul_f32 v87, v87, v61
    v_mul_f32 v92, v92, v61
    v_mul_f32 v93, v93, v61
    v_mul_f32 v94, v94, v61
    v_mul_f32 v95, v95, v61
    v_mul_f32 v100, v100, v61
    v_mul_f32 v101, v101, v61
    v_mul_f32 v102, v102, v61
    v_mul_f32 v103, v103, v61
    v_mul_f32 v108, v108, v61
    v_mul_f32 v109, v109, v61
    v_mul_f32 v110, v110, v61
    v_mul_f32 v111, v111, v61
    v_mul_f32 v116, v116, v61
    v_mul_f32 v117, v117, v61
    v_mul_f32 v118, v118, v61
    v_mul_f32 v119, v119, v61
    v_mul_f32 v124, v124, v61
    v_mul_f32 v125, v125, v61
    v_mul_f32 v126, v126, v61
    v_mul_f32 v127, v127, v61
    s_cmp_eq_u32 s60, 0
    s_cbranch_scc1 L_rsb_0_2
    s_cmp_eq_u32 s60, 2
    s_cbranch_scc1 L_rsb_2_2
    s_cmp_eq_u32 s60, 4
    s_cbranch_scc1 L_rsb_4_2
    s_cmp_eq_u32 s60, 6
    s_cbranch_scc1 L_rsb_6_2
    s_cmp_eq_u32 s60, 8
    s_cbranch_scc1 L_rsb_8_2
    s_cmp_eq_u32 s60, 10
    s_cbranch_scc1 L_rsb_10_2
    s_nop 0
    s_branch L_rsb_12_2
L_notag_2:
    v_mov_b32 v2, 0
    s_mov_b32 s75, 0
L_cnt_2:
    buffer_load_dwordx2 v[184:185], v2, s[48:51], 0 offen sc1
    s_add_u32 s75, s75, 1
    s_cmp_gt_u32 s75, 4000000
    s_cbranch_scc1 L_cnt_2_out
    s_waitcnt vmcnt(0)
    v_and_b32 v1, v184, v185
    v_and_b32 v1, 1, v1
    v_cmp_eq_u32 vcc, 0, v1
    s_cbranch_vccz L_cnt_2_out
    s_branch L_cnt_2
L_cnt_2_out:
    s_branch L_tag_2
L_rs_0_1:
    s_mov_b32 s60, 0
    s_branch L_rsB_1
L_rs_1_1:
    s_mov_b32 s60, 1
    s_branch L_rsA_1
L_rs_2_1:
    s_mov_b32 s60, 2
    s_branch L_rsB_1
L_rs_3_1:
    s_mov_b32 s60, 3
    s_branch L_rsA_1
L_rs_4_1:
    s_mov_b32 s60, 4
    s_branch L_rsB_1
L_rs_5_1:
    s_mov_b32 s60, 5
    s_branch L_rsA_1
L_rs_6_1:
    s_mov_b32 s60, 6
    s_branch L_rsB_1
L_rs_7_1:
    s_mov_b32 s60, 7
    s_branch L_rsA_1
L_rs_8_1:
    s_mov_b32 s60, 8
    s_branch L_rsB_1
L_rs_9_1:
    s_mov_b32 s60, 9
    s_branch L_rsA_1
L_rs_10_1:
    s_mov_b32 s60, 10
    s_branch L_rsB_1
L_rs_11_1:
    s_mov_b32 s60, 11
    s_branch L_rsA_1
L_rs_12_1:
    s_mov_b32 s60, 12
    s_branch L_rsB_1
L_rsA_1:
    v_max3_f32 v48, v128, v129, v130
    v_max3_f32 v48, v48, v131, v136
    v_max3_f32 v48, v48, v137, v138
    v_max_f32 v48, v48, v139
    v_mov_b32 v60, v48
    s_nop 1
    v_permlane32_swap_b32 v48, v60
    v_max_f32 v48, v48, v60
    v_mov_b32 v60, v48
    s_nop 1
    v_permlane16_swap_b32 v48, v60
    v_max_f32 v48, v48, v60
    v_max_f32 v48, 0, v48
    v_sub_f32 v60, 0, v48
    v_exp_f32 v60, v60
    v_sub_f32 v128, v128, v48
    v_sub_f32 v129, v129, v48
    v_sub_f32 v130, v130, v48
    v_sub_f32 v131, v131, v48
    v_sub_f32 v136, v136, v48
    v_sub_f32 v137, v137, v48
    v_sub_f32 v138, v138, v48
    v_sub_f32 v139, v139, v48
    v_sub_f32 v160, v160, v48
    v_sub_f32 v161, v161, v48
    v_sub_f32 v162, v162, v48
    v_sub_f32 v163, v163, v48
    v_mul_f32 v168, v168, v60
    v_mul_f32 v169, v169, v60
    v_mul_f32 v170, v170, v60
    v_mul_f32 v171, v171, v60
    v_mul_f32 v64, v64, v60
    v_mul_f32 v65, v65, v60
    v_mul_f32 v66, v66, v60
    v_mul_f32 v67, v67, v60
    v_mul_f32 v72, v72, v60
    v_mul_f32 v73, v73, v60
    v_mul_f32 v74, v74, v60
    v_mul_f32 v75, v75, v60
    v_mul_f32 v80, v80, v60
    v_mul_f32 v81, v81, v60
    v_mul_f32 v82, v82, v60
    v_mul_f32 v83, v83, v60
    v_mul_f32 v88, v88, v60
    v_mul_f32 v89, v89, v60
    v_mul_f32 v90, v90, v60
    v_mul_f32 v91, v91, v60
    v_mul_f32 v96, v96, v60
    v_mul_f32 v97, v97, v60
    v_mul_f32 v98, v98, v60
    v_mul_f32 v99, v99, v60
    v_mul_f32 v104, v104, v60
    v_mul_f32 v105, v105, v60
    v_mul_f32 v106, v106, v60
    v_mul_f32 v107, v107, v60
    v_mul_f32 v112, v112, v60
    v_mul_f32 v113, v113, v60
    v_mul_f32 v114, v114, v60
    v_mul_f32 v115, v115, v60
    v_mul_f32 v120, v120, v60
    v_mul_f32 v121, v121, v60
    v_mul_f32 v122, v122, v60
    v_mul_f32 v123, v123, v60
    s_cmp_eq_u32 s60, 1
    s_cbranch_scc1 L_rsb_1_1
    s_cmp_eq_u32 s60, 3
    s_cbranch_scc1 L_rsb_3_1
    s_cmp_eq_u32 s60, 5
    s_cbranch_scc1 L_rsb_5_1
    s_cmp_eq_u32 s60, 7
    s_cbranch_scc1 L_rsb_7_1
    s_cmp_eq_u32 s60, 9
    s_cbranch_scc1 L_rsb_9_1
    s_nop 0
    s_branch L_rsb_11_1
L_rsB_1:
    v_max3_f32 v48, v144, v145, v146
    v_max3_f32 v48, v48, v147, v152
    v_max3_f32 v48, v48, v153, v154
    v_max_f32 v48, v48, v155
    v_mov_b32 v60, v48
    s_nop 1
    v_permlane32_swap_b32 v48, v60
    v_max_f32 v48, v48, v60
    v_mov_b32 v60, v48
    s_nop 1
    v_permlane16_swap_b32 v48, v60
    v_max_f32 v48, v48, v60
    v_max_f32 v48, 0, v48
    v_sub_f32 v60, 0, v48
    v_exp_f32 v60, v60
    v_sub_f32 v144, v144, v48
    v_sub_f32 v145, v145, v48
    v_sub_f32 v146, v146, v48
    v_sub_f32 v147, v147, v48
    v_sub_f32 v152, v152, v48
    v_sub_f32 v153, v153, v48
    v_sub_f32 v154, v154, v48
    v_sub_f32 v155, v155, v48
    v_sub_f32 v160, v160, v48
    v_sub_f32 v161, v161, v48
    v_sub_f32 v162, v162, v48
    v_sub_f32 v163, v163, v48
    v_mul_f32 v168, v168, v60
    v_mul_f32 v169, v169, v60
    v_mul_f32 v170, v170, v60
    v_mul_f32 v171, v171, v60
    v_mul_f32 v64, v64, v60
    v_mul_f32 v65, v65, v60
    v_mul_f32 v66, v66, v60
    v_mul_f32 v67, v67, v60
    v_mul_f32 v72, v72, v60
    v_mul_f32 v73, v73, v60
    v_mul_f32 v74, v74, v60
    v_mul_f32 v75, v75, v60
    v_mul_f32 v80, v80, v60
    v_mul_f32 v81, v81, v60
    v_mul_f32 v82, v82, v60
    v_mul_f32 v83, v83, v60
    v_mul_f32 v88, v88, v60
    v_mul_f32 v89, v89, v60
    v_mul_f32 v90, v90, v60
    v_mul_f32 v91, v91, v60
    v_mul_f32 v96, v96, v60
    v_mul_f32 v97, v97, v60
    v_mul_f32 v98, v98, v60
    v_mul_f32 v99, v99, v60
    v_mul_f32 v104, v104, v60
    v_mul_f32 v105, v105, v60
    v_mul_f32 v106, v106, v60
    v_mul_f32 v107, v107, v60
    v_mul_f32 v112, v112, v60
    v_mul_f32 v113, v113, v60
    v_mul_f32 v114, v114, v60
    v_mul_f32 v115, v115, v60
    v_mul_f32 v120, v120, v60
    v_mul_f32 v121, v121, v60
    v_mul_f32 v122, v122, v60
    v_mul_f32 v123, v123, v60
    s_cmp_eq_u32 s60, 0
    s_cbranch_scc1 L_rsb_0_1
    s_cmp_eq_u32 s60, 2
    s_cbranch_scc1 L_rsb_2_1
    s_cmp_eq_u32 s60, 4
    s_cbranch_scc1 L_rsb_4_1
    s_cmp_eq_u32 s60, 6
    s_cbranch_scc1 L_rsb_6_1
    s_cmp_eq_u32 s60, 8
    s_cbranch_scc1 L_rsb_8_1
    s_cmp_eq_u32 s60, 10
    s_cbranch_scc1 L_rsb_10_1
    s_nop 0
    s_branch L_rsb_12_1
L_notag_1:
    v_mov_b32 v2, 0
    s_mov_b32 s75, 0
L_cnt_1:
    buffer_load_dwordx2 v[184:185], v2, s[48:51], 0 offen sc1
    s_add_u32 s75, s75, 1
    s_cmp_gt_u32 s75, 4000000
    s_cbranch_scc1 L_cnt_1_out
    s_waitcnt vmcnt(0)
    v_and_b32 v1, v184, v185
    v_and_b32 v1, 1, v1
    v_cmp_eq_u32 vcc, 0, v1
    s_cbranch_vccz L_cnt_1_out
    s_branch L_cnt_1
L_cnt_1_out:
    s_branch L_tag_1
.section .rodata,"a"
.p2align 6
.amdhsa_kernel standalone__mha_block_cached__near_ridge_kernel
  .amdhsa_next_free_vgpr 512
  .amdhsa_next_free_sgpr 102
  .amdhsa_accum_offset 256
  .amdhsa_group_segment_fixed_size 0
  .amdhsa_kernarg_size 64
  .amdhsa_user_sgpr_count 2
  .amdhsa_user_sgpr_kernarg_segment_ptr 1
  .amdhsa_system_sgpr_workgroup_id_x 1
  .amdhsa_float_denorm_mode_32 3
.end_amdhsa_kernel
```
